```python
import torch

def _softmax(x, axis=-1):
    return torch.softmax(x, dim=axis)

def _gelu(x):
    return torch.nn.functional.gelu(x, approximate='tanh')

def _silu(x):
    return torch.nn.functional.silu(x)

def _sigmoid(x):
    return torch.sigmoid(x)

def _layernorm(x, axis=-1, eps=1e-05):
    m = x.mean(dim=axis, keepdim=True)
    v = x.var(dim=axis, keepdim=True, unbiased=False)
    return (x - m) / torch.sqrt(v + eps)

def _scatter_add(tgt, idx, src, axis=0):
    return tgt.clone().index_add_(axis, idx, src)

def _segment_sum(src, seg, n):
    out = torch.zeros((n,) + src.shape[1:], dtype=src.dtype)
    return out.index_add_(0, seg, src)

def _pad(x, pw):
    flat = tuple((v for pair in reversed(pw) for v in pair))
    return torch.nn.functional.pad(x, flat)
kernel_name = 'adaLN_cond__ssm_conv_h3__glu_gated_swiglu__prompt'

def setup_inputs():

    _w = lambda a: (lambda t: t.to(torch.bfloat16) if t.is_floating_point() else t)(torch.as_tensor(a))

    def _A_setup():
        B, S, D = (1, 2048, 1024)
        ks = 4
        return {'q': _w((lambda *s: torch.randn(*s, dtype=torch.bfloat16) * 0.05)(B, S, D)), 'k': _w((lambda *s: torch.randn(*s, dtype=torch.bfloat16) * 0.8)(B, S, D)), 'v': _w((lambda *s: torch.randn(*s, dtype=torch.bfloat16) * 0.8)(B, S, D)), 'shift_k': _w((lambda *s: torch.randn(*s, dtype=torch.bfloat16) * 0.8)(D, ks) * 0.5), 'ssm_k': _w((lambda *s: torch.randn(*s, dtype=torch.bfloat16) * 0.8)(D, S) * (1.0 / S ** 0.5)), 'ssm_D': _w((lambda *s: torch.randn(*s, dtype=torch.bfloat16) * 0.8)(D))}
    _A_in = _A_setup()

    def _B_setup():
        B, S, D, F = (1, 2048, 1024, 3584)
        return {'x': _w((lambda *s: torch.randn(*s, dtype=torch.bfloat16) * 0.05)(B, S, D)), 'w1': _w((lambda *s: torch.randn(*s, dtype=torch.bfloat16) * 0.8)(D, F) * (2.0 / D) ** 0.5), 'w3': _w((lambda *s: torch.randn(*s, dtype=torch.bfloat16) * 0.8)(D, F) * (2.0 / D) ** 0.5), 'w2': _w((lambda *s: torch.randn(*s, dtype=torch.bfloat16) * 0.8)(F, D) * (2.0 / F) ** 0.5)}
    _B_in = _B_setup()
    return {'A_q': _A_in['q'], 'A_k': _A_in['k'], 'A_v': _A_in['v'], 'A_shift_k': _A_in['shift_k'], 'A_ssm_k': _A_in['ssm_k'], 'A_ssm_D': _A_in['ssm_D'], 'B_x': _B_in['x'], 'B_w1': _B_in['w1'], 'B_w3': _B_in['w3'], 'B_w2': _B_in['w2'], 'c': _w((lambda *s: torch.randn(*s, dtype=torch.bfloat16) * 0.2)(1, 1024) * 8.0), 'w_mod': _w((lambda *s: torch.randn(*s, dtype=torch.bfloat16) * 0.2)(1024, 6 * 1024) * 1024 ** (-0.5) * 8.0)}

def reference(A_q, A_k, A_v, A_shift_k, A_ssm_k, A_ssm_D, B_x, B_w1, B_w3, B_w2, c, w_mod):

    def _A_ref(q, k, v, shift_k, ssm_k, ssm_D):
        B, S, D = q.shape
        ks = shift_k.shape[-1]
        k_pad = _pad(k, ((0, 0), (ks - 1, 0), (0, 0)))
        k_shift = torch.zeros_like(k)
        for t in range(ks):
            k_shift = k_shift + k_pad[:, t:t + S, :] * shift_k[:, ks - 1 - t][None, None, :]
        kv = k_shift * v
        L = 2 * S
        kv_pad = _pad(kv, ((0, 0), (0, S), (0, 0)))
        kf_pad = _pad(ssm_k, ((0, 0), (0, S)))
        kv_f = (lambda x, axes=(-2, -1): torch.fft.rfft2(x.float(), dim=axes))(kv_pad[:, None, :, :], axes=(1, 2))
        kf_f = (lambda x, axes=(-2, -1): torch.fft.rfft2(x.float(), dim=axes))(kf_pad[:, None, :], axes=(1, 2))
        kf_f = (lambda x, *d: x.permute(*d))(kf_f, 1, 2, 0)
        y_f = kv_f * kf_f[None, :, :, :]
        y = (lambda x, s, axes=(-2, -1): torch.fft.irfft2(x, s=s, dim=axes).to(torch.bfloat16))(y_f, (1, L), axes=(1, 2))[:, 0, :S, :]
        y = y + kv * ssm_D[None, None, :]
        return q * y

    def _B_ref(x, w1, w3, w2):
        gate = torch.einsum('bsd,df->bsf', x, w1)
        up = torch.einsum('bsd,df->bsf', x, w3)
        h = _silu(gate) * up
        out = torch.einsum('bsf,fd->bsd', h, w2)
        return out
    x = A_q
    mod = (_silu(c) @ w_mod).reshape(c.shape[0], 6, 1, -1)
    sa, ca, ga, sb, cb, gb = (mod[:, 0].clone(), mod[:, 1].clone(), mod[:, 2].clone(), mod[:, 3].clone(), mod[:, 4].clone(), mod[:, 5].clone())
    h = _layernorm(x, axis=-1) * (1 + ca) + sa
    x = x + ga * _A_ref(h, A_k, A_v, A_shift_k, A_ssm_k, A_ssm_D)
    h = _layernorm(x, axis=-1) * (1 + cb) + sb
    x = x + gb * _B_ref(h, B_w1, B_w3, B_w2)
    return x
```

```asm
; @launch grid=(256,1,1) block=(512,1,1) lds=163840
.amdgcn_target "amdgcn-amd-amdhsa--gfx950"
.text
.globl adaLN_cond__ssm_conv_h3__glu_gated_swiglu__prompt_kernel
.p2align 8
.type adaLN_cond__ssm_conv_h3__glu_gated_swiglu__prompt_kernel,@function
adaLN_cond__ssm_conv_h3__glu_gated_swiglu__prompt_kernel:
    s_cmp_ge_u32 s2, 256
    s_cbranch_scc1 Lend_1
    s_load_dwordx4 s[44:47], s[0:1], 8
    s_load_dwordx4 s[48:51], s[0:1], 24
    s_load_dwordx2 s[52:53], s[0:1], 40
    s_load_dwordx4 s[56:59], s[0:1], 56
    s_load_dwordx4 s[60:63], s[0:1], 72
    s_load_dwordx2 s[64:65], s[0:1], 88
    s_load_dwordx4 s[68:71], s[0:1], 104
    v_lshrrev_b32 v1, 6, v0
    v_and_b32 v2, 63, v0
    s_nop 0
    v_readfirstlane_b32 s16, v1
    s_mov_b32 s40, 0xffff0000
    s_and_b32 s41, s2, 7
    s_lshr_b32 s42, s2, 3
    s_and_b32 s92, s41, 1
    s_lshl_b32 s92, s92, 3
    s_and_b32 s19, s42, 7
    s_add_u32 s92, s92, s19
    s_lshr_b32 s3, s41, 1
    s_lshl_b32 s3, s3, 2
    s_lshr_b32 s19, s42, 3
    s_add_u32 s3, s3, s19
    s_lshl_b32 s17, s41, 7
    s_lshl_b32 s18, s42, 2
    s_add_u32 s17, s17, s18
    s_waitcnt lgkmcnt(0)
    s_mov_b32 s4, s44
    s_and_b32 s5, s45, 0xffff
    s_mov_b32 s6, 4194304
    s_mov_b32 s7, 0x00020000
    s_mov_b32 s8, s46
    s_and_b32 s9, s47, 0xffff
    s_mov_b32 s10, 4194304
    s_mov_b32 s11, 0x00020000
    s_mov_b32 s24, s48
    s_and_b32 s25, s49, 0xffff
    s_mov_b32 s26, 8192
    s_mov_b32 s27, 0x00020000
    s_add_u32 s20, s70, 28311552
    s_addc_u32 s21, s71, 0
    s_and_b32 s21, s21, 0xffff
    s_mov_b32 s22, 5242880
    s_mov_b32 s23, 0x00020000
    s_mov_b32 s72, s68
    s_and_b32 s73, s69, 0xffff
    s_mov_b32 s74, 256
    s_mov_b32 s75, 0x00020000
    s_add_u32 s32, s70, 33554432
    s_addc_u32 s33, s71, 0
    s_and_b32 s33, s33, 0xffff
    s_mov_b32 s34, 32768
    s_mov_b32 s35, 0x00020000
    s_cmp_lg_u32 s2, 0
    s_cbranch_scc1 Lnw_2
    s_memrealtime s[38:39]
    s_waitcnt lgkmcnt(0)
    s_lshl_b32 s38, s38, 3
    s_or_b32 s38, s38, 8
    v_mov_b32 v6, 0
    v_mov_b32 v7, s38
    v_cmp_eq_u32 vcc, 0, v0
    s_and_saveexec_b64 s[38:39], vcc
    s_cbranch_execz Lnw_2_r
    buffer_store_dword v7, v6, s[72:75], 0 offen sc1
Lnw_2_r:
    s_mov_b64 exec, s[38:39]
Lnw_2:
    v_mov_b32 v4, 113664
    v_mov_b32 v6, 0
    v_mov_b32 v7, 0
    v_mov_b32 v8, 0
    v_mov_b32 v9, 0
    ds_write_b128 v4, v[6:9]
    s_waitcnt lgkmcnt(0)
    s_barrier
    s_cmp_ge_u32 s16, 4
    s_cbranch_scc1 Laux_3
    v_and_b32 v130, 15, v0
    v_lshrrev_b32 v131, 4, v0
    s_lshl_b32 s19, s42, 17
    s_lshl_b32 s18, s41, 8
    s_add_u32 s19, s19, s18
    v_lshlrev_b32 v3, 13, v131
    v_lshl_add_u32 v3, v130, 4, v3
    v_add_u32 v3, s19, v3
    v_subrev_u32 v4, 6144, v3
    buffer_load_dwordx4 v[8:11], v4, s[4:7], 0 offen nt
    v_subrev_u32 v4, 4096, v3
    buffer_load_dwordx4 v[12:15], v4, s[4:7], 0 offen nt
    v_subrev_u32 v4, 2048, v3
    buffer_load_dwordx4 v[16:19], v4, s[4:7], 0 offen nt
    buffer_load_dwordx4 v[20:23], v3, s[4:7], 0 offen nt
    buffer_load_dwordx4 v[36:39], v3, s[8:11], 0 offen nt
    v_add_u32 v4, 2048, v3
    buffer_load_dwordx4 v[24:27], v4, s[4:7], 0 offen nt
    buffer_load_dwordx4 v[40:43], v4, s[8:11], 0 offen nt
    v_add_u32 v4, 4096, v3
    buffer_load_dwordx4 v[28:31], v4, s[4:7], 0 offen nt
    buffer_load_dwordx4 v[44:47], v4, s[8:11], 0 offen nt
    v_add_u32 v4, 6144, v3
    buffer_load_dwordx4 v[32:35], v4, s[4:7], 0 offen nt
    buffer_load_dwordx4 v[48:51], v4, s[8:11], 0 offen nt
    s_lshl_b32 s18, s41, 10
    v_lshlrev_b32 v4, 6, v130
    v_add_u32 v4, s18, v4
    buffer_load_dwordx4 v[52:55], v4, s[24:27], 0 offen offset:0
    buffer_load_dwordx4 v[56:59], v4, s[24:27], 0 offen offset:16
    buffer_load_dwordx4 v[60:63], v4, s[24:27], 0 offen offset:32
    buffer_load_dwordx4 v[64:67], v4, s[24:27], 0 offen offset:48
    s_add_u32 s18, s17, s16
    s_lshl_b32 s18, s18, 12
    s_add_u32 s12, s50, s18
    s_addc_u32 s13, s51, 0
    s_and_b32 s13, s13, 0xffff
    s_mov_b32 s14, 4096
    s_mov_b32 s15, 0x00020000
    s_lshl_b32 s18, s17, 1
    s_add_u32 s18, s52, s18
    s_addc_u32 s19, s53, 0
    s_load_dwordx2 s[76:77], s[18:19], 0
    v_lshlrev_b32 v5, 4, v2
    buffer_load_dwordx4 a[0:3], v5, s[12:15], 0 offen offset:0 nt
    buffer_load_dwordx4 a[4:7], v5, s[12:15], 0 offen offset:4 nt
    buffer_load_dwordx4 a[8:11], v5, s[12:15], 0 offen offset:8 nt
    buffer_load_dwordx4 a[12:15], v5, s[12:15], 0 offen offset:1024 nt
    buffer_load_dwordx4 a[16:19], v5, s[12:15], 0 offen offset:1028 nt
    buffer_load_dwordx4 a[20:23], v5, s[12:15], 0 offen offset:1032 nt
    buffer_load_dwordx4 a[24:27], v5, s[12:15], 0 offen offset:2048 nt
    buffer_load_dwordx4 a[28:31], v5, s[12:15], 0 offen offset:2052 nt
    buffer_load_dwordx4 a[32:35], v5, s[12:15], 0 offen offset:2056 nt
    buffer_load_dwordx4 a[36:39], v5, s[12:15], 0 offen offset:3072 nt
    buffer_load_dwordx4 a[40:43], v5, s[12:15], 0 offen offset:3076 nt
    buffer_load_dwordx4 a[44:47], v5, s[12:15], 0 offen offset:3080 nt
    v_mov_b32 v6, 0
    buffer_load_dwordx2 v[132:133], v6, s[12:15], 0 offen
    s_waitcnt vmcnt(13)
    buffer_load_dword v137, v6, s[72:75], 0 offen sc1
    v_lshlrev_b32 v68, 16, v52
    v_and_b32 v70, s40, v52
    v_lshlrev_b32 v72, 16, v53
    v_and_b32 v74, s40, v53
    v_lshlrev_b32 v69, 16, v54
    v_and_b32 v71, s40, v54
    v_lshlrev_b32 v73, 16, v55
    v_and_b32 v75, s40, v55
    v_lshlrev_b32 v76, 16, v8
    v_and_b32 v77, s40, v8
    v_lshlrev_b32 v78, 16, v12
    v_and_b32 v79, s40, v12
    v_lshlrev_b32 v80, 16, v16
    v_and_b32 v81, s40, v16
    v_lshlrev_b32 v82, 16, v20
    v_and_b32 v83, s40, v20
    v_lshlrev_b32 v84, 16, v24
    v_and_b32 v85, s40, v24
    v_lshlrev_b32 v86, 16, v28
    v_and_b32 v87, s40, v28
    v_lshlrev_b32 v88, 16, v32
    v_and_b32 v89, s40, v32
    v_pk_mul_f32 v[98:99], v[76:77], v[74:75]
    v_cvt_pk_bf16_f32 v138, v98, v99
    v_lshlrev_b32 v98, 16, v138
    v_and_b32 v99, s40, v138
    v_pk_mul_f32 v[90:91], v[78:79], v[72:73]
    v_cvt_pk_bf16_f32 v138, v90, v91
    v_lshlrev_b32 v90, 16, v138
    v_and_b32 v91, s40, v138
    v_pk_add_f32 v[98:99], v[98:99], v[90:91]
    v_cvt_pk_bf16_f32 v138, v98, v99
    v_lshlrev_b32 v98, 16, v138
    v_and_b32 v99, s40, v138
    v_pk_mul_f32 v[90:91], v[80:81], v[70:71]
    v_cvt_pk_bf16_f32 v138, v90, v91
    v_lshlrev_b32 v90, 16, v138
    v_and_b32 v91, s40, v138
    v_pk_add_f32 v[98:99], v[98:99], v[90:91]
    v_cvt_pk_bf16_f32 v138, v98, v99
    v_lshlrev_b32 v98, 16, v138
    v_and_b32 v99, s40, v138
    v_pk_mul_f32 v[90:91], v[82:83], v[68:69]
    v_cvt_pk_bf16_f32 v138, v90, v91
    v_lshlrev_b32 v90, 16, v138
    v_and_b32 v91, s40, v138
    v_pk_add_f32 v[98:99], v[98:99], v[90:91]
    v_cvt_pk_bf16_f32 v138, v98, v99
    v_lshlrev_b32 v98, 16, v138
    v_and_b32 v99, s40, v138
    v_lshlrev_b32 v92, 16, v36
    v_and_b32 v93, s40, v36
    v_pk_mul_f32 v[98:99], v[98:99], v[92:93]
    v_pk_mul_f32 v[106:107], v[78:79], v[74:75]
    v_cvt_pk_bf16_f32 v139, v106, v107
    v_lshlrev_b32 v106, 16, v139
    v_and_b32 v107, s40, v139
    v_pk_mul_f32 v[94:95], v[80:81], v[72:73]
    v_cvt_pk_bf16_f32 v139, v94, v95
    v_lshlrev_b32 v94, 16, v139
    v_and_b32 v95, s40, v139
    v_pk_add_f32 v[106:107], v[106:107], v[94:95]
    v_cvt_pk_bf16_f32 v139, v106, v107
    v_lshlrev_b32 v106, 16, v139
    v_and_b32 v107, s40, v139
    v_pk_mul_f32 v[94:95], v[82:83], v[70:71]
    v_cvt_pk_bf16_f32 v139, v94, v95
    v_lshlrev_b32 v94, 16, v139
    v_and_b32 v95, s40, v139
    v_pk_add_f32 v[106:107], v[106:107], v[94:95]
    v_cvt_pk_bf16_f32 v139, v106, v107
    v_lshlrev_b32 v106, 16, v139
    v_and_b32 v107, s40, v139
    v_pk_mul_f32 v[94:95], v[84:85], v[68:69]
    v_cvt_pk_bf16_f32 v139, v94, v95
    v_lshlrev_b32 v94, 16, v139
    v_and_b32 v95, s40, v139
    v_pk_add_f32 v[106:107], v[106:107], v[94:95]
    v_cvt_pk_bf16_f32 v139, v106, v107
    v_lshlrev_b32 v106, 16, v139
    v_and_b32 v107, s40, v139
    v_lshlrev_b32 v96, 16, v40
    v_and_b32 v97, s40, v40
    v_pk_mul_f32 v[106:107], v[106:107], v[96:97]
    v_pk_mul_f32 v[114:115], v[80:81], v[74:75]
    v_cvt_pk_bf16_f32 v138, v114, v115
    v_lshlrev_b32 v114, 16, v138
    v_and_b32 v115, s40, v138
    v_pk_mul_f32 v[90:91], v[82:83], v[72:73]
    v_cvt_pk_bf16_f32 v138, v90, v91
    v_lshlrev_b32 v90, 16, v138
    v_and_b32 v91, s40, v138
    v_pk_add_f32 v[114:115], v[114:115], v[90:91]
    v_cvt_pk_bf16_f32 v138, v114, v115
    v_lshlrev_b32 v114, 16, v138
    v_and_b32 v115, s40, v138
    v_pk_mul_f32 v[90:91], v[84:85], v[70:71]
    v_cvt_pk_bf16_f32 v138, v90, v91
    v_lshlrev_b32 v90, 16, v138
    v_and_b32 v91, s40, v138
    v_pk_add_f32 v[114:115], v[114:115], v[90:91]
    v_cvt_pk_bf16_f32 v138, v114, v115
    v_lshlrev_b32 v114, 16, v138
    v_and_b32 v115, s40, v138
    v_pk_mul_f32 v[90:91], v[86:87], v[68:69]
    v_cvt_pk_bf16_f32 v138, v90, v91
    v_lshlrev_b32 v90, 16, v138
    v_and_b32 v91, s40, v138
    v_pk_add_f32 v[114:115], v[114:115], v[90:91]
    v_cvt_pk_bf16_f32 v138, v114, v115
    v_lshlrev_b32 v114, 16, v138
    v_and_b32 v115, s40, v138
    v_lshlrev_b32 v92, 16, v44
    v_and_b32 v93, s40, v44
    v_pk_mul_f32 v[114:115], v[114:115], v[92:93]
    v_pk_mul_f32 v[122:123], v[82:83], v[74:75]
    v_cvt_pk_bf16_f32 v139, v122, v123
    v_lshlrev_b32 v122, 16, v139
    v_and_b32 v123, s40, v139
    v_pk_mul_f32 v[94:95], v[84:85], v[72:73]
    v_cvt_pk_bf16_f32 v139, v94, v95
    v_lshlrev_b32 v94, 16, v139
    v_and_b32 v95, s40, v139
    v_pk_add_f32 v[122:123], v[122:123], v[94:95]
    v_cvt_pk_bf16_f32 v139, v122, v123
    v_lshlrev_b32 v122, 16, v139
    v_and_b32 v123, s40, v139
    v_pk_mul_f32 v[94:95], v[86:87], v[70:71]
    v_cvt_pk_bf16_f32 v139, v94, v95
    v_lshlrev_b32 v94, 16, v139
    v_and_b32 v95, s40, v139
    v_pk_add_f32 v[122:123], v[122:123], v[94:95]
    v_cvt_pk_bf16_f32 v139, v122, v123
    v_lshlrev_b32 v122, 16, v139
    v_and_b32 v123, s40, v139
    v_pk_mul_f32 v[94:95], v[88:89], v[68:69]
    v_cvt_pk_bf16_f32 v139, v94, v95
    v_lshlrev_b32 v94, 16, v139
    v_and_b32 v95, s40, v139
    v_pk_add_f32 v[122:123], v[122:123], v[94:95]
    v_cvt_pk_bf16_f32 v139, v122, v123
    v_lshlrev_b32 v122, 16, v139
    v_and_b32 v123, s40, v139
    v_lshlrev_b32 v96, 16, v48
    v_and_b32 v97, s40, v48
    v_pk_mul_f32 v[122:123], v[122:123], v[96:97]
    v_lshlrev_b32 v68, 16, v56
    v_and_b32 v70, s40, v56
    v_lshlrev_b32 v72, 16, v57
    v_and_b32 v74, s40, v57
    v_lshlrev_b32 v69, 16, v58
    v_and_b32 v71, s40, v58
    v_lshlrev_b32 v73, 16, v59
    v_and_b32 v75, s40, v59
    v_lshlrev_b32 v76, 16, v9
    v_and_b32 v77, s40, v9
    v_lshlrev_b32 v78, 16, v13
    v_and_b32 v79, s40, v13
    v_lshlrev_b32 v80, 16, v17
    v_and_b32 v81, s40, v17
    v_lshlrev_b32 v82, 16, v21
    v_and_b32 v83, s40, v21
    v_lshlrev_b32 v84, 16, v25
    v_and_b32 v85, s40, v25
    v_lshlrev_b32 v86, 16, v29
    v_and_b32 v87, s40, v29
    v_lshlrev_b32 v88, 16, v33
    v_and_b32 v89, s40, v33
    v_pk_mul_f32 v[100:101], v[76:77], v[74:75]
    v_cvt_pk_bf16_f32 v138, v100, v101
    v_lshlrev_b32 v100, 16, v138
    v_and_b32 v101, s40, v138
    v_pk_mul_f32 v[90:91], v[78:79], v[72:73]
    v_cvt_pk_bf16_f32 v138, v90, v91
    v_lshlrev_b32 v90, 16, v138
    v_and_b32 v91, s40, v138
    v_pk_add_f32 v[100:101], v[100:101], v[90:91]
    v_cvt_pk_bf16_f32 v138, v100, v101
    v_lshlrev_b32 v100, 16, v138
    v_and_b32 v101, s40, v138
    v_pk_mul_f32 v[90:91], v[80:81], v[70:71]
    v_cvt_pk_bf16_f32 v138, v90, v91
    v_lshlrev_b32 v90, 16, v138
    v_and_b32 v91, s40, v138
    v_pk_add_f32 v[100:101], v[100:101], v[90:91]
    v_cvt_pk_bf16_f32 v138, v100, v101
    v_lshlrev_b32 v100, 16, v138
    v_and_b32 v101, s40, v138
    v_pk_mul_f32 v[90:91], v[82:83], v[68:69]
    v_cvt_pk_bf16_f32 v138, v90, v91
    v_lshlrev_b32 v90, 16, v138
    v_and_b32 v91, s40, v138
    v_pk_add_f32 v[100:101], v[100:101], v[90:91]
    v_cvt_pk_bf16_f32 v138, v100, v101
    v_lshlrev_b32 v100, 16, v138
    v_and_b32 v101, s40, v138
    v_lshlrev_b32 v92, 16, v37
    v_and_b32 v93, s40, v37
    v_pk_mul_f32 v[100:101], v[100:101], v[92:93]
    v_pk_mul_f32 v[108:109], v[78:79], v[74:75]
    v_cvt_pk_bf16_f32 v139, v108, v109
    v_lshlrev_b32 v108, 16, v139
    v_and_b32 v109, s40, v139
    v_pk_mul_f32 v[94:95], v[80:81], v[72:73]
    v_cvt_pk_bf16_f32 v139, v94, v95
    v_lshlrev_b32 v94, 16, v139
    v_and_b32 v95, s40, v139
    v_pk_add_f32 v[108:109], v[108:109], v[94:95]
    v_cvt_pk_bf16_f32 v139, v108, v109
    v_lshlrev_b32 v108, 16, v139
    v_and_b32 v109, s40, v139
    v_pk_mul_f32 v[94:95], v[82:83], v[70:71]
    v_cvt_pk_bf16_f32 v139, v94, v95
    v_lshlrev_b32 v94, 16, v139
    v_and_b32 v95, s40, v139
    v_pk_add_f32 v[108:109], v[108:109], v[94:95]
    v_cvt_pk_bf16_f32 v139, v108, v109
    v_lshlrev_b32 v108, 16, v139
    v_and_b32 v109, s40, v139
    v_pk_mul_f32 v[94:95], v[84:85], v[68:69]
    v_cvt_pk_bf16_f32 v139, v94, v95
    v_lshlrev_b32 v94, 16, v139
    v_and_b32 v95, s40, v139
    v_pk_add_f32 v[108:109], v[108:109], v[94:95]
    v_cvt_pk_bf16_f32 v139, v108, v109
    v_lshlrev_b32 v108, 16, v139
    v_and_b32 v109, s40, v139
    v_lshlrev_b32 v96, 16, v41
    v_and_b32 v97, s40, v41
    v_pk_mul_f32 v[108:109], v[108:109], v[96:97]
    v_pk_mul_f32 v[116:117], v[80:81], v[74:75]
    v_cvt_pk_bf16_f32 v138, v116, v117
    v_lshlrev_b32 v116, 16, v138
    v_and_b32 v117, s40, v138
    v_pk_mul_f32 v[90:91], v[82:83], v[72:73]
    v_cvt_pk_bf16_f32 v138, v90, v91
    v_lshlrev_b32 v90, 16, v138
    v_and_b32 v91, s40, v138
    v_pk_add_f32 v[116:117], v[116:117], v[90:91]
    v_cvt_pk_bf16_f32 v138, v116, v117
    v_lshlrev_b32 v116, 16, v138
    v_and_b32 v117, s40, v138
    v_pk_mul_f32 v[90:91], v[84:85], v[70:71]
    v_cvt_pk_bf16_f32 v138, v90, v91
    v_lshlrev_b32 v90, 16, v138
    v_and_b32 v91, s40, v138
    v_pk_add_f32 v[116:117], v[116:117], v[90:91]
    v_cvt_pk_bf16_f32 v138, v116, v117
    v_lshlrev_b32 v116, 16, v138
    v_and_b32 v117, s40, v138
    v_pk_mul_f32 v[90:91], v[86:87], v[68:69]
    v_cvt_pk_bf16_f32 v138, v90, v91
    v_lshlrev_b32 v90, 16, v138
    v_and_b32 v91, s40, v138
    v_pk_add_f32 v[116:117], v[116:117], v[90:91]
    v_cvt_pk_bf16_f32 v138, v116, v117
    v_lshlrev_b32 v116, 16, v138
    v_and_b32 v117, s40, v138
    v_lshlrev_b32 v92, 16, v45
    v_and_b32 v93, s40, v45
    v_pk_mul_f32 v[116:117], v[116:117], v[92:93]
    v_pk_mul_f32 v[124:125], v[82:83], v[74:75]
    v_cvt_pk_bf16_f32 v139, v124, v125
    v_lshlrev_b32 v124, 16, v139
    v_and_b32 v125, s40, v139
    v_pk_mul_f32 v[94:95], v[84:85], v[72:73]
    v_cvt_pk_bf16_f32 v139, v94, v95
    v_lshlrev_b32 v94, 16, v139
    v_and_b32 v95, s40, v139
    v_pk_add_f32 v[124:125], v[124:125], v[94:95]
    v_cvt_pk_bf16_f32 v139, v124, v125
    v_lshlrev_b32 v124, 16, v139
    v_and_b32 v125, s40, v139
    v_pk_mul_f32 v[94:95], v[86:87], v[70:71]
    v_cvt_pk_bf16_f32 v139, v94, v95
    v_lshlrev_b32 v94, 16, v139
    v_and_b32 v95, s40, v139
    v_pk_add_f32 v[124:125], v[124:125], v[94:95]
    v_cvt_pk_bf16_f32 v139, v124, v125
    v_lshlrev_b32 v124, 16, v139
    v_and_b32 v125, s40, v139
    v_pk_mul_f32 v[94:95], v[88:89], v[68:69]
    v_cvt_pk_bf16_f32 v139, v94, v95
    v_lshlrev_b32 v94, 16, v139
    v_and_b32 v95, s40, v139
    v_pk_add_f32 v[124:125], v[124:125], v[94:95]
    v_cvt_pk_bf16_f32 v139, v124, v125
    v_lshlrev_b32 v124, 16, v139
    v_and_b32 v125, s40, v139
    v_lshlrev_b32 v96, 16, v49
    v_and_b32 v97, s40, v49
    v_pk_mul_f32 v[124:125], v[124:125], v[96:97]
    v_lshlrev_b32 v68, 16, v60
    v_and_b32 v70, s40, v60
    v_lshlrev_b32 v72, 16, v61
    v_and_b32 v74, s40, v61
    v_lshlrev_b32 v69, 16, v62
    v_and_b32 v71, s40, v62
    v_lshlrev_b32 v73, 16, v63
    v_and_b32 v75, s40, v63
    v_lshlrev_b32 v76, 16, v10
    v_and_b32 v77, s40, v10
    v_lshlrev_b32 v78, 16, v14
    v_and_b32 v79, s40, v14
    v_lshlrev_b32 v80, 16, v18
    v_and_b32 v81, s40, v18
    v_lshlrev_b32 v82, 16, v22
    v_and_b32 v83, s40, v22
    v_lshlrev_b32 v84, 16, v26
    v_and_b32 v85, s40, v26
    v_lshlrev_b32 v86, 16, v30
    v_and_b32 v87, s40, v30
    v_lshlrev_b32 v88, 16, v34
    v_and_b32 v89, s40, v34
    v_pk_mul_f32 v[102:103], v[76:77], v[74:75]
    v_cvt_pk_bf16_f32 v138, v102, v103
    v_lshlrev_b32 v102, 16, v138
    v_and_b32 v103, s40, v138
    v_pk_mul_f32 v[90:91], v[78:79], v[72:73]
    v_cvt_pk_bf16_f32 v138, v90, v91
    v_lshlrev_b32 v90, 16, v138
    v_and_b32 v91, s40, v138
    v_pk_add_f32 v[102:103], v[102:103], v[90:91]
    v_cvt_pk_bf16_f32 v138, v102, v103
    v_lshlrev_b32 v102, 16, v138
    v_and_b32 v103, s40, v138
    v_pk_mul_f32 v[90:91], v[80:81], v[70:71]
    v_cvt_pk_bf16_f32 v138, v90, v91
    v_lshlrev_b32 v90, 16, v138
    v_and_b32 v91, s40, v138
    v_pk_add_f32 v[102:103], v[102:103], v[90:91]
    v_cvt_pk_bf16_f32 v138, v102, v103
    v_lshlrev_b32 v102, 16, v138
    v_and_b32 v103, s40, v138
    v_pk_mul_f32 v[90:91], v[82:83], v[68:69]
    v_cvt_pk_bf16_f32 v138, v90, v91
    v_lshlrev_b32 v90, 16, v138
    v_and_b32 v91, s40, v138
    v_pk_add_f32 v[102:103], v[102:103], v[90:91]
    v_cvt_pk_bf16_f32 v138, v102, v103
    v_lshlrev_b32 v102, 16, v138
    v_and_b32 v103, s40, v138
    v_lshlrev_b32 v92, 16, v38
    v_and_b32 v93, s40, v38
    v_pk_mul_f32 v[102:103], v[102:103], v[92:93]
    v_pk_mul_f32 v[110:111], v[78:79], v[74:75]
    v_cvt_pk_bf16_f32 v139, v110, v111
    v_lshlrev_b32 v110, 16, v139
    v_and_b32 v111, s40, v139
    v_pk_mul_f32 v[94:95], v[80:81], v[72:73]
    v_cvt_pk_bf16_f32 v139, v94, v95
    v_lshlrev_b32 v94, 16, v139
    v_and_b32 v95, s40, v139
    v_pk_add_f32 v[110:111], v[110:111], v[94:95]
    v_cvt_pk_bf16_f32 v139, v110, v111
    v_lshlrev_b32 v110, 16, v139
    v_and_b32 v111, s40, v139
    v_pk_mul_f32 v[94:95], v[82:83], v[70:71]
    v_cvt_pk_bf16_f32 v139, v94, v95
    v_lshlrev_b32 v94, 16, v139
    v_and_b32 v95, s40, v139
    v_pk_add_f32 v[110:111], v[110:111], v[94:95]
    v_cvt_pk_bf16_f32 v139, v110, v111
    v_lshlrev_b32 v110, 16, v139
    v_and_b32 v111, s40, v139
    v_pk_mul_f32 v[94:95], v[84:85], v[68:69]
    v_cvt_pk_bf16_f32 v139, v94, v95
    v_lshlrev_b32 v94, 16, v139
    v_and_b32 v95, s40, v139
    v_pk_add_f32 v[110:111], v[110:111], v[94:95]
    v_cvt_pk_bf16_f32 v139, v110, v111
    v_lshlrev_b32 v110, 16, v139
    v_and_b32 v111, s40, v139
    v_lshlrev_b32 v96, 16, v42
    v_and_b32 v97, s40, v42
    v_pk_mul_f32 v[110:111], v[110:111], v[96:97]
    v_pk_mul_f32 v[118:119], v[80:81], v[74:75]
    v_cvt_pk_bf16_f32 v138, v118, v119
    v_lshlrev_b32 v118, 16, v138
    v_and_b32 v119, s40, v138
    v_pk_mul_f32 v[90:91], v[82:83], v[72:73]
    v_cvt_pk_bf16_f32 v138, v90, v91
    v_lshlrev_b32 v90, 16, v138
    v_and_b32 v91, s40, v138
    v_pk_add_f32 v[118:119], v[118:119], v[90:91]
    v_cvt_pk_bf16_f32 v138, v118, v119
    v_lshlrev_b32 v118, 16, v138
    v_and_b32 v119, s40, v138
    v_pk_mul_f32 v[90:91], v[84:85], v[70:71]
    v_cvt_pk_bf16_f32 v138, v90, v91
    v_lshlrev_b32 v90, 16, v138
    v_and_b32 v91, s40, v138
    v_pk_add_f32 v[118:119], v[118:119], v[90:91]
    v_cvt_pk_bf16_f32 v138, v118, v119
    v_lshlrev_b32 v118, 16, v138
    v_and_b32 v119, s40, v138
    v_pk_mul_f32 v[90:91], v[86:87], v[68:69]
    v_cvt_pk_bf16_f32 v138, v90, v91
    v_lshlrev_b32 v90, 16, v138
    v_and_b32 v91, s40, v138
    v_pk_add_f32 v[118:119], v[118:119], v[90:91]
    v_cvt_pk_bf16_f32 v138, v118, v119
    v_lshlrev_b32 v118, 16, v138
    v_and_b32 v119, s40, v138
    v_lshlrev_b32 v92, 16, v46
    v_and_b32 v93, s40, v46
    v_pk_mul_f32 v[118:119], v[118:119], v[92:93]
    v_pk_mul_f32 v[126:127], v[82:83], v[74:75]
    v_cvt_pk_bf16_f32 v139, v126, v127
    v_lshlrev_b32 v126, 16, v139
    v_and_b32 v127, s40, v139
    v_pk_mul_f32 v[94:95], v[84:85], v[72:73]
    v_cvt_pk_bf16_f32 v139, v94, v95
    v_lshlrev_b32 v94, 16, v139
    v_and_b32 v95, s40, v139
    v_pk_add_f32 v[126:127], v[126:127], v[94:95]
    v_cvt_pk_bf16_f32 v139, v126, v127
    v_lshlrev_b32 v126, 16, v139
    v_and_b32 v127, s40, v139
    v_pk_mul_f32 v[94:95], v[86:87], v[70:71]
    v_cvt_pk_bf16_f32 v139, v94, v95
    v_lshlrev_b32 v94, 16, v139
    v_and_b32 v95, s40, v139
    v_pk_add_f32 v[126:127], v[126:127], v[94:95]
    v_cvt_pk_bf16_f32 v139, v126, v127
    v_lshlrev_b32 v126, 16, v139
    v_and_b32 v127, s40, v139
    v_pk_mul_f32 v[94:95], v[88:89], v[68:69]
    v_cvt_pk_bf16_f32 v139, v94, v95
    v_lshlrev_b32 v94, 16, v139
    v_and_b32 v95, s40, v139
    v_pk_add_f32 v[126:127], v[126:127], v[94:95]
    v_cvt_pk_bf16_f32 v139, v126, v127
    v_lshlrev_b32 v126, 16, v139
    v_and_b32 v127, s40, v139
    v_lshlrev_b32 v96, 16, v50
    v_and_b32 v97, s40, v50
    v_pk_mul_f32 v[126:127], v[126:127], v[96:97]
    v_lshlrev_b32 v68, 16, v64
    v_and_b32 v70, s40, v64
    v_lshlrev_b32 v72, 16, v65
    v_and_b32 v74, s40, v65
    v_lshlrev_b32 v69, 16, v66
    v_and_b32 v71, s40, v66
    v_lshlrev_b32 v73, 16, v67
    v_and_b32 v75, s40, v67
    v_lshlrev_b32 v76, 16, v11
    v_and_b32 v77, s40, v11
    v_lshlrev_b32 v78, 16, v15
    v_and_b32 v79, s40, v15
    v_lshlrev_b32 v80, 16, v19
    v_and_b32 v81, s40, v19
    v_lshlrev_b32 v82, 16, v23
    v_and_b32 v83, s40, v23
    v_lshlrev_b32 v84, 16, v27
    v_and_b32 v85, s40, v27
    v_lshlrev_b32 v86, 16, v31
    v_and_b32 v87, s40, v31
    v_lshlrev_b32 v88, 16, v35
    v_and_b32 v89, s40, v35
    v_pk_mul_f32 v[104:105], v[76:77], v[74:75]
    v_cvt_pk_bf16_f32 v138, v104, v105
    v_lshlrev_b32 v104, 16, v138
    v_and_b32 v105, s40, v138
    v_pk_mul_f32 v[90:91], v[78:79], v[72:73]
    v_cvt_pk_bf16_f32 v138, v90, v91
    v_lshlrev_b32 v90, 16, v138
    v_and_b32 v91, s40, v138
    v_pk_add_f32 v[104:105], v[104:105], v[90:91]
    v_cvt_pk_bf16_f32 v138, v104, v105
    v_lshlrev_b32 v104, 16, v138
    v_and_b32 v105, s40, v138
    v_pk_mul_f32 v[90:91], v[80:81], v[70:71]
    v_cvt_pk_bf16_f32 v138, v90, v91
    v_lshlrev_b32 v90, 16, v138
    v_and_b32 v91, s40, v138
    v_pk_add_f32 v[104:105], v[104:105], v[90:91]
    v_cvt_pk_bf16_f32 v138, v104, v105
    v_lshlrev_b32 v104, 16, v138
    v_and_b32 v105, s40, v138
    v_pk_mul_f32 v[90:91], v[82:83], v[68:69]
    v_cvt_pk_bf16_f32 v138, v90, v91
    v_lshlrev_b32 v90, 16, v138
    v_and_b32 v91, s40, v138
    v_pk_add_f32 v[104:105], v[104:105], v[90:91]
    v_cvt_pk_bf16_f32 v138, v104, v105
    v_lshlrev_b32 v104, 16, v138
    v_and_b32 v105, s40, v138
    v_lshlrev_b32 v92, 16, v39
    v_and_b32 v93, s40, v39
    v_pk_mul_f32 v[104:105], v[104:105], v[92:93]
    v_pk_mul_f32 v[112:113], v[78:79], v[74:75]
    v_cvt_pk_bf16_f32 v139, v112, v113
    v_lshlrev_b32 v112, 16, v139
    v_and_b32 v113, s40, v139
    v_pk_mul_f32 v[94:95], v[80:81], v[72:73]
    v_cvt_pk_bf16_f32 v139, v94, v95
    v_lshlrev_b32 v94, 16, v139
    v_and_b32 v95, s40, v139
    v_pk_add_f32 v[112:113], v[112:113], v[94:95]
    v_cvt_pk_bf16_f32 v139, v112, v113
    v_lshlrev_b32 v112, 16, v139
    v_and_b32 v113, s40, v139
    v_pk_mul_f32 v[94:95], v[82:83], v[70:71]
    v_cvt_pk_bf16_f32 v139, v94, v95
    v_lshlrev_b32 v94, 16, v139
    v_and_b32 v95, s40, v139
    v_pk_add_f32 v[112:113], v[112:113], v[94:95]
    v_cvt_pk_bf16_f32 v139, v112, v113
    v_lshlrev_b32 v112, 16, v139
    v_and_b32 v113, s40, v139
    v_pk_mul_f32 v[94:95], v[84:85], v[68:69]
    v_cvt_pk_bf16_f32 v139, v94, v95
    v_lshlrev_b32 v94, 16, v139
    v_and_b32 v95, s40, v139
    v_pk_add_f32 v[112:113], v[112:113], v[94:95]
    v_cvt_pk_bf16_f32 v139, v112, v113
    v_lshlrev_b32 v112, 16, v139
    v_and_b32 v113, s40, v139
    v_lshlrev_b32 v96, 16, v43
    v_and_b32 v97, s40, v43
    v_pk_mul_f32 v[112:113], v[112:113], v[96:97]
    v_pk_mul_f32 v[120:121], v[80:81], v[74:75]
    v_cvt_pk_bf16_f32 v138, v120, v121
    v_lshlrev_b32 v120, 16, v138
    v_and_b32 v121, s40, v138
    v_pk_mul_f32 v[90:91], v[82:83], v[72:73]
    v_cvt_pk_bf16_f32 v138, v90, v91
    v_lshlrev_b32 v90, 16, v138
    v_and_b32 v91, s40, v138
    v_pk_add_f32 v[120:121], v[120:121], v[90:91]
    v_cvt_pk_bf16_f32 v138, v120, v121
    v_lshlrev_b32 v120, 16, v138
    v_and_b32 v121, s40, v138
    v_pk_mul_f32 v[90:91], v[84:85], v[70:71]
    v_cvt_pk_bf16_f32 v138, v90, v91
    v_lshlrev_b32 v90, 16, v138
    v_and_b32 v91, s40, v138
    v_pk_add_f32 v[120:121], v[120:121], v[90:91]
    v_cvt_pk_bf16_f32 v138, v120, v121
    v_lshlrev_b32 v120, 16, v138
    v_and_b32 v121, s40, v138
    v_pk_mul_f32 v[90:91], v[86:87], v[68:69]
    v_cvt_pk_bf16_f32 v138, v90, v91
    v_lshlrev_b32 v90, 16, v138
    v_and_b32 v91, s40, v138
    v_pk_add_f32 v[120:121], v[120:121], v[90:91]
    v_cvt_pk_bf16_f32 v138, v120, v121
    v_lshlrev_b32 v120, 16, v138
    v_and_b32 v121, s40, v138
    v_lshlrev_b32 v92, 16, v47
    v_and_b32 v93, s40, v47
    v_pk_mul_f32 v[120:121], v[120:121], v[92:93]
    v_pk_mul_f32 v[128:129], v[82:83], v[74:75]
    v_cvt_pk_bf16_f32 v139, v128, v129
    v_lshlrev_b32 v128, 16, v139
    v_and_b32 v129, s40, v139
    v_pk_mul_f32 v[94:95], v[84:85], v[72:73]
    v_cvt_pk_bf16_f32 v139, v94, v95
    v_lshlrev_b32 v94, 16, v139
    v_and_b32 v95, s40, v139
    v_pk_add_f32 v[128:129], v[128:129], v[94:95]
    v_cvt_pk_bf16_f32 v139, v128, v129
    v_lshlrev_b32 v128, 16, v139
    v_and_b32 v129, s40, v139
    v_pk_mul_f32 v[94:95], v[86:87], v[70:71]
    v_cvt_pk_bf16_f32 v139, v94, v95
    v_lshlrev_b32 v94, 16, v139
    v_and_b32 v95, s40, v139
    v_pk_add_f32 v[128:129], v[128:129], v[94:95]
    v_cvt_pk_bf16_f32 v139, v128, v129
    v_lshlrev_b32 v128, 16, v139
    v_and_b32 v129, s40, v139
    v_pk_mul_f32 v[94:95], v[88:89], v[68:69]
    v_cvt_pk_bf16_f32 v139, v94, v95
    v_lshlrev_b32 v94, 16, v139
    v_and_b32 v95, s40, v139
    v_pk_add_f32 v[128:129], v[128:129], v[94:95]
    v_cvt_pk_bf16_f32 v139, v128, v129
    v_lshlrev_b32 v128, 16, v139
    v_and_b32 v129, s40, v139
    v_lshlrev_b32 v96, 16, v51
    v_and_b32 v97, s40, v51
    v_pk_mul_f32 v[128:129], v[128:129], v[96:97]
    v_mul_u32_u24 v4, 1152, v130
    v_lshlrev_b32 v6, 3, v131
    v_sub_u32 v4, v4, v6
    v_add_u32 v4, 70776, v4
    v_cvt_pk_bf16_f32 v8, v122, v114
    v_cvt_pk_bf16_f32 v9, v106, v98
    ds_write_b64 v4, v[8:9] offset:0
    v_cvt_pk_bf16_f32 v10, v123, v115
    v_cvt_pk_bf16_f32 v11, v107, v99
    ds_write_b64 v4, v[10:11] offset:144
    v_cvt_pk_bf16_f32 v12, v124, v116
    v_cvt_pk_bf16_f32 v13, v108, v100
    ds_write_b64 v4, v[12:13] offset:288
    v_cvt_pk_bf16_f32 v14, v125, v117
    v_cvt_pk_bf16_f32 v15, v109, v101
    ds_write_b64 v4, v[14:15] offset:432
    v_cvt_pk_bf16_f32 v16, v126, v118
    v_cvt_pk_bf16_f32 v17, v110, v102
    ds_write_b64 v4, v[16:17] offset:576
    v_cvt_pk_bf16_f32 v18, v127, v119
    v_cvt_pk_bf16_f32 v19, v111, v103
    ds_write_b64 v4, v[18:19] offset:720
    v_cvt_pk_bf16_f32 v20, v128, v120
    v_cvt_pk_bf16_f32 v21, v112, v104
    ds_write_b64 v4, v[20:21] offset:864
    v_cvt_pk_bf16_f32 v22, v129, v121
    v_cvt_pk_bf16_f32 v23, v113, v105
    ds_write_b64 v4, v[22:23] offset:1008
    s_waitcnt lgkmcnt(0)
    v_mov_b32 v6, 113668
    v_mov_b32 v7, 1
    s_mov_b64 exec, 1
    ds_add_u32 v6, v7
    s_mov_b64 exec, -1
    s_mov_b32 s18, 1600000
Lls_5:
    ds_read_b32 v7, v6
    s_waitcnt lgkmcnt(0)
    v_readfirstlane_b32 s19, v7
    s_nop 3
    s_cmp_ge_u32 s19, 4
    s_cbranch_scc1 Llsd_6
    s_sub_u32 s18, s18, 1
    s_cmp_lg_u32 s18, 0
    s_cbranch_scc1 Lls_5
Llsd_6:
    v_lshrrev_b32 v4, 3, v0
    v_and_b32 v3, 7, v0
    v_mul_u32_u24 v6, 144, v4
    v_lshl_add_u32 v6, v3, 4, v6
    v_add_u32 v6, 70656, v6
    v_mul_u32_u24 v7, 5120, v4
    v_lshl_add_u32 v7, v3, 4, v7
    s_mul_i32 s18, s41, 655360
    s_sub_u32 s19, 31, s42
    s_mul_i32 s19, s19, 160
    s_add_u32 s18, s18, s19
    v_add_u32 v7, s18, v7
    ds_read_b128 v[8:11], v6 offset:0
    ds_read_b128 v[12:15], v6 offset:4608
    ds_read_b128 v[16:19], v6 offset:9216
    ds_read_b128 v[20:23], v6 offset:13824
    s_waitcnt lgkmcnt(3)
    s_mov_b32 s18, 0
    buffer_store_dwordx4 v[8:11], v7, s[20:23], s18 offen sc1
    s_waitcnt lgkmcnt(2)
    s_mov_b32 s18, 163840
    buffer_store_dwordx4 v[12:15], v7, s[20:23], s18 offen sc1
    s_waitcnt lgkmcnt(1)
    s_mov_b32 s18, 327680
    buffer_store_dwordx4 v[16:19], v7, s[20:23], s18 offen sc1
    s_waitcnt lgkmcnt(0)
    s_mov_b32 s18, 491520
    buffer_store_dwordx4 v[20:23], v7, s[20:23], s18 offen sc1
    s_waitcnt vmcnt(0)
    v_readfirstlane_b32 s93, v137
    s_nop 3
    s_cmp_lg_u32 s93, 0
    s_cbranch_scc1 Lgot_7
    s_mov_b32 s55, 200000
    v_mov_b32 v24, 0
Lnr_8:
    buffer_load_dword v25, v24, s[72:75], 0 offen sc1
    s_waitcnt vmcnt(0)
    v_readfirstlane_b32 s93, v25
    s_nop 3
    s_cmp_lg_u32 s93, 0
    s_cbranch_scc1 Lnd_9
    s_sub_u32 s55, s55, 1
    s_cmp_lg_u32 s55, 0
    s_sleep 1
    s_cbranch_scc1 Lnr_8
Lnd_9:
Lgot_7:
    v_mov_b32 v6, 113672
    v_mov_b32 v7, 1
    s_mov_b64 exec, 1
    ds_add_u32 v6, v7
    s_mov_b64 exec, -1
    s_mov_b32 s18, 1600000
Lls_10:
    ds_read_b32 v7, v6
    s_waitcnt lgkmcnt(0)
    v_readfirstlane_b32 s19, v7
    s_nop 3
    s_cmp_ge_u32 s19, 4
    s_cbranch_scc1 Llsd_11
    s_sub_u32 s18, s18, 1
    s_cmp_lg_u32 s18, 0
    s_cbranch_scc1 Lls_10
Llsd_11:
    s_cmp_lg_u32 s16, 0
    s_cbranch_scc1 Lp1_12
    s_lshl_b32 s38, s2, 7
    s_add_u32 s39, s93, 1
    v_mov_b32 v24, s38
    v_mov_b32 v25, s39
    s_mov_b64 exec, 1
    buffer_store_dword v25, v24, s[32:35], 0 offen sc1
    s_mov_b64 exec, -1
Lp1_12:
    s_mul_i32 s18, s16, 17664
    v_add_u32 v6, s18, v5
    v_accvgpr_read_b32 v40, a0
    v_accvgpr_read_b32 v41, a1
    v_accvgpr_read_b32 v42, a2
    v_accvgpr_read_b32 v43, a3
    v_accvgpr_read_b32 v44, a4
    v_accvgpr_read_b32 v45, a5
    v_accvgpr_read_b32 v46, a6
    v_accvgpr_read_b32 v47, a7
    v_accvgpr_read_b32 v48, a8
    v_accvgpr_read_b32 v49, a9
    v_accvgpr_read_b32 v50, a10
    v_accvgpr_read_b32 v51, a11
    v_alignbit_b32 v52, v44, v40, 16
    v_alignbit_b32 v56, v48, v44, 16
    v_alignbit_b32 v53, v45, v41, 16
    v_alignbit_b32 v57, v49, v45, 16
    v_alignbit_b32 v54, v46, v42, 16
    v_alignbit_b32 v58, v50, v46, 16
    v_alignbit_b32 v55, v47, v43, 16
    v_alignbit_b32 v59, v51, v47, 16
    ds_write_b128 v6, v[40:43] offset:128
    ds_write_b128 v6, v[52:55] offset:4544
    ds_write_b128 v6, v[44:47] offset:8960
    ds_write_b128 v6, v[56:59] offset:13376
    v_accvgpr_read_b32 v64, a12
    v_accvgpr_read_b32 v65, a13
    v_accvgpr_read_b32 v66, a14
    v_accvgpr_read_b32 v67, a15
    v_accvgpr_read_b32 v68, a16
    v_accvgpr_read_b32 v69, a17
    v_accvgpr_read_b32 v70, a18
    v_accvgpr_read_b32 v71, a19
    v_accvgpr_read_b32 v72, a20
    v_accvgpr_read_b32 v73, a21
    v_accvgpr_read_b32 v74, a22
    v_accvgpr_read_b32 v75, a23
    v_alignbit_b32 v76, v68, v64, 16
    v_alignbit_b32 v80, v72, v68, 16
    v_alignbit_b32 v77, v69, v65, 16
    v_alignbit_b32 v81, v73, v69, 16
    v_alignbit_b32 v78, v70, v66, 16
    v_alignbit_b32 v82, v74, v70, 16
    v_alignbit_b32 v79, v71, v67, 16
    v_alignbit_b32 v83, v75, v71, 16
    ds_write_b128 v6, v[64:67] offset:1152
    ds_write_b128 v6, v[76:79] offset:5568
    ds_write_b128 v6, v[68:71] offset:9984
    ds_write_b128 v6, v[80:83] offset:14400
    v_accvgpr_read_b32 v40, a24
    v_accvgpr_read_b32 v41, a25
    v_accvgpr_read_b32 v42, a26
    v_accvgpr_read_b32 v43, a27
    v_accvgpr_read_b32 v44, a28
    v_accvgpr_read_b32 v45, a29
    v_accvgpr_read_b32 v46, a30
    v_accvgpr_read_b32 v47, a31
    v_accvgpr_read_b32 v48, a32
    v_accvgpr_read_b32 v49, a33
    v_accvgpr_read_b32 v50, a34
    v_accvgpr_read_b32 v51, a35
    v_alignbit_b32 v52, v44, v40, 16
    v_alignbit_b32 v56, v48, v44, 16
    v_alignbit_b32 v53, v45, v41, 16
    v_alignbit_b32 v57, v49, v45, 16
    v_alignbit_b32 v54, v46, v42, 16
    v_alignbit_b32 v58, v50, v46, 16
    v_alignbit_b32 v55, v47, v43, 16
    v_alignbit_b32 v59, v51, v47, 16
    ds_write_b128 v6, v[40:43] offset:2176
    ds_write_b128 v6, v[52:55] offset:6592
    ds_write_b128 v6, v[44:47] offset:11008
    ds_write_b128 v6, v[56:59] offset:15424
    v_accvgpr_read_b32 v64, a36
    v_accvgpr_read_b32 v65, a37
    v_accvgpr_read_b32 v66, a38
    v_accvgpr_read_b32 v67, a39
    v_accvgpr_read_b32 v68, a40
    v_accvgpr_read_b32 v69, a41
    v_accvgpr_read_b32 v70, a42
    v_accvgpr_read_b32 v71, a43
    v_accvgpr_read_b32 v72, a44
    v_accvgpr_read_b32 v73, a45
    v_accvgpr_read_b32 v74, a46
    v_accvgpr_read_b32 v75, a47
    v_alignbit_b32 v76, v68, v64, 16
    v_alignbit_b32 v80, v72, v68, 16
    v_alignbit_b32 v77, v69, v65, 16
    v_alignbit_b32 v81, v73, v69, 16
    v_alignbit_b32 v78, v70, v66, 16
    v_alignbit_b32 v82, v74, v70, 16
    v_alignbit_b32 v79, v71, v67, 16
    v_alignbit_b32 v83, v75, v71, 16
    ds_write_b128 v6, v[64:67] offset:3200
    ds_write_b128 v6, v[76:79] offset:7616
    ds_write_b128 v6, v[68:71] offset:12032
    ds_write_b128 v6, v[80:83] offset:16448
    v_mov_b32 v96, 0
    v_mov_b32 v97, 0
    v_mov_b32 v98, 0
    v_mov_b32 v99, 0
    v_mov_b32 v100, 0
    v_mov_b32 v101, 0
    v_mov_b32 v102, 0
    v_mov_b32 v103, 0
    v_mov_b32 v104, 0
    v_mov_b32 v105, 0
    v_mov_b32 v106, 0
    v_mov_b32 v107, 0
    v_mov_b32 v108, 0
    v_mov_b32 v109, 0
    v_mov_b32 v110, 0
    v_mov_b32 v111, 0
    v_cmp_eq_u32 vcc, 7, v2
    v_lshlrev_b32 v116, 16, v132
    v_alignbit_b32 v117, v133, v132, 16
    v_cndmask_b32 v103, 0, v116, vcc
    v_cndmask_b32 v107, 0, v132, vcc
    v_cndmask_b32 v110, 0, v116, vcc
    v_cndmask_b32 v111, 0, v117, vcc
    v_cmp_gt_u32 vcc, 8, v2
    s_and_saveexec_b64 s[38:39], vcc
    ds_write_b128 v6, v[96:99] offset:0
    ds_write_b128 v6, v[100:103] offset:4416
    ds_write_b128 v6, v[104:107] offset:8832
    ds_write_b128 v6, v[108:111] offset:13248
    s_mov_b64 exec, s[38:39]
    s_mul_i32 s18, s16, 8192
    s_add_u32 s18, s18, 70656
    v_add_u32 v7, s18, v5
    ds_write_b128 v7, v[96:99] offset:5120
    ds_write_b128 v7, v[96:99] offset:6144
    ds_write_b128 v7, v[96:99] offset:7168
    v_and_b32 v134, 15, v2
    v_lshrrev_b32 v135, 4, v2
    v_add_u32 v1, 1, v134
    v_and_b32 v1, 3, v1
    v_mul_u32_u24 v3, 4414, v1
    v_lshl_add_u32 v3, v134, 1, v3
    v_lshl_add_u32 v3, v135, 4, v3
    s_mul_i32 s18, s16, 17664
    s_add_u32 s18, s18, 2
    v_add_u32 v3, s18, v3
    v_sub_u32 v1, 15, v134
    v_mul_u32_u24 v4, 160, v1
    v_lshl_add_u32 v4, v135, 4, v4
    s_mul_i32 s18, s16, 8192
    s_add_u32 s18, s18, 70656
    v_add_u32 v4, s18, v4
    v_mov_b32 v120, v134
    v_mov_b32 v121, v135
    v_and_b32 v1, 31, v2
    v_lshlrev_b32 v1, 3, v1
    v_add_u32 v1, s41, v1
    v_lshlrev_b32 v1, 7, v1
    s_mov_b32 s55, 200000
    s_add_u32 s38, s93, 1
Lpoll_13:
    buffer_load_dword v6, v1, s[32:35], 0 offen sc1
    s_waitcnt vmcnt(0)
    v_subrev_u32 v6, s38, v6
    v_cmp_gt_u32 vcc, 7, v6
    s_nop 1
    s_cmp_eq_u64 vcc, -1
    s_cbranch_scc1 Lpd_14
    s_sub_u32 s55, s55, 1
    s_cmp_lg_u32 s55, 0
    s_sleep 1
    s_cbranch_scc1 Lpoll_13
Lpd_14:
    s_add_u32 s18, s17, s16
    s_mul_i32 s18, s18, 5120
    s_add_u32 s19, s18, 0
    buffer_load_dwordx4 v[56:59], v5, s[20:23], s19 offen sc1
    s_add_u32 s19, s18, 1024
    buffer_load_dwordx4 v[60:63], v5, s[20:23], s19 offen sc1
    s_add_u32 s19, s18, 2048
    buffer_load_dwordx4 v[64:67], v5, s[20:23], s19 offen sc1
    s_add_u32 s19, s18, 3072
    buffer_load_dwordx4 v[68:71], v5, s[20:23], s19 offen sc1
    s_add_u32 s19, s18, 4096
    buffer_load_dwordx4 v[72:75], v5, s[20:23], s19 offen sc1
    s_load_dwordx2 s[80:81], s[0:1], 0
    s_lshl_b32 s82, s92, 4
    s_add_u32 s82, s82, s3
    s_lshl_b32 s82, s82, 3
    s_add_u32 s82, s82, s16
    s_lshl_b32 s82, s82, 11
    v_lshlrev_b32 v136, 4, v2
    v_add_u32 v136, s82, v136
    s_waitcnt lgkmcnt(0)
    s_and_b32 s81, s81, 0xffff
    s_mov_b32 s82, 4194304
    s_mov_b32 s83, 0x00020000
    buffer_load_dwordx4 v[128:131], v136, s[80:83], 0 offen offset:0 nt
    buffer_load_dwordx4 v[132:135], v136, s[80:83], 0 offen offset:1024 nt
    v_mov_b32 v8, 0
    v_mov_b32 v9, 0
    v_mov_b32 v10, 0
    v_mov_b32 v11, 0
    v_mov_b32 v12, 0
    v_mov_b32 v13, 0
    v_mov_b32 v14, 0
    v_mov_b32 v15, 0
    v_mov_b32 v16, 0
    v_mov_b32 v17, 0
    v_mov_b32 v18, 0
    v_mov_b32 v19, 0
    v_mov_b32 v20, 0
    v_mov_b32 v21, 0
    v_mov_b32 v22, 0
    v_mov_b32 v23, 0
    v_mov_b32 v24, 0
    v_mov_b32 v25, 0
    v_mov_b32 v26, 0
    v_mov_b32 v27, 0
    v_mov_b32 v28, 0
    v_mov_b32 v29, 0
    v_mov_b32 v30, 0
    v_mov_b32 v31, 0
    v_mov_b32 v32, 0
    v_mov_b32 v33, 0
    v_mov_b32 v34, 0
    v_mov_b32 v35, 0
    v_mov_b32 v36, 0
    v_mov_b32 v37, 0
    v_mov_b32 v38, 0
    v_mov_b32 v39, 0
    s_waitcnt vmcnt(6)
    ds_write_b128 v7, v[56:59] offset:0
    s_waitcnt vmcnt(5)
    ds_write_b128 v7, v[60:63] offset:1024
    s_waitcnt vmcnt(4)
    ds_write_b128 v7, v[64:67] offset:2048
    s_waitcnt vmcnt(3)
    ds_write_b128 v7, v[68:71] offset:3072
    s_waitcnt vmcnt(2)
    ds_write_b128 v7, v[72:75] offset:4096
    s_waitcnt lgkmcnt(0)
    ds_read_b128 a[80:83], v4 offset:64
    ds_read_b128 a[84:87], v4 offset:0
    ds_read_b128 a[88:91], v4 offset:2624
    ds_read_b128 a[92:95], v4 offset:2560
    ds_read_b64 a[0:1], v3 offset:0
    ds_read_b64 a[2:3], v3 offset:8
    ds_read_b64 a[4:5], v3 offset:32
    ds_read_b64 a[6:7], v3 offset:40
    ds_read_b64 a[8:9], v3 offset:64
    ds_read_b64 a[10:11], v3 offset:72
    ds_read_b64 a[12:13], v3 offset:96
    ds_read_b64 a[14:15], v3 offset:104
    ds_read_b64 a[16:17], v3 offset:128
    ds_read_b64 a[18:19], v3 offset:136
    ds_read_b64 a[20:21], v3 offset:160
    ds_read_b64 a[22:23], v3 offset:168
    ds_read_b64 a[56:57], v3 offset:2048
    ds_read_b64 a[58:59], v3 offset:2056
    ds_read_b64 a[60:61], v3 offset:2080
    ds_read_b64 a[62:63], v3 offset:2088
    ds_read_b64 a[64:65], v3 offset:2112
    ds_read_b64 a[66:67], v3 offset:2120
    ds_read_b64 a[68:69], v3 offset:2144
    ds_read_b64 a[70:71], v3 offset:2152
    ds_read_b64 a[72:73], v3 offset:2176
    ds_read_b64 a[74:75], v3 offset:2184
    ds_read_b64 a[76:77], v3 offset:2208
    ds_read_b64 a[78:79], v3 offset:2216
    s_waitcnt lgkmcnt(0)
    v_mfma_f32_16x16x32_bf16 v[12:15], a[8:11], a[80:83], v[12:15]
    ds_read_b128 a[96:99], v4 offset:224
    v_mfma_f32_16x16x32_bf16 v[8:11], a[8:11], a[88:91], v[8:11]
    ds_read_b128 a[100:103], v4 offset:160
    v_mfma_f32_16x16x32_bf16 v[12:15], a[64:67], a[88:91], v[12:15]
    ds_read_b128 a[104:107], v4 offset:2784
    v_mfma_f32_16x16x32_bf16 v[20:23], a[12:15], a[80:83], v[20:23]
    ds_read_b128 a[108:111], v4 offset:2720
    v_mfma_f32_16x16x32_bf16 v[16:19], a[12:15], a[88:91], v[16:19]
    ds_read_b64 a[24:25], v3 offset:192
    v_mfma_f32_16x16x32_bf16 v[20:23], a[68:71], a[88:91], v[20:23]
    ds_read_b64 a[26:27], v3 offset:200
    v_mfma_f32_16x16x32_bf16 v[28:31], a[16:19], a[80:83], v[28:31]
    ds_read_b64 a[28:29], v3 offset:224
    v_mfma_f32_16x16x32_bf16 v[24:27], a[16:19], a[88:91], v[24:27]
    ds_read_b64 a[30:31], v3 offset:232
    v_mfma_f32_16x16x32_bf16 v[28:31], a[72:75], a[88:91], v[28:31]
    ds_read_b64 a[32:33], v3 offset:256
    v_mfma_f32_16x16x32_bf16 v[36:39], a[20:23], a[80:83], v[36:39]
    ds_read_b64 a[34:35], v3 offset:264
    v_mfma_f32_16x16x32_bf16 v[32:35], a[20:23], a[88:91], v[32:35]
    ds_read_b64 a[36:37], v3 offset:288
    v_mfma_f32_16x16x32_bf16 v[36:39], a[76:79], a[88:91], v[36:39]
    ds_read_b64 a[38:39], v3 offset:296
    v_mfma_f32_16x16x32_bf16 v[12:15], a[0:3], a[84:87], v[12:15]
    ds_read_b64 a[40:41], v3 offset:2240
    v_mfma_f32_16x16x32_bf16 v[8:11], a[0:3], a[92:95], v[8:11]
    ds_read_b64 a[42:43], v3 offset:2248
    v_mfma_f32_16x16x32_bf16 v[12:15], a[56:59], a[92:95], v[12:15]
    ds_read_b64 a[44:45], v3 offset:2272
    v_mfma_f32_16x16x32_bf16 v[20:23], a[4:7], a[84:87], v[20:23]
    ds_read_b64 a[46:47], v3 offset:2280
    v_mfma_f32_16x16x32_bf16 v[16:19], a[4:7], a[92:95], v[16:19]
    ds_read_b64 a[48:49], v3 offset:2304
    v_mfma_f32_16x16x32_bf16 v[20:23], a[60:63], a[92:95], v[20:23]
    ds_read_b64 a[50:51], v3 offset:2312
    v_mfma_f32_16x16x32_bf16 v[28:31], a[8:11], a[84:87], v[28:31]
    ds_read_b64 a[52:53], v3 offset:2336
    v_mfma_f32_16x16x32_bf16 v[24:27], a[8:11], a[92:95], v[24:27]
    ds_read_b64 a[54:55], v3 offset:2344
    v_mfma_f32_16x16x32_bf16 v[28:31], a[64:67], a[92:95], v[28:31]
    v_mfma_f32_16x16x32_bf16 v[36:39], a[12:15], a[84:87], v[36:39]
    v_mfma_f32_16x16x32_bf16 v[32:35], a[12:15], a[92:95], v[32:35]
    v_mfma_f32_16x16x32_bf16 v[36:39], a[68:71], a[92:95], v[36:39]
    s_waitcnt lgkmcnt(0)
    v_mfma_f32_16x16x32_bf16 v[12:15], a[24:27], a[96:99], v[12:15]
    ds_read_b128 a[80:83], v4 offset:384
    v_mfma_f32_16x16x32_bf16 v[8:11], a[24:27], a[104:107], v[8:11]
    ds_read_b128 a[84:87], v4 offset:320
    v_mfma_f32_16x16x32_bf16 v[12:15], a[40:43], a[104:107], v[12:15]
    ds_read_b128 a[88:91], v4 offset:2944
    v_mfma_f32_16x16x32_bf16 v[20:23], a[28:31], a[96:99], v[20:23]
    ds_read_b128 a[92:95], v4 offset:2880
    v_mfma_f32_16x16x32_bf16 v[16:19], a[28:31], a[104:107], v[16:19]
    ds_read_b64 a[0:1], v3 offset:320
    v_mfma_f32_16x16x32_bf16 v[20:23], a[44:47], a[104:107], v[20:23]
    ds_read_b64 a[2:3], v3 offset:328
    v_mfma_f32_16x16x32_bf16 v[28:31], a[32:35], a[96:99], v[28:31]
    ds_read_b64 a[4:5], v3 offset:352
    v_mfma_f32_16x16x32_bf16 v[24:27], a[32:35], a[104:107], v[24:27]
    ds_read_b64 a[6:7], v3 offset:360
    v_mfma_f32_16x16x32_bf16 v[28:31], a[48:51], a[104:107], v[28:31]
    ds_read_b64 a[8:9], v3 offset:384
    v_mfma_f32_16x16x32_bf16 v[36:39], a[36:39], a[96:99], v[36:39]
    ds_read_b64 a[10:11], v3 offset:392
    v_mfma_f32_16x16x32_bf16 v[32:35], a[36:39], a[104:107], v[32:35]
    ds_read_b64 a[12:13], v3 offset:416
    v_mfma_f32_16x16x32_bf16 v[36:39], a[52:55], a[104:107], v[36:39]
    ds_read_b64 a[14:15], v3 offset:424
    v_mfma_f32_16x16x32_bf16 v[12:15], a[16:19], a[100:103], v[12:15]
    ds_read_b64 a[56:57], v3 offset:2368
    v_mfma_f32_16x16x32_bf16 v[8:11], a[16:19], a[108:111], v[8:11]
    ds_read_b64 a[58:59], v3 offset:2376
    v_mfma_f32_16x16x32_bf16 v[12:15], a[72:75], a[108:111], v[12:15]
    ds_read_b64 a[60:61], v3 offset:2400
    v_mfma_f32_16x16x32_bf16 v[20:23], a[20:23], a[100:103], v[20:23]
    ds_read_b64 a[62:63], v3 offset:2408
    v_mfma_f32_16x16x32_bf16 v[16:19], a[20:23], a[108:111], v[16:19]
    ds_read_b64 a[64:65], v3 offset:2432
    v_mfma_f32_16x16x32_bf16 v[20:23], a[76:79], a[108:111], v[20:23]
    ds_read_b64 a[66:67], v3 offset:2440
    v_mfma_f32_16x16x32_bf16 v[28:31], a[24:27], a[100:103], v[28:31]
    ds_read_b64 a[68:69], v3 offset:2464
    v_mfma_f32_16x16x32_bf16 v[24:27], a[24:27], a[108:111], v[24:27]
    ds_read_b64 a[70:71], v3 offset:2472
    v_mfma_f32_16x16x32_bf16 v[28:31], a[40:43], a[108:111], v[28:31]
    v_mfma_f32_16x16x32_bf16 v[36:39], a[28:31], a[100:103], v[36:39]
    v_mfma_f32_16x16x32_bf16 v[32:35], a[28:31], a[108:111], v[32:35]
    v_mfma_f32_16x16x32_bf16 v[36:39], a[44:47], a[108:111], v[36:39]
    s_waitcnt lgkmcnt(0)
    v_mfma_f32_16x16x32_bf16 v[12:15], a[0:3], a[80:83], v[12:15]
    ds_read_b128 a[96:99], v4 offset:544
    v_mfma_f32_16x16x32_bf16 v[8:11], a[0:3], a[88:91], v[8:11]
    ds_read_b128 a[100:103], v4 offset:480
    v_mfma_f32_16x16x32_bf16 v[12:15], a[56:59], a[88:91], v[12:15]
    ds_read_b128 a[104:107], v4 offset:3104
    v_mfma_f32_16x16x32_bf16 v[20:23], a[4:7], a[80:83], v[20:23]
    ds_read_b128 a[108:111], v4 offset:3040
    v_mfma_f32_16x16x32_bf16 v[16:19], a[4:7], a[88:91], v[16:19]
    ds_read_b64 a[16:17], v3 offset:448
    v_mfma_f32_16x16x32_bf16 v[20:23], a[60:63], a[88:91], v[20:23]
    ds_read_b64 a[18:19], v3 offset:456
    v_mfma_f32_16x16x32_bf16 v[28:31], a[8:11], a[80:83], v[28:31]
    ds_read_b64 a[20:21], v3 offset:480
    v_mfma_f32_16x16x32_bf16 v[24:27], a[8:11], a[88:91], v[24:27]
    ds_read_b64 a[22:23], v3 offset:488
    v_mfma_f32_16x16x32_bf16 v[28:31], a[64:67], a[88:91], v[28:31]
    ds_read_b64 a[24:25], v3 offset:512
    v_mfma_f32_16x16x32_bf16 v[36:39], a[12:15], a[80:83], v[36:39]
    ds_read_b64 a[26:27], v3 offset:520
    v_mfma_f32_16x16x32_bf16 v[32:35], a[12:15], a[88:91], v[32:35]
    ds_read_b64 a[28:29], v3 offset:544
    v_mfma_f32_16x16x32_bf16 v[36:39], a[68:71], a[88:91], v[36:39]
    ds_read_b64 a[30:31], v3 offset:552
    v_mfma_f32_16x16x32_bf16 v[12:15], a[32:35], a[84:87], v[12:15]
    ds_read_b64 a[72:73], v3 offset:2496
    v_mfma_f32_16x16x32_bf16 v[8:11], a[32:35], a[92:95], v[8:11]
    ds_read_b64 a[74:75], v3 offset:2504
    v_mfma_f32_16x16x32_bf16 v[12:15], a[48:51], a[92:95], v[12:15]
    ds_read_b64 a[76:77], v3 offset:2528
    v_mfma_f32_16x16x32_bf16 v[20:23], a[36:39], a[84:87], v[20:23]
    ds_read_b64 a[78:79], v3 offset:2536
    v_mfma_f32_16x16x32_bf16 v[16:19], a[36:39], a[92:95], v[16:19]
    ds_read_b64 a[40:41], v3 offset:2560
    v_mfma_f32_16x16x32_bf16 v[20:23], a[52:55], a[92:95], v[20:23]
    ds_read_b64 a[42:43], v3 offset:2568
    v_mfma_f32_16x16x32_bf16 v[28:31], a[0:3], a[84:87], v[28:31]
    ds_read_b64 a[44:45], v3 offset:2592
    v_mfma_f32_16x16x32_bf16 v[24:27], a[0:3], a[92:95], v[24:27]
    ds_read_b64 a[46:47], v3 offset:2600
    v_mfma_f32_16x16x32_bf16 v[28:31], a[56:59], a[92:95], v[28:31]
    v_mfma_f32_16x16x32_bf16 v[36:39], a[4:7], a[84:87], v[36:39]
    v_mfma_f32_16x16x32_bf16 v[32:35], a[4:7], a[92:95], v[32:35]
    v_mfma_f32_16x16x32_bf16 v[36:39], a[60:63], a[92:95], v[36:39]
    s_waitcnt lgkmcnt(0)
    v_mfma_f32_16x16x32_bf16 v[12:15], a[16:19], a[96:99], v[12:15]
    ds_read_b128 a[80:83], v4 offset:704
    v_mfma_f32_16x16x32_bf16 v[8:11], a[16:19], a[104:107], v[8:11]
    ds_read_b128 a[84:87], v4 offset:640
    v_mfma_f32_16x16x32_bf16 v[12:15], a[72:75], a[104:107], v[12:15]
    ds_read_b128 a[88:91], v4 offset:3264
    v_mfma_f32_16x16x32_bf16 v[20:23], a[20:23], a[96:99], v[20:23]
    ds_read_b128 a[92:95], v4 offset:3200
    v_mfma_f32_16x16x32_bf16 v[16:19], a[20:23], a[104:107], v[16:19]
    ds_read_b64 a[32:33], v3 offset:576
    v_mfma_f32_16x16x32_bf16 v[20:23], a[76:79], a[104:107], v[20:23]
    ds_read_b64 a[34:35], v3 offset:584
    v_mfma_f32_16x16x32_bf16 v[28:31], a[24:27], a[96:99], v[28:31]
    ds_read_b64 a[36:37], v3 offset:608
    v_mfma_f32_16x16x32_bf16 v[24:27], a[24:27], a[104:107], v[24:27]
    ds_read_b64 a[38:39], v3 offset:616
    v_mfma_f32_16x16x32_bf16 v[28:31], a[40:43], a[104:107], v[28:31]
    ds_read_b64 a[0:1], v3 offset:640
    v_mfma_f32_16x16x32_bf16 v[36:39], a[28:31], a[96:99], v[36:39]
    ds_read_b64 a[2:3], v3 offset:648
    v_mfma_f32_16x16x32_bf16 v[32:35], a[28:31], a[104:107], v[32:35]
    ds_read_b64 a[4:5], v3 offset:672
    v_mfma_f32_16x16x32_bf16 v[36:39], a[44:47], a[104:107], v[36:39]
    ds_read_b64 a[6:7], v3 offset:680
    v_mfma_f32_16x16x32_bf16 v[12:15], a[8:11], a[100:103], v[12:15]
    ds_read_b64 a[48:49], v3 offset:2624
    v_mfma_f32_16x16x32_bf16 v[8:11], a[8:11], a[108:111], v[8:11]
    ds_read_b64 a[50:51], v3 offset:2632
    v_mfma_f32_16x16x32_bf16 v[12:15], a[64:67], a[108:111], v[12:15]
    ds_read_b64 a[52:53], v3 offset:2656
    v_mfma_f32_16x16x32_bf16 v[20:23], a[12:15], a[100:103], v[20:23]
    ds_read_b64 a[54:55], v3 offset:2664
    v_mfma_f32_16x16x32_bf16 v[16:19], a[12:15], a[108:111], v[16:19]
    ds_read_b64 a[56:57], v3 offset:2688
    v_mfma_f32_16x16x32_bf16 v[20:23], a[68:71], a[108:111], v[20:23]
    ds_read_b64 a[58:59], v3 offset:2696
    v_mfma_f32_16x16x32_bf16 v[28:31], a[16:19], a[100:103], v[28:31]
    ds_read_b64 a[60:61], v3 offset:2720
    v_mfma_f32_16x16x32_bf16 v[24:27], a[16:19], a[108:111], v[24:27]
    ds_read_b64 a[62:63], v3 offset:2728
    v_mfma_f32_16x16x32_bf16 v[28:31], a[72:75], a[108:111], v[28:31]
    v_mfma_f32_16x16x32_bf16 v[36:39], a[20:23], a[100:103], v[36:39]
    v_mfma_f32_16x16x32_bf16 v[32:35], a[20:23], a[108:111], v[32:35]
    v_mfma_f32_16x16x32_bf16 v[36:39], a[76:79], a[108:111], v[36:39]
    s_waitcnt lgkmcnt(0)
    v_mfma_f32_16x16x32_bf16 v[12:15], a[32:35], a[80:83], v[12:15]
    ds_read_b128 a[96:99], v4 offset:864
    v_mfma_f32_16x16x32_bf16 v[8:11], a[32:35], a[88:91], v[8:11]
    ds_read_b128 a[100:103], v4 offset:800
    v_mfma_f32_16x16x32_bf16 v[12:15], a[48:51], a[88:91], v[12:15]
    ds_read_b128 a[104:107], v4 offset:3424
    v_mfma_f32_16x16x32_bf16 v[20:23], a[36:39], a[80:83], v[20:23]
    ds_read_b128 a[108:111], v4 offset:3360
    v_mfma_f32_16x16x32_bf16 v[16:19], a[36:39], a[88:91], v[16:19]
    ds_read_b64 a[8:9], v3 offset:704
    v_mfma_f32_16x16x32_bf16 v[20:23], a[52:55], a[88:91], v[20:23]
    ds_read_b64 a[10:11], v3 offset:712
    v_mfma_f32_16x16x32_bf16 v[28:31], a[0:3], a[80:83], v[28:31]
    ds_read_b64 a[12:13], v3 offset:736
    v_mfma_f32_16x16x32_bf16 v[24:27], a[0:3], a[88:91], v[24:27]
    ds_read_b64 a[14:15], v3 offset:744
    v_mfma_f32_16x16x32_bf16 v[28:31], a[56:59], a[88:91], v[28:31]
    ds_read_b64 a[16:17], v3 offset:768
    v_mfma_f32_16x16x32_bf16 v[36:39], a[4:7], a[80:83], v[36:39]
    ds_read_b64 a[18:19], v3 offset:776
    v_mfma_f32_16x16x32_bf16 v[32:35], a[4:7], a[88:91], v[32:35]
    ds_read_b64 a[20:21], v3 offset:800
    v_mfma_f32_16x16x32_bf16 v[36:39], a[60:63], a[88:91], v[36:39]
    ds_read_b64 a[22:23], v3 offset:808
    v_mfma_f32_16x16x32_bf16 v[12:15], a[24:27], a[84:87], v[12:15]
    ds_read_b64 a[64:65], v3 offset:2752
    v_mfma_f32_16x16x32_bf16 v[8:11], a[24:27], a[92:95], v[8:11]
    ds_read_b64 a[66:67], v3 offset:2760
    v_mfma_f32_16x16x32_bf16 v[12:15], a[40:43], a[92:95], v[12:15]
    ds_read_b64 a[68:69], v3 offset:2784
    v_mfma_f32_16x16x32_bf16 v[20:23], a[28:31], a[84:87], v[20:23]
    ds_read_b64 a[70:71], v3 offset:2792
    v_mfma_f32_16x16x32_bf16 v[16:19], a[28:31], a[92:95], v[16:19]
    ds_read_b64 a[72:73], v3 offset:2816
    v_mfma_f32_16x16x32_bf16 v[20:23], a[44:47], a[92:95], v[20:23]
    ds_read_b64 a[74:75], v3 offset:2824
    v_mfma_f32_16x16x32_bf16 v[28:31], a[32:35], a[84:87], v[28:31]
    ds_read_b64 a[76:77], v3 offset:2848
    v_mfma_f32_16x16x32_bf16 v[24:27], a[32:35], a[92:95], v[24:27]
    ds_read_b64 a[78:79], v3 offset:2856
    v_mfma_f32_16x16x32_bf16 v[28:31], a[48:51], a[92:95], v[28:31]
    v_mfma_f32_16x16x32_bf16 v[36:39], a[36:39], a[84:87], v[36:39]
    v_mfma_f32_16x16x32_bf16 v[32:35], a[36:39], a[92:95], v[32:35]
    v_mfma_f32_16x16x32_bf16 v[36:39], a[52:55], a[92:95], v[36:39]
    s_waitcnt lgkmcnt(0)
    v_mfma_f32_16x16x32_bf16 v[12:15], a[8:11], a[96:99], v[12:15]
    ds_read_b128 a[80:83], v4 offset:1024
    v_mfma_f32_16x16x32_bf16 v[8:11], a[8:11], a[104:107], v[8:11]
    ds_read_b128 a[84:87], v4 offset:960
    v_mfma_f32_16x16x32_bf16 v[12:15], a[64:67], a[104:107], v[12:15]
    ds_read_b128 a[88:91], v4 offset:3584
    v_mfma_f32_16x16x32_bf16 v[20:23], a[12:15], a[96:99], v[20:23]
    ds_read_b128 a[92:95], v4 offset:3520
    v_mfma_f32_16x16x32_bf16 v[16:19], a[12:15], a[104:107], v[16:19]
    ds_read_b64 a[24:25], v3 offset:832
    v_mfma_f32_16x16x32_bf16 v[20:23], a[68:71], a[104:107], v[20:23]
    ds_read_b64 a[26:27], v3 offset:840
    v_mfma_f32_16x16x32_bf16 v[28:31], a[16:19], a[96:99], v[28:31]
    ds_read_b64 a[28:29], v3 offset:864
    v_mfma_f32_16x16x32_bf16 v[24:27], a[16:19], a[104:107], v[24:27]
    ds_read_b64 a[30:31], v3 offset:872
    v_mfma_f32_16x16x32_bf16 v[28:31], a[72:75], a[104:107], v[28:31]
    ds_read_b64 a[32:33], v3 offset:896
    v_mfma_f32_16x16x32_bf16 v[36:39], a[20:23], a[96:99], v[36:39]
    ds_read_b64 a[34:35], v3 offset:904
    v_mfma_f32_16x16x32_bf16 v[32:35], a[20:23], a[104:107], v[32:35]
    ds_read_b64 a[36:37], v3 offset:928
    v_mfma_f32_16x16x32_bf16 v[36:39], a[76:79], a[104:107], v[36:39]
    ds_read_b64 a[38:39], v3 offset:936
    v_mfma_f32_16x16x32_bf16 v[12:15], a[0:3], a[100:103], v[12:15]
    ds_read_b64 a[40:41], v3 offset:2880
    v_mfma_f32_16x16x32_bf16 v[8:11], a[0:3], a[108:111], v[8:11]
    ds_read_b64 a[42:43], v3 offset:2888
    v_mfma_f32_16x16x32_bf16 v[12:15], a[56:59], a[108:111], v[12:15]
    ds_read_b64 a[44:45], v3 offset:2912
    v_mfma_f32_16x16x32_bf16 v[20:23], a[4:7], a[100:103], v[20:23]
    ds_read_b64 a[46:47], v3 offset:2920
    v_mfma_f32_16x16x32_bf16 v[16:19], a[4:7], a[108:111], v[16:19]
    ds_read_b64 a[48:49], v3 offset:2944
    v_mfma_f32_16x16x32_bf16 v[20:23], a[60:63], a[108:111], v[20:23]
    ds_read_b64 a[50:51], v3 offset:2952
    v_mfma_f32_16x16x32_bf16 v[28:31], a[8:11], a[100:103], v[28:31]
    ds_read_b64 a[52:53], v3 offset:2976
    v_mfma_f32_16x16x32_bf16 v[24:27], a[8:11], a[108:111], v[24:27]
    ds_read_b64 a[54:55], v3 offset:2984
    v_mfma_f32_16x16x32_bf16 v[28:31], a[64:67], a[108:111], v[28:31]
    v_mfma_f32_16x16x32_bf16 v[36:39], a[12:15], a[100:103], v[36:39]
    v_mfma_f32_16x16x32_bf16 v[32:35], a[12:15], a[108:111], v[32:35]
    v_mfma_f32_16x16x32_bf16 v[36:39], a[68:71], a[108:111], v[36:39]
    s_waitcnt lgkmcnt(0)
    v_mfma_f32_16x16x32_bf16 v[12:15], a[24:27], a[80:83], v[12:15]
    ds_read_b128 a[96:99], v4 offset:1184
    v_mfma_f32_16x16x32_bf16 v[8:11], a[24:27], a[88:91], v[8:11]
    ds_read_b128 a[100:103], v4 offset:1120
    v_mfma_f32_16x16x32_bf16 v[12:15], a[40:43], a[88:91], v[12:15]
    ds_read_b128 a[104:107], v4 offset:3744
    v_mfma_f32_16x16x32_bf16 v[20:23], a[28:31], a[80:83], v[20:23]
    ds_read_b128 a[108:111], v4 offset:3680
    v_mfma_f32_16x16x32_bf16 v[16:19], a[28:31], a[88:91], v[16:19]
    ds_read_b64 a[0:1], v3 offset:960
    v_mfma_f32_16x16x32_bf16 v[20:23], a[44:47], a[88:91], v[20:23]
    ds_read_b64 a[2:3], v3 offset:968
    v_mfma_f32_16x16x32_bf16 v[28:31], a[32:35], a[80:83], v[28:31]
    ds_read_b64 a[4:5], v3 offset:992
    v_mfma_f32_16x16x32_bf16 v[24:27], a[32:35], a[88:91], v[24:27]
    ds_read_b64 a[6:7], v3 offset:1000
    v_mfma_f32_16x16x32_bf16 v[28:31], a[48:51], a[88:91], v[28:31]
    ds_read_b64 a[8:9], v3 offset:1024
    v_mfma_f32_16x16x32_bf16 v[36:39], a[36:39], a[80:83], v[36:39]
    ds_read_b64 a[10:11], v3 offset:1032
    v_mfma_f32_16x16x32_bf16 v[32:35], a[36:39], a[88:91], v[32:35]
    ds_read_b64 a[12:13], v3 offset:1056
    v_mfma_f32_16x16x32_bf16 v[36:39], a[52:55], a[88:91], v[36:39]
    ds_read_b64 a[14:15], v3 offset:1064
    v_mfma_f32_16x16x32_bf16 v[12:15], a[16:19], a[84:87], v[12:15]
    ds_read_b64 a[56:57], v3 offset:3008
    v_mfma_f32_16x16x32_bf16 v[8:11], a[16:19], a[92:95], v[8:11]
    ds_read_b64 a[58:59], v3 offset:3016
    v_mfma_f32_16x16x32_bf16 v[12:15], a[72:75], a[92:95], v[12:15]
    ds_read_b64 a[60:61], v3 offset:3040
    v_mfma_f32_16x16x32_bf16 v[20:23], a[20:23], a[84:87], v[20:23]
    ds_read_b64 a[62:63], v3 offset:3048
    v_mfma_f32_16x16x32_bf16 v[16:19], a[20:23], a[92:95], v[16:19]
    ds_read_b64 a[64:65], v3 offset:3072
    v_mfma_f32_16x16x32_bf16 v[20:23], a[76:79], a[92:95], v[20:23]
    ds_read_b64 a[66:67], v3 offset:3080
    v_mfma_f32_16x16x32_bf16 v[28:31], a[24:27], a[84:87], v[28:31]
    ds_read_b64 a[68:69], v3 offset:3104
    v_mfma_f32_16x16x32_bf16 v[24:27], a[24:27], a[92:95], v[24:27]
    ds_read_b64 a[70:71], v3 offset:3112
    v_mfma_f32_16x16x32_bf16 v[28:31], a[40:43], a[92:95], v[28:31]
    v_mfma_f32_16x16x32_bf16 v[36:39], a[28:31], a[84:87], v[36:39]
    v_mfma_f32_16x16x32_bf16 v[32:35], a[28:31], a[92:95], v[32:35]
    v_mfma_f32_16x16x32_bf16 v[36:39], a[44:47], a[92:95], v[36:39]
    s_waitcnt lgkmcnt(0)
    v_mfma_f32_16x16x32_bf16 v[12:15], a[0:3], a[96:99], v[12:15]
    ds_read_b128 a[80:83], v4 offset:1344
    v_mfma_f32_16x16x32_bf16 v[8:11], a[0:3], a[104:107], v[8:11]
    ds_read_b128 a[84:87], v4 offset:1280
    v_mfma_f32_16x16x32_bf16 v[12:15], a[56:59], a[104:107], v[12:15]
    ds_read_b128 a[88:91], v4 offset:3904
    v_mfma_f32_16x16x32_bf16 v[20:23], a[4:7], a[96:99], v[20:23]
    ds_read_b128 a[92:95], v4 offset:3840
    v_mfma_f32_16x16x32_bf16 v[16:19], a[4:7], a[104:107], v[16:19]
    ds_read_b64 a[16:17], v3 offset:1088
    v_mfma_f32_16x16x32_bf16 v[20:23], a[60:63], a[104:107], v[20:23]
    ds_read_b64 a[18:19], v3 offset:1096
    v_mfma_f32_16x16x32_bf16 v[28:31], a[8:11], a[96:99], v[28:31]
    ds_read_b64 a[20:21], v3 offset:1120
    v_mfma_f32_16x16x32_bf16 v[24:27], a[8:11], a[104:107], v[24:27]
    ds_read_b64 a[22:23], v3 offset:1128
    v_mfma_f32_16x16x32_bf16 v[28:31], a[64:67], a[104:107], v[28:31]
    ds_read_b64 a[24:25], v3 offset:1152
    v_mfma_f32_16x16x32_bf16 v[36:39], a[12:15], a[96:99], v[36:39]
    ds_read_b64 a[26:27], v3 offset:1160
    v_mfma_f32_16x16x32_bf16 v[32:35], a[12:15], a[104:107], v[32:35]
    ds_read_b64 a[28:29], v3 offset:1184
    v_mfma_f32_16x16x32_bf16 v[36:39], a[68:71], a[104:107], v[36:39]
    ds_read_b64 a[30:31], v3 offset:1192
    v_mfma_f32_16x16x32_bf16 v[12:15], a[32:35], a[100:103], v[12:15]
    ds_read_b64 a[72:73], v3 offset:3136
    v_mfma_f32_16x16x32_bf16 v[8:11], a[32:35], a[108:111], v[8:11]
    ds_read_b64 a[74:75], v3 offset:3144
    v_mfma_f32_16x16x32_bf16 v[12:15], a[48:51], a[108:111], v[12:15]
    ds_read_b64 a[76:77], v3 offset:3168
    v_mfma_f32_16x16x32_bf16 v[20:23], a[36:39], a[100:103], v[20:23]
    ds_read_b64 a[78:79], v3 offset:3176
    v_mfma_f32_16x16x32_bf16 v[16:19], a[36:39], a[108:111], v[16:19]
    ds_read_b64 a[40:41], v3 offset:3200
    v_mfma_f32_16x16x32_bf16 v[20:23], a[52:55], a[108:111], v[20:23]
    ds_read_b64 a[42:43], v3 offset:3208
    v_mfma_f32_16x16x32_bf16 v[28:31], a[0:3], a[100:103], v[28:31]
    ds_read_b64 a[44:45], v3 offset:3232
    v_mfma_f32_16x16x32_bf16 v[24:27], a[0:3], a[108:111], v[24:27]
    ds_read_b64 a[46:47], v3 offset:3240
    v_mfma_f32_16x16x32_bf16 v[28:31], a[56:59], a[108:111], v[28:31]
    v_mfma_f32_16x16x32_bf16 v[36:39], a[4:7], a[100:103], v[36:39]
    v_mfma_f32_16x16x32_bf16 v[32:35], a[4:7], a[108:111], v[32:35]
    v_mfma_f32_16x16x32_bf16 v[36:39], a[60:63], a[108:111], v[36:39]
    s_waitcnt lgkmcnt(0)
    v_mfma_f32_16x16x32_bf16 v[12:15], a[16:19], a[80:83], v[12:15]
    ds_read_b128 a[96:99], v4 offset:1504
    v_mfma_f32_16x16x32_bf16 v[8:11], a[16:19], a[88:91], v[8:11]
    ds_read_b128 a[100:103], v4 offset:1440
    v_mfma_f32_16x16x32_bf16 v[12:15], a[72:75], a[88:91], v[12:15]
    ds_read_b128 a[104:107], v4 offset:4064
    v_mfma_f32_16x16x32_bf16 v[20:23], a[20:23], a[80:83], v[20:23]
    ds_read_b128 a[108:111], v4 offset:4000
    v_mfma_f32_16x16x32_bf16 v[16:19], a[20:23], a[88:91], v[16:19]
    ds_read_b64 a[32:33], v3 offset:1216
    v_mfma_f32_16x16x32_bf16 v[20:23], a[76:79], a[88:91], v[20:23]
    ds_read_b64 a[34:35], v3 offset:1224
    v_mfma_f32_16x16x32_bf16 v[28:31], a[24:27], a[80:83], v[28:31]
    ds_read_b64 a[36:37], v3 offset:1248
    v_mfma_f32_16x16x32_bf16 v[24:27], a[24:27], a[88:91], v[24:27]
    ds_read_b64 a[38:39], v3 offset:1256
    v_mfma_f32_16x16x32_bf16 v[28:31], a[40:43], a[88:91], v[28:31]
    ds_read_b64 a[0:1], v3 offset:1280
    v_mfma_f32_16x16x32_bf16 v[36:39], a[28:31], a[80:83], v[36:39]
    ds_read_b64 a[2:3], v3 offset:1288
    v_mfma_f32_16x16x32_bf16 v[32:35], a[28:31], a[88:91], v[32:35]
    ds_read_b64 a[4:5], v3 offset:1312
    v_mfma_f32_16x16x32_bf16 v[36:39], a[44:47], a[88:91], v[36:39]
    ds_read_b64 a[6:7], v3 offset:1320
    v_mfma_f32_16x16x32_bf16 v[12:15], a[8:11], a[84:87], v[12:15]
    ds_read_b64 a[48:49], v3 offset:3264
    v_mfma_f32_16x16x32_bf16 v[8:11], a[8:11], a[92:95], v[8:11]
    ds_read_b64 a[50:51], v3 offset:3272
    v_mfma_f32_16x16x32_bf16 v[12:15], a[64:67], a[92:95], v[12:15]
    ds_read_b64 a[52:53], v3 offset:3296
    v_mfma_f32_16x16x32_bf16 v[20:23], a[12:15], a[84:87], v[20:23]
    ds_read_b64 a[54:55], v3 offset:3304
    v_mfma_f32_16x16x32_bf16 v[16:19], a[12:15], a[92:95], v[16:19]
    ds_read_b64 a[56:57], v3 offset:3328
    v_mfma_f32_16x16x32_bf16 v[20:23], a[68:71], a[92:95], v[20:23]
    ds_read_b64 a[58:59], v3 offset:3336
    v_mfma_f32_16x16x32_bf16 v[28:31], a[16:19], a[84:87], v[28:31]
    ds_read_b64 a[60:61], v3 offset:3360
    v_mfma_f32_16x16x32_bf16 v[24:27], a[16:19], a[92:95], v[24:27]
    ds_read_b64 a[62:63], v3 offset:3368
    v_mfma_f32_16x16x32_bf16 v[28:31], a[72:75], a[92:95], v[28:31]
    v_mfma_f32_16x16x32_bf16 v[36:39], a[20:23], a[84:87], v[36:39]
    v_mfma_f32_16x16x32_bf16 v[32:35], a[20:23], a[92:95], v[32:35]
    v_mfma_f32_16x16x32_bf16 v[36:39], a[76:79], a[92:95], v[36:39]
    s_waitcnt lgkmcnt(0)
    v_mfma_f32_16x16x32_bf16 v[12:15], a[32:35], a[96:99], v[12:15]
    ds_read_b128 a[80:83], v4 offset:1664
    v_mfma_f32_16x16x32_bf16 v[8:11], a[32:35], a[104:107], v[8:11]
    ds_read_b128 a[84:87], v4 offset:1600
    v_mfma_f32_16x16x32_bf16 v[12:15], a[48:51], a[104:107], v[12:15]
    ds_read_b128 a[88:91], v4 offset:4224
    v_mfma_f32_16x16x32_bf16 v[20:23], a[36:39], a[96:99], v[20:23]
    ds_read_b128 a[92:95], v4 offset:4160
    v_mfma_f32_16x16x32_bf16 v[16:19], a[36:39], a[104:107], v[16:19]
    ds_read_b64 a[8:9], v3 offset:1344
    v_mfma_f32_16x16x32_bf16 v[20:23], a[52:55], a[104:107], v[20:23]
    ds_read_b64 a[10:11], v3 offset:1352
    v_mfma_f32_16x16x32_bf16 v[28:31], a[0:3], a[96:99], v[28:31]
    ds_read_b64 a[12:13], v3 offset:1376
    v_mfma_f32_16x16x32_bf16 v[24:27], a[0:3], a[104:107], v[24:27]
    ds_read_b64 a[14:15], v3 offset:1384
    v_mfma_f32_16x16x32_bf16 v[28:31], a[56:59], a[104:107], v[28:31]
    ds_read_b64 a[16:17], v3 offset:1408
    v_mfma_f32_16x16x32_bf16 v[36:39], a[4:7], a[96:99], v[36:39]
    ds_read_b64 a[18:19], v3 offset:1416
    v_mfma_f32_16x16x32_bf16 v[32:35], a[4:7], a[104:107], v[32:35]
    ds_read_b64 a[20:21], v3 offset:1440
    v_mfma_f32_16x16x32_bf16 v[36:39], a[60:63], a[104:107], v[36:39]
    ds_read_b64 a[22:23], v3 offset:1448
    v_mfma_f32_16x16x32_bf16 v[12:15], a[24:27], a[100:103], v[12:15]
    ds_read_b64 a[64:65], v3 offset:3392
    v_mfma_f32_16x16x32_bf16 v[8:11], a[24:27], a[108:111], v[8:11]
    ds_read_b64 a[66:67], v3 offset:3400
    v_mfma_f32_16x16x32_bf16 v[12:15], a[40:43], a[108:111], v[12:15]
    ds_read_b64 a[68:69], v3 offset:3424
    v_mfma_f32_16x16x32_bf16 v[20:23], a[28:31], a[100:103], v[20:23]
    ds_read_b64 a[70:71], v3 offset:3432
    v_mfma_f32_16x16x32_bf16 v[16:19], a[28:31], a[108:111], v[16:19]
    ds_read_b64 a[72:73], v3 offset:3456
    v_mfma_f32_16x16x32_bf16 v[20:23], a[44:47], a[108:111], v[20:23]
    ds_read_b64 a[74:75], v3 offset:3464
    v_mfma_f32_16x16x32_bf16 v[28:31], a[32:35], a[100:103], v[28:31]
    ds_read_b64 a[76:77], v3 offset:3488
    v_mfma_f32_16x16x32_bf16 v[24:27], a[32:35], a[108:111], v[24:27]
    ds_read_b64 a[78:79], v3 offset:3496
    v_mfma_f32_16x16x32_bf16 v[28:31], a[48:51], a[108:111], v[28:31]
    v_mfma_f32_16x16x32_bf16 v[36:39], a[36:39], a[100:103], v[36:39]
    v_mfma_f32_16x16x32_bf16 v[32:35], a[36:39], a[108:111], v[32:35]
    v_mfma_f32_16x16x32_bf16 v[36:39], a[52:55], a[108:111], v[36:39]
    s_waitcnt lgkmcnt(0)
    v_mfma_f32_16x16x32_bf16 v[12:15], a[8:11], a[80:83], v[12:15]
    ds_read_b128 a[96:99], v4 offset:1824
    v_mfma_f32_16x16x32_bf16 v[8:11], a[8:11], a[88:91], v[8:11]
    ds_read_b128 a[100:103], v4 offset:1760
    v_mfma_f32_16x16x32_bf16 v[12:15], a[64:67], a[88:91], v[12:15]
    ds_read_b128 a[104:107], v4 offset:4384
    v_mfma_f32_16x16x32_bf16 v[20:23], a[12:15], a[80:83], v[20:23]
    ds_read_b128 a[108:111], v4 offset:4320
    v_mfma_f32_16x16x32_bf16 v[16:19], a[12:15], a[88:91], v[16:19]
    ds_read_b64 a[24:25], v3 offset:1472
    v_mfma_f32_16x16x32_bf16 v[20:23], a[68:71], a[88:91], v[20:23]
    ds_read_b64 a[26:27], v3 offset:1480
    v_mfma_f32_16x16x32_bf16 v[28:31], a[16:19], a[80:83], v[28:31]
    ds_read_b64 a[28:29], v3 offset:1504
    v_mfma_f32_16x16x32_bf16 v[24:27], a[16:19], a[88:91], v[24:27]
    ds_read_b64 a[30:31], v3 offset:1512
    v_mfma_f32_16x16x32_bf16 v[28:31], a[72:75], a[88:91], v[28:31]
    ds_read_b64 a[32:33], v3 offset:1536
    v_mfma_f32_16x16x32_bf16 v[36:39], a[20:23], a[80:83], v[36:39]
    ds_read_b64 a[34:35], v3 offset:1544
    v_mfma_f32_16x16x32_bf16 v[32:35], a[20:23], a[88:91], v[32:35]
    ds_read_b64 a[36:37], v3 offset:1568
    v_mfma_f32_16x16x32_bf16 v[36:39], a[76:79], a[88:91], v[36:39]
    ds_read_b64 a[38:39], v3 offset:1576
    v_mfma_f32_16x16x32_bf16 v[12:15], a[0:3], a[84:87], v[12:15]
    ds_read_b64 a[40:41], v3 offset:3520
    v_mfma_f32_16x16x32_bf16 v[8:11], a[0:3], a[92:95], v[8:11]
    ds_read_b64 a[42:43], v3 offset:3528
    v_mfma_f32_16x16x32_bf16 v[12:15], a[56:59], a[92:95], v[12:15]
    ds_read_b64 a[44:45], v3 offset:3552
    v_mfma_f32_16x16x32_bf16 v[20:23], a[4:7], a[84:87], v[20:23]
    ds_read_b64 a[46:47], v3 offset:3560
    v_mfma_f32_16x16x32_bf16 v[16:19], a[4:7], a[92:95], v[16:19]
    ds_read_b64 a[48:49], v3 offset:3584
    v_mfma_f32_16x16x32_bf16 v[20:23], a[60:63], a[92:95], v[20:23]
    ds_read_b64 a[50:51], v3 offset:3592
    v_mfma_f32_16x16x32_bf16 v[28:31], a[8:11], a[84:87], v[28:31]
    ds_read_b64 a[52:53], v3 offset:3616
    v_mfma_f32_16x16x32_bf16 v[24:27], a[8:11], a[92:95], v[24:27]
    ds_read_b64 a[54:55], v3 offset:3624
    v_mfma_f32_16x16x32_bf16 v[28:31], a[64:67], a[92:95], v[28:31]
    v_mfma_f32_16x16x32_bf16 v[36:39], a[12:15], a[84:87], v[36:39]
    v_mfma_f32_16x16x32_bf16 v[32:35], a[12:15], a[92:95], v[32:35]
    v_mfma_f32_16x16x32_bf16 v[36:39], a[68:71], a[92:95], v[36:39]
    s_waitcnt lgkmcnt(0)
    v_mfma_f32_16x16x32_bf16 v[12:15], a[24:27], a[96:99], v[12:15]
    ds_read_b128 a[80:83], v4 offset:1984
    v_mfma_f32_16x16x32_bf16 v[8:11], a[24:27], a[104:107], v[8:11]
    ds_read_b128 a[84:87], v4 offset:1920
    v_mfma_f32_16x16x32_bf16 v[12:15], a[40:43], a[104:107], v[12:15]
    ds_read_b128 a[88:91], v4 offset:4544
    v_mfma_f32_16x16x32_bf16 v[20:23], a[28:31], a[96:99], v[20:23]
    ds_read_b128 a[92:95], v4 offset:4480
    v_mfma_f32_16x16x32_bf16 v[16:19], a[28:31], a[104:107], v[16:19]
    ds_read_b64 a[0:1], v3 offset:1600
    v_mfma_f32_16x16x32_bf16 v[20:23], a[44:47], a[104:107], v[20:23]
    ds_read_b64 a[2:3], v3 offset:1608
    v_mfma_f32_16x16x32_bf16 v[28:31], a[32:35], a[96:99], v[28:31]
    ds_read_b64 a[4:5], v3 offset:1632
    v_mfma_f32_16x16x32_bf16 v[24:27], a[32:35], a[104:107], v[24:27]
    ds_read_b64 a[6:7], v3 offset:1640
    v_mfma_f32_16x16x32_bf16 v[28:31], a[48:51], a[104:107], v[28:31]
    ds_read_b64 a[8:9], v3 offset:1664
    v_mfma_f32_16x16x32_bf16 v[36:39], a[36:39], a[96:99], v[36:39]
    ds_read_b64 a[10:11], v3 offset:1672
    v_mfma_f32_16x16x32_bf16 v[32:35], a[36:39], a[104:107], v[32:35]
    ds_read_b64 a[12:13], v3 offset:1696
    v_mfma_f32_16x16x32_bf16 v[36:39], a[52:55], a[104:107], v[36:39]
    ds_read_b64 a[14:15], v3 offset:1704
    v_mfma_f32_16x16x32_bf16 v[12:15], a[16:19], a[100:103], v[12:15]
    ds_read_b64 a[56:57], v3 offset:3648
    v_mfma_f32_16x16x32_bf16 v[8:11], a[16:19], a[108:111], v[8:11]
    ds_read_b64 a[58:59], v3 offset:3656
    v_mfma_f32_16x16x32_bf16 v[12:15], a[72:75], a[108:111], v[12:15]
    ds_read_b64 a[60:61], v3 offset:3680
    v_mfma_f32_16x16x32_bf16 v[20:23], a[20:23], a[100:103], v[20:23]
    ds_read_b64 a[62:63], v3 offset:3688
    v_mfma_f32_16x16x32_bf16 v[16:19], a[20:23], a[108:111], v[16:19]
    ds_read_b64 a[64:65], v3 offset:3712
    v_mfma_f32_16x16x32_bf16 v[20:23], a[76:79], a[108:111], v[20:23]
    ds_read_b64 a[66:67], v3 offset:3720
    v_mfma_f32_16x16x32_bf16 v[28:31], a[24:27], a[100:103], v[28:31]
    ds_read_b64 a[68:69], v3 offset:3744
    v_mfma_f32_16x16x32_bf16 v[24:27], a[24:27], a[108:111], v[24:27]
    ds_read_b64 a[70:71], v3 offset:3752
    v_mfma_f32_16x16x32_bf16 v[28:31], a[40:43], a[108:111], v[28:31]
    v_mfma_f32_16x16x32_bf16 v[36:39], a[28:31], a[100:103], v[36:39]
    v_mfma_f32_16x16x32_bf16 v[32:35], a[28:31], a[108:111], v[32:35]
    v_mfma_f32_16x16x32_bf16 v[36:39], a[44:47], a[108:111], v[36:39]
    s_waitcnt lgkmcnt(0)
    v_mfma_f32_16x16x32_bf16 v[12:15], a[0:3], a[80:83], v[12:15]
    ds_read_b128 a[96:99], v4 offset:2144
    v_mfma_f32_16x16x32_bf16 v[8:11], a[0:3], a[88:91], v[8:11]
    ds_read_b128 a[100:103], v4 offset:2080
    v_mfma_f32_16x16x32_bf16 v[12:15], a[56:59], a[88:91], v[12:15]
    ds_read_b128 a[104:107], v4 offset:4704
    v_mfma_f32_16x16x32_bf16 v[20:23], a[4:7], a[80:83], v[20:23]
    ds_read_b128 a[108:111], v4 offset:4640
    v_mfma_f32_16x16x32_bf16 v[16:19], a[4:7], a[88:91], v[16:19]
    ds_read_b64 a[16:17], v3 offset:1728
    v_mfma_f32_16x16x32_bf16 v[20:23], a[60:63], a[88:91], v[20:23]
    ds_read_b64 a[18:19], v3 offset:1736
    v_mfma_f32_16x16x32_bf16 v[28:31], a[8:11], a[80:83], v[28:31]
    ds_read_b64 a[20:21], v3 offset:1760
    v_mfma_f32_16x16x32_bf16 v[24:27], a[8:11], a[88:91], v[24:27]
    ds_read_b64 a[22:23], v3 offset:1768
    v_mfma_f32_16x16x32_bf16 v[28:31], a[64:67], a[88:91], v[28:31]
    ds_read_b64 a[24:25], v3 offset:1792
    v_mfma_f32_16x16x32_bf16 v[36:39], a[12:15], a[80:83], v[36:39]
    ds_read_b64 a[26:27], v3 offset:1800
    v_mfma_f32_16x16x32_bf16 v[32:35], a[12:15], a[88:91], v[32:35]
    ds_read_b64 a[28:29], v3 offset:1824
    v_mfma_f32_16x16x32_bf16 v[36:39], a[68:71], a[88:91], v[36:39]
    ds_read_b64 a[30:31], v3 offset:1832
    v_mfma_f32_16x16x32_bf16 v[12:15], a[32:35], a[84:87], v[12:15]
    ds_read_b64 a[72:73], v3 offset:3776
    v_mfma_f32_16x16x32_bf16 v[8:11], a[32:35], a[92:95], v[8:11]
    ds_read_b64 a[74:75], v3 offset:3784
    v_mfma_f32_16x16x32_bf16 v[12:15], a[48:51], a[92:95], v[12:15]
    ds_read_b64 a[76:77], v3 offset:3808
    v_mfma_f32_16x16x32_bf16 v[20:23], a[36:39], a[84:87], v[20:23]
    ds_read_b64 a[78:79], v3 offset:3816
    v_mfma_f32_16x16x32_bf16 v[16:19], a[36:39], a[92:95], v[16:19]
    ds_read_b64 a[40:41], v3 offset:3840
    v_mfma_f32_16x16x32_bf16 v[20:23], a[52:55], a[92:95], v[20:23]
    ds_read_b64 a[42:43], v3 offset:3848
    v_mfma_f32_16x16x32_bf16 v[28:31], a[0:3], a[84:87], v[28:31]
    ds_read_b64 a[44:45], v3 offset:3872
    v_mfma_f32_16x16x32_bf16 v[24:27], a[0:3], a[92:95], v[24:27]
    ds_read_b64 a[46:47], v3 offset:3880
    v_mfma_f32_16x16x32_bf16 v[28:31], a[56:59], a[92:95], v[28:31]
    v_mfma_f32_16x16x32_bf16 v[36:39], a[4:7], a[84:87], v[36:39]
    v_mfma_f32_16x16x32_bf16 v[32:35], a[4:7], a[92:95], v[32:35]
    v_mfma_f32_16x16x32_bf16 v[36:39], a[60:63], a[92:95], v[36:39]
    s_waitcnt lgkmcnt(0)
    v_mfma_f32_16x16x32_bf16 v[12:15], a[16:19], a[96:99], v[12:15]
    ds_read_b128 a[80:83], v4 offset:2304
    v_mfma_f32_16x16x32_bf16 v[8:11], a[16:19], a[104:107], v[8:11]
    ds_read_b128 a[84:87], v4 offset:2240
    v_mfma_f32_16x16x32_bf16 v[12:15], a[72:75], a[104:107], v[12:15]
    ds_read_b128 a[88:91], v4 offset:4864
    v_mfma_f32_16x16x32_bf16 v[20:23], a[20:23], a[96:99], v[20:23]
    ds_read_b128 a[92:95], v4 offset:4800
    v_mfma_f32_16x16x32_bf16 v[16:19], a[20:23], a[104:107], v[16:19]
    ds_read_b64 a[32:33], v3 offset:1856
    v_mfma_f32_16x16x32_bf16 v[20:23], a[76:79], a[104:107], v[20:23]
    ds_read_b64 a[34:35], v3 offset:1864
    v_mfma_f32_16x16x32_bf16 v[28:31], a[24:27], a[96:99], v[28:31]
    ds_read_b64 a[36:37], v3 offset:1888
    v_mfma_f32_16x16x32_bf16 v[24:27], a[24:27], a[104:107], v[24:27]
    ds_read_b64 a[38:39], v3 offset:1896
    v_mfma_f32_16x16x32_bf16 v[28:31], a[40:43], a[104:107], v[28:31]
    ds_read_b64 a[0:1], v3 offset:1920
    v_mfma_f32_16x16x32_bf16 v[36:39], a[28:31], a[96:99], v[36:39]
    ds_read_b64 a[2:3], v3 offset:1928
    v_mfma_f32_16x16x32_bf16 v[32:35], a[28:31], a[104:107], v[32:35]
    ds_read_b64 a[4:5], v3 offset:1952
    v_mfma_f32_16x16x32_bf16 v[36:39], a[44:47], a[104:107], v[36:39]
    ds_read_b64 a[6:7], v3 offset:1960
    v_mfma_f32_16x16x32_bf16 v[12:15], a[8:11], a[100:103], v[12:15]
    ds_read_b64 a[48:49], v3 offset:3904
    v_mfma_f32_16x16x32_bf16 v[8:11], a[8:11], a[108:111], v[8:11]
    ds_read_b64 a[50:51], v3 offset:3912
    v_mfma_f32_16x16x32_bf16 v[12:15], a[64:67], a[108:111], v[12:15]
    ds_read_b64 a[52:53], v3 offset:3936
    v_mfma_f32_16x16x32_bf16 v[20:23], a[12:15], a[100:103], v[20:23]
    ds_read_b64 a[54:55], v3 offset:3944
    v_mfma_f32_16x16x32_bf16 v[16:19], a[12:15], a[108:111], v[16:19]
    ds_read_b64 a[56:57], v3 offset:3968
    v_mfma_f32_16x16x32_bf16 v[20:23], a[68:71], a[108:111], v[20:23]
    ds_read_b64 a[58:59], v3 offset:3976
    v_mfma_f32_16x16x32_bf16 v[28:31], a[16:19], a[100:103], v[28:31]
    ds_read_b64 a[60:61], v3 offset:4000
    v_mfma_f32_16x16x32_bf16 v[24:27], a[16:19], a[108:111], v[24:27]
    ds_read_b64 a[62:63], v3 offset:4008
    v_mfma_f32_16x16x32_bf16 v[28:31], a[72:75], a[108:111], v[28:31]
    v_mfma_f32_16x16x32_bf16 v[36:39], a[20:23], a[100:103], v[36:39]
    v_mfma_f32_16x16x32_bf16 v[32:35], a[20:23], a[108:111], v[32:35]
    v_mfma_f32_16x16x32_bf16 v[36:39], a[76:79], a[108:111], v[36:39]
    s_waitcnt lgkmcnt(0)
    v_mfma_f32_16x16x32_bf16 v[12:15], a[32:35], a[80:83], v[12:15]
    ds_read_b128 a[96:99], v4 offset:2464
    v_mfma_f32_16x16x32_bf16 v[8:11], a[32:35], a[88:91], v[8:11]
    ds_read_b128 a[100:103], v4 offset:2400
    v_mfma_f32_16x16x32_bf16 v[12:15], a[48:51], a[88:91], v[12:15]
    ds_read_b128 a[104:107], v4 offset:5024
    v_mfma_f32_16x16x32_bf16 v[20:23], a[36:39], a[80:83], v[20:23]
    ds_read_b128 a[108:111], v4 offset:4960
    v_mfma_f32_16x16x32_bf16 v[16:19], a[36:39], a[88:91], v[16:19]
    ds_read_b64 a[8:9], v3 offset:1984
    v_mfma_f32_16x16x32_bf16 v[20:23], a[52:55], a[88:91], v[20:23]
    ds_read_b64 a[10:11], v3 offset:1992
    v_mfma_f32_16x16x32_bf16 v[28:31], a[0:3], a[80:83], v[28:31]
    ds_read_b64 a[12:13], v3 offset:2016
    v_mfma_f32_16x16x32_bf16 v[24:27], a[0:3], a[88:91], v[24:27]
    ds_read_b64 a[14:15], v3 offset:2024
    v_mfma_f32_16x16x32_bf16 v[28:31], a[56:59], a[88:91], v[28:31]
    ds_read_b64 a[16:17], v3 offset:2048
    v_mfma_f32_16x16x32_bf16 v[36:39], a[4:7], a[80:83], v[36:39]
    ds_read_b64 a[18:19], v3 offset:2056
    v_mfma_f32_16x16x32_bf16 v[32:35], a[4:7], a[88:91], v[32:35]
    ds_read_b64 a[20:21], v3 offset:2080
    v_mfma_f32_16x16x32_bf16 v[36:39], a[60:63], a[88:91], v[36:39]
    ds_read_b64 a[22:23], v3 offset:2088
    v_mfma_f32_16x16x32_bf16 v[12:15], a[24:27], a[84:87], v[12:15]
    ds_read_b64 a[64:65], v3 offset:4032
    v_mfma_f32_16x16x32_bf16 v[8:11], a[24:27], a[92:95], v[8:11]
    ds_read_b64 a[66:67], v3 offset:4040
    v_mfma_f32_16x16x32_bf16 v[12:15], a[40:43], a[92:95], v[12:15]
    ds_read_b64 a[68:69], v3 offset:4064
    v_mfma_f32_16x16x32_bf16 v[20:23], a[28:31], a[84:87], v[20:23]
    ds_read_b64 a[70:71], v3 offset:4072
    v_mfma_f32_16x16x32_bf16 v[16:19], a[28:31], a[92:95], v[16:19]
    ds_read_b64 a[72:73], v3 offset:4096
    v_mfma_f32_16x16x32_bf16 v[20:23], a[44:47], a[92:95], v[20:23]
    ds_read_b64 a[74:75], v3 offset:4104
    v_mfma_f32_16x16x32_bf16 v[28:31], a[32:35], a[84:87], v[28:31]
    ds_read_b64 a[76:77], v3 offset:4128
    v_mfma_f32_16x16x32_bf16 v[24:27], a[32:35], a[92:95], v[24:27]
    ds_read_b64 a[78:79], v3 offset:4136
    v_mfma_f32_16x16x32_bf16 v[28:31], a[48:51], a[92:95], v[28:31]
    v_mfma_f32_16x16x32_bf16 v[36:39], a[36:39], a[84:87], v[36:39]
    v_mfma_f32_16x16x32_bf16 v[32:35], a[36:39], a[92:95], v[32:35]
    v_mfma_f32_16x16x32_bf16 v[36:39], a[52:55], a[92:95], v[36:39]
    s_waitcnt lgkmcnt(0)
    v_mfma_f32_16x16x32_bf16 v[12:15], a[8:11], a[96:99], v[12:15]
    v_mfma_f32_16x16x32_bf16 v[8:11], a[8:11], a[104:107], v[8:11]
    v_mfma_f32_16x16x32_bf16 v[12:15], a[64:67], a[104:107], v[12:15]
    v_mfma_f32_16x16x32_bf16 v[20:23], a[12:15], a[96:99], v[20:23]
    v_mfma_f32_16x16x32_bf16 v[16:19], a[12:15], a[104:107], v[16:19]
    v_mfma_f32_16x16x32_bf16 v[20:23], a[68:71], a[104:107], v[20:23]
    v_mfma_f32_16x16x32_bf16 v[28:31], a[16:19], a[96:99], v[28:31]
    v_mfma_f32_16x16x32_bf16 v[24:27], a[16:19], a[104:107], v[24:27]
    v_mfma_f32_16x16x32_bf16 v[28:31], a[72:75], a[104:107], v[28:31]
    v_mfma_f32_16x16x32_bf16 v[36:39], a[20:23], a[96:99], v[36:39]
    v_mfma_f32_16x16x32_bf16 v[32:35], a[20:23], a[104:107], v[32:35]
    v_mfma_f32_16x16x32_bf16 v[36:39], a[76:79], a[104:107], v[36:39]
    v_mfma_f32_16x16x32_bf16 v[12:15], a[0:3], a[100:103], v[12:15]
    v_mfma_f32_16x16x32_bf16 v[8:11], a[0:3], a[108:111], v[8:11]
    v_mfma_f32_16x16x32_bf16 v[12:15], a[56:59], a[108:111], v[12:15]
    v_mfma_f32_16x16x32_bf16 v[20:23], a[4:7], a[100:103], v[20:23]
    v_mfma_f32_16x16x32_bf16 v[16:19], a[4:7], a[108:111], v[16:19]
    v_mfma_f32_16x16x32_bf16 v[20:23], a[60:63], a[108:111], v[20:23]
    v_mfma_f32_16x16x32_bf16 v[28:31], a[8:11], a[100:103], v[28:31]
    v_mfma_f32_16x16x32_bf16 v[24:27], a[8:11], a[108:111], v[24:27]
    v_mfma_f32_16x16x32_bf16 v[28:31], a[64:67], a[108:111], v[28:31]
    v_mfma_f32_16x16x32_bf16 v[36:39], a[12:15], a[100:103], v[36:39]
    v_mfma_f32_16x16x32_bf16 v[32:35], a[12:15], a[108:111], v[32:35]
    v_mfma_f32_16x16x32_bf16 v[36:39], a[68:71], a[108:111], v[36:39]
    s_nop 7
    s_nop 7
    v_mul_u32_u24 v1, 24, v121
    v_sub_u32 v5, v4, v1
    v_add_u32 v5, 24, v5
    ds_read_b64 v[48:49], v5 offset:2656
    ds_read_b64 v[50:51], v5 offset:96
    ds_read_b64 v[52:53], v5 offset:2624
    ds_read_b64 v[54:55], v5 offset:64
    ds_read_b64 v[56:57], v5 offset:2592
    ds_read_b64 v[58:59], v5 offset:32
    ds_read_b64 v[60:61], v5 offset:2560
    ds_read_b64 v[62:63], v5 offset:0
    s_lshr_b32 s18, s16, 1
    s_cmp_eq_u32 s18, 0
    s_cselect_b32 s78, s76, s77
    s_and_b32 s18, s16, 1
    s_lshl_b32 s19, s78, 16
    s_and_b32 s78, s78, 0xffff0000
    s_cmp_eq_u32 s18, 0
    s_cselect_b32 s78, s19, s78
    s_mov_b32 s79, s78
    v_lshlrev_b32 v1, 7, v120
    v_lshl_add_u32 v1, v121, 3, v1
    s_mul_i32 s18, s16, 17664
    v_add_u32 v1, s18, v1
    s_waitcnt lgkmcnt(0)
    v_cvt_pk_bf16_f32 v68, v8, v9
    v_lshlrev_b32 v8, 16, v68
    v_and_b32 v9, s40, v68
    v_cvt_pk_bf16_f32 v69, v10, v11
    v_lshlrev_b32 v10, 16, v69
    v_and_b32 v11, s40, v69
    v_and_b32 v64, s40, v49
    v_lshlrev_b32 v65, 16, v49
    v_and_b32 v66, s40, v48
    v_lshlrev_b32 v67, 16, v48
    v_mul_f32 v64, s78, v64
    v_mul_f32 v65, s78, v65
    v_mul_f32 v66, s78, v66
    v_mul_f32 v67, s78, v67
    v_cvt_pk_bf16_f32 v68, v64, v65
    v_lshlrev_b32 v64, 16, v68
    v_and_b32 v65, s40, v68
    v_cvt_pk_bf16_f32 v69, v66, v67
    v_lshlrev_b32 v66, 16, v69
    v_and_b32 v67, s40, v69
    v_add_f32 v8, v8, v64
    v_add_f32 v9, v9, v65
    v_add_f32 v10, v10, v66
    v_add_f32 v11, v11, v67
    v_cvt_pk_bf16_f32 v70, v8, v9
    v_cvt_pk_bf16_f32 v71, v10, v11
    ds_write_b64 v1, v[70:71] offset:0
    v_cvt_pk_bf16_f32 v76, v12, v13
    v_lshlrev_b32 v12, 16, v76
    v_and_b32 v13, s40, v76
    v_cvt_pk_bf16_f32 v77, v14, v15
    v_lshlrev_b32 v14, 16, v77
    v_and_b32 v15, s40, v77
    v_and_b32 v72, s40, v51
    v_lshlrev_b32 v73, 16, v51
    v_and_b32 v74, s40, v50
    v_lshlrev_b32 v75, 16, v50
    v_mul_f32 v72, s78, v72
    v_mul_f32 v73, s78, v73
    v_mul_f32 v74, s78, v74
    v_mul_f32 v75, s78, v75
    v_cvt_pk_bf16_f32 v76, v72, v73
    v_lshlrev_b32 v72, 16, v76
    v_and_b32 v73, s40, v76
    v_cvt_pk_bf16_f32 v77, v74, v75
    v_lshlrev_b32 v74, 16, v77
    v_and_b32 v75, s40, v77
    v_add_f32 v12, v12, v72
    v_add_f32 v13, v13, v73
    v_add_f32 v14, v14, v74
    v_add_f32 v15, v15, v75
    v_cvt_pk_bf16_f32 v78, v12, v13
    v_cvt_pk_bf16_f32 v79, v14, v15
    ds_write_b64 v1, v[78:79] offset:2048
    v_cvt_pk_bf16_f32 v68, v16, v17
    v_lshlrev_b32 v16, 16, v68
    v_and_b32 v17, s40, v68
    v_cvt_pk_bf16_f32 v69, v18, v19
    v_lshlrev_b32 v18, 16, v69
    v_and_b32 v19, s40, v69
    v_and_b32 v64, s40, v53
    v_lshlrev_b32 v65, 16, v53
    v_and_b32 v66, s40, v52
    v_lshlrev_b32 v67, 16, v52
    v_mul_f32 v64, s78, v64
    v_mul_f32 v65, s78, v65
    v_mul_f32 v66, s78, v66
    v_mul_f32 v67, s78, v67
    v_cvt_pk_bf16_f32 v68, v64, v65
    v_lshlrev_b32 v64, 16, v68
    v_and_b32 v65, s40, v68
    v_cvt_pk_bf16_f32 v69, v66, v67
    v_lshlrev_b32 v66, 16, v69
    v_and_b32 v67, s40, v69
    v_add_f32 v16, v16, v64
    v_add_f32 v17, v17, v65
    v_add_f32 v18, v18, v66
    v_add_f32 v19, v19, v67
    v_cvt_pk_bf16_f32 v70, v16, v17
    v_cvt_pk_bf16_f32 v71, v18, v19
    ds_write_b64 v1, v[70:71] offset:32
    v_cvt_pk_bf16_f32 v76, v20, v21
    v_lshlrev_b32 v20, 16, v76
    v_and_b32 v21, s40, v76
    v_cvt_pk_bf16_f32 v77, v22, v23
    v_lshlrev_b32 v22, 16, v77
    v_and_b32 v23, s40, v77
    v_and_b32 v72, s40, v55
    v_lshlrev_b32 v73, 16, v55
    v_and_b32 v74, s40, v54
    v_lshlrev_b32 v75, 16, v54
    v_mul_f32 v72, s78, v72
    v_mul_f32 v73, s78, v73
    v_mul_f32 v74, s78, v74
    v_mul_f32 v75, s78, v75
    v_cvt_pk_bf16_f32 v76, v72, v73
    v_lshlrev_b32 v72, 16, v76
    v_and_b32 v73, s40, v76
    v_cvt_pk_bf16_f32 v77, v74, v75
    v_lshlrev_b32 v74, 16, v77
    v_and_b32 v75, s40, v77
    v_add_f32 v20, v20, v72
    v_add_f32 v21, v21, v73
    v_add_f32 v22, v22, v74
    v_add_f32 v23, v23, v75
    v_cvt_pk_bf16_f32 v78, v20, v21
    v_cvt_pk_bf16_f32 v79, v22, v23
    ds_write_b64 v1, v[78:79] offset:2080
    v_cvt_pk_bf16_f32 v68, v24, v25
    v_lshlrev_b32 v24, 16, v68
    v_and_b32 v25, s40, v68
    v_cvt_pk_bf16_f32 v69, v26, v27
    v_lshlrev_b32 v26, 16, v69
    v_and_b32 v27, s40, v69
    v_and_b32 v64, s40, v57
    v_lshlrev_b32 v65, 16, v57
    v_and_b32 v66, s40, v56
    v_lshlrev_b32 v67, 16, v56
    v_mul_f32 v64, s78, v64
    v_mul_f32 v65, s78, v65
    v_mul_f32 v66, s78, v66
    v_mul_f32 v67, s78, v67
    v_cvt_pk_bf16_f32 v68, v64, v65
    v_lshlrev_b32 v64, 16, v68
    v_and_b32 v65, s40, v68
    v_cvt_pk_bf16_f32 v69, v66, v67
    v_lshlrev_b32 v66, 16, v69
    v_and_b32 v67, s40, v69
    v_add_f32 v24, v24, v64
    v_add_f32 v25, v25, v65
    v_add_f32 v26, v26, v66
    v_add_f32 v27, v27, v67
    v_cvt_pk_bf16_f32 v70, v24, v25
    v_cvt_pk_bf16_f32 v71, v26, v27
    ds_write_b64 v1, v[70:71] offset:64
    v_cvt_pk_bf16_f32 v76, v28, v29
    v_lshlrev_b32 v28, 16, v76
    v_and_b32 v29, s40, v76
    v_cvt_pk_bf16_f32 v77, v30, v31
    v_lshlrev_b32 v30, 16, v77
    v_and_b32 v31, s40, v77
    v_and_b32 v72, s40, v59
    v_lshlrev_b32 v73, 16, v59
    v_and_b32 v74, s40, v58
    v_lshlrev_b32 v75, 16, v58
    v_mul_f32 v72, s78, v72
    v_mul_f32 v73, s78, v73
    v_mul_f32 v74, s78, v74
    v_mul_f32 v75, s78, v75
    v_cvt_pk_bf16_f32 v76, v72, v73
    v_lshlrev_b32 v72, 16, v76
    v_and_b32 v73, s40, v76
    v_cvt_pk_bf16_f32 v77, v74, v75
    v_lshlrev_b32 v74, 16, v77
    v_and_b32 v75, s40, v77
    v_add_f32 v28, v28, v72
    v_add_f32 v29, v29, v73
    v_add_f32 v30, v30, v74
    v_add_f32 v31, v31, v75
    v_cvt_pk_bf16_f32 v78, v28, v29
    v_cvt_pk_bf16_f32 v79, v30, v31
    ds_write_b64 v1, v[78:79] offset:2112
    v_cvt_pk_bf16_f32 v68, v32, v33
    v_lshlrev_b32 v32, 16, v68
    v_and_b32 v33, s40, v68
    v_cvt_pk_bf16_f32 v69, v34, v35
    v_lshlrev_b32 v34, 16, v69
    v_and_b32 v35, s40, v69
    v_and_b32 v64, s40, v61
    v_lshlrev_b32 v65, 16, v61
    v_and_b32 v66, s40, v60
    v_lshlrev_b32 v67, 16, v60
    v_mul_f32 v64, s78, v64
    v_mul_f32 v65, s78, v65
    v_mul_f32 v66, s78, v66
    v_mul_f32 v67, s78, v67
    v_cvt_pk_bf16_f32 v68, v64, v65
    v_lshlrev_b32 v64, 16, v68
    v_and_b32 v65, s40, v68
    v_cvt_pk_bf16_f32 v69, v66, v67
    v_lshlrev_b32 v66, 16, v69
    v_and_b32 v67, s40, v69
    v_add_f32 v32, v32, v64
    v_add_f32 v33, v33, v65
    v_add_f32 v34, v34, v66
    v_add_f32 v35, v35, v67
    v_cvt_pk_bf16_f32 v70, v32, v33
    v_cvt_pk_bf16_f32 v71, v34, v35
    ds_write_b64 v1, v[70:71] offset:96
    v_cvt_pk_bf16_f32 v76, v36, v37
    v_lshlrev_b32 v36, 16, v76
    v_and_b32 v37, s40, v76
    v_cvt_pk_bf16_f32 v77, v38, v39
    v_lshlrev_b32 v38, 16, v77
    v_and_b32 v39, s40, v77
    v_and_b32 v72, s40, v63
    v_lshlrev_b32 v73, 16, v63
    v_and_b32 v74, s40, v62
    v_lshlrev_b32 v75, 16, v62
    v_mul_f32 v72, s78, v72
    v_mul_f32 v73, s78, v73
    v_mul_f32 v74, s78, v74
    v_mul_f32 v75, s78, v75
    v_cvt_pk_bf16_f32 v76, v72, v73
    v_lshlrev_b32 v72, 16, v76
    v_and_b32 v73, s40, v76
    v_cvt_pk_bf16_f32 v77, v74, v75
    v_lshlrev_b32 v74, 16, v77
    v_and_b32 v75, s40, v77
    v_add_f32 v36, v36, v72
    v_add_f32 v37, v37, v73
    v_add_f32 v38, v38, v74
    v_add_f32 v39, v39, v75
    v_cvt_pk_bf16_f32 v78, v36, v37
    v_cvt_pk_bf16_f32 v79, v38, v39
    ds_write_b64 v1, v[78:79] offset:2144
    s_add_u32 s4, s70, 1048576
    s_addc_u32 s5, s71, 0
    s_and_b32 s5, s5, 0xffff
    s_mov_b32 s6, 4194304
    s_mov_b32 s7, 0x00020000
    s_mul_i32 s18, s16, 17664
    v_lshlrev_b32 v5, 4, v2
    v_add_u32 v1, s18, v5
    s_waitcnt lgkmcnt(0)
    ds_read_b128 v[48:51], v1 offset:0
    ds_read_b128 v[52:55], v1 offset:1024
    ds_read_b128 v[56:59], v1 offset:2048
    ds_read_b128 v[60:63], v1 offset:3072
    s_add_u32 s18, s17, s16
    s_lshl_b32 s18, s18, 12
    s_waitcnt lgkmcnt(3)
    buffer_store_dwordx4 v[48:51], v5, s[4:7], s18 offen offset:0 sc1
    s_waitcnt lgkmcnt(2)
    buffer_store_dwordx4 v[52:55], v5, s[4:7], s18 offen offset:1024 sc1
    s_waitcnt lgkmcnt(1)
    buffer_store_dwordx4 v[56:59], v5, s[4:7], s18 offen offset:2048 sc1
    s_waitcnt lgkmcnt(0)
    buffer_store_dwordx4 v[60:63], v5, s[4:7], s18 offen offset:3072 sc1
    s_branch Ljoin_4
Laux_3:
    v_subrev_u32 v3, 256, v0
    s_sub_u32 s43, s16, 4
    s_cmp_ge_u32 s2, 96
    s_cselect_b32 s54, 1, 0
    s_mul_i32 s18, s54, 96
    s_sub_u32 s55, s2, s18
    s_mov_b32 s24, s62
    s_and_b32 s25, s63, 0xffff
    s_mov_b32 s26, 2048
    s_mov_b32 s27, 0x00020000
    s_mov_b32 s28, s64
    s_and_b32 s29, s65, 0xffff
    s_mov_b32 s30, 12582912
    s_mov_b32 s31, 0x00020000
    s_cmp_ge_u32 s2, 192
    s_cselect_b32 s30, 0, s30
    s_cselect_b32 s26, 0, s26
    v_lshlrev_b32 v4, 1, v2
    v_add_u32 v5, 0, v4
    v_lshrrev_b32 v6, 4, v5
    v_and_b32 v5, 15, v5
    v_lshl_add_u32 v5, v5, 5, v6
    s_lshl_b32 s18, s43, 3
    s_lshl_b32 s19, s54, 9
    s_add_u32 s18, s18, s19
    v_add_u32 v5, s18, v5
    v_lshlrev_b32 v5, 1, v5
    buffer_load_ushort v8, v5, s[24:27], 0 offen
    v_add_u32 v5, 1, v4
    v_lshrrev_b32 v6, 4, v5
    v_and_b32 v5, 15, v5
    v_lshl_add_u32 v5, v5, 5, v6
    s_lshl_b32 s18, s43, 3
    s_lshl_b32 s19, s54, 9
    s_add_u32 s18, s18, s19
    v_add_u32 v5, s18, v5
    v_lshlrev_b32 v5, 1, v5
    buffer_load_ushort v9, v5, s[24:27], 0 offen
    s_load_dwordx2 s[80:81], s[0:1], 0
    s_lshl_b32 s82, s92, 4
    s_add_u32 s82, s82, s3
    s_lshl_b32 s82, s82, 3
    s_add_u32 s82, s82, s16
    s_lshl_b32 s82, s82, 11
    v_lshlrev_b32 v136, 4, v2
    v_add_u32 v136, s82, v136
    s_waitcnt lgkmcnt(0)
    s_and_b32 s81, s81, 0xffff
    s_mov_b32 s82, 4194304
    s_mov_b32 s83, 0x00020000
    buffer_load_dwordx4 v[128:131], v136, s[80:83], 0 offen offset:0 nt
    buffer_load_dwordx4 v[132:135], v136, s[80:83], 0 offen offset:1024 nt
    s_waitcnt vmcnt(0)
    v_lshrrev_b32 v6, 3, v3
    v_mul_u32_u24 v6, 12288, v6
    v_and_b32 v7, 7, v3
    v_lshl_add_u32 v6, v7, 4, v6
    s_lshl_b32 s18, s55, 7
    s_mul_i32 s19, s54, 6291456
    s_add_u32 s18, s18, s19
    v_add_u32 v6, s18, v6
    v_mov_b32 v138, v6
    v_mov_b32 v6, 0
    buffer_load_dword v137, v6, s[72:75], 0 offen sc1
    s_mov_b32 s18, 0
    buffer_load_dwordx4 v[64:67], v138, s[28:31], s18 offen nt
    s_mov_b32 s18, 393216
    buffer_load_dwordx4 v[68:71], v138, s[28:31], s18 offen nt
    s_mov_b32 s18, 786432
    buffer_load_dwordx4 v[72:75], v138, s[28:31], s18 offen nt
    s_mov_b32 s18, 1179648
    buffer_load_dwordx4 v[76:79], v138, s[28:31], s18 offen nt
    v_lshlrev_b32 v8, 16, v8
    v_lshlrev_b32 v9, 16, v9
    v_mul_f32 v10, 0xbfb8aa3b, v8
    v_mul_f32 v11, 0xbfb8aa3b, v9
    v_exp_f32 v10, v10
    v_exp_f32 v11, v11
    s_nop 0
    v_add_f32 v10, 1.0, v10
    v_add_f32 v11, 1.0, v11
    v_rcp_f32 v10, v10
    v_rcp_f32 v11, v11
    s_nop 0
    v_mul_f32 v10, v10, v8
    v_mul_f32 v11, v11, v9
    v_cvt_pk_bf16_f32 v12, v10, v11
    v_lshlrev_b32 v10, 16, v12
    v_and_b32 v11, s40, v12
    s_lshl_b32 s18, s43, 9
    s_add_u32 s18, s18, 103424
    v_lshlrev_b32 v4, 3, v2
    v_add_u32 v4, s18, v4
    ds_write_b64 v4, v[10:11]
    v_lshrrev_b32 v5, 3, v2
    v_lshlrev_b32 v5, 6, v5
    v_add_u32 v5, s18, v5
    s_waitcnt lgkmcnt(0)
    ds_read_b128 v[16:19], v5 offset:0
    ds_read_b128 v[20:23], v5 offset:16
    ds_read_b128 v[24:27], v5 offset:32
    ds_read_b128 v[28:31], v5 offset:48
    v_mov_b32 v32, 0
    v_mov_b32 v33, 0
    v_mov_b32 v34, 0
    v_mov_b32 v35, 0
    v_mov_b32 v36, 0
    v_mov_b32 v37, 0
    v_mov_b32 v38, 0
    v_mov_b32 v39, 0
    s_waitcnt lgkmcnt(0)
    s_waitcnt vmcnt(3)
    s_mov_b32 s18, 1572864
    buffer_load_dwordx4 v[80:83], v138, s[28:31], s18 offen nt
    v_lshlrev_b32 v40, 16, v64
    v_and_b32 v41, s40, v64
    v_lshlrev_b32 v42, 16, v65
    v_and_b32 v43, s40, v65
    v_lshlrev_b32 v44, 16, v66
    v_and_b32 v45, s40, v66
    v_lshlrev_b32 v46, 16, v67
    v_and_b32 v47, s40, v67
    v_fmac_f32 v32, v40, v16
    v_fmac_f32 v33, v41, v16
    v_fmac_f32 v34, v42, v16
    v_fmac_f32 v35, v43, v16
    v_fmac_f32 v36, v44, v16
    v_fmac_f32 v37, v45, v16
    v_fmac_f32 v38, v46, v16
    v_fmac_f32 v39, v47, v16
    s_waitcnt vmcnt(3)
    s_mov_b32 s18, 1966080
    buffer_load_dwordx4 v[84:87], v138, s[28:31], s18 offen nt
    v_lshlrev_b32 v40, 16, v68
    v_and_b32 v41, s40, v68
    v_lshlrev_b32 v42, 16, v69
    v_and_b32 v43, s40, v69
    v_lshlrev_b32 v44, 16, v70
    v_and_b32 v45, s40, v70
    v_lshlrev_b32 v46, 16, v71
    v_and_b32 v47, s40, v71
    v_fmac_f32 v32, v40, v17
    v_fmac_f32 v33, v41, v17
    v_fmac_f32 v34, v42, v17
    v_fmac_f32 v35, v43, v17
    v_fmac_f32 v36, v44, v17
    v_fmac_f32 v37, v45, v17
    v_fmac_f32 v38, v46, v17
    v_fmac_f32 v39, v47, v17
    s_waitcnt vmcnt(3)
    s_mov_b32 s18, 2359296
    buffer_load_dwordx4 v[88:91], v138, s[28:31], s18 offen nt
    v_lshlrev_b32 v40, 16, v72
    v_and_b32 v41, s40, v72
    v_lshlrev_b32 v42, 16, v73
    v_and_b32 v43, s40, v73
    v_lshlrev_b32 v44, 16, v74
    v_and_b32 v45, s40, v74
    v_lshlrev_b32 v46, 16, v75
    v_and_b32 v47, s40, v75
    v_fmac_f32 v32, v40, v18
    v_fmac_f32 v33, v41, v18
    v_fmac_f32 v34, v42, v18
    v_fmac_f32 v35, v43, v18
    v_fmac_f32 v36, v44, v18
    v_fmac_f32 v37, v45, v18
    v_fmac_f32 v38, v46, v18
    v_fmac_f32 v39, v47, v18
    s_waitcnt vmcnt(3)
    s_mov_b32 s18, 2752512
    buffer_load_dwordx4 v[92:95], v138, s[28:31], s18 offen nt
    v_lshlrev_b32 v40, 16, v76
    v_and_b32 v41, s40, v76
    v_lshlrev_b32 v42, 16, v77
    v_and_b32 v43, s40, v77
    v_lshlrev_b32 v44, 16, v78
    v_and_b32 v45, s40, v78
    v_lshlrev_b32 v46, 16, v79
    v_and_b32 v47, s40, v79
    v_fmac_f32 v32, v40, v19
    v_fmac_f32 v33, v41, v19
    v_fmac_f32 v34, v42, v19
    v_fmac_f32 v35, v43, v19
    v_fmac_f32 v36, v44, v19
    v_fmac_f32 v37, v45, v19
    v_fmac_f32 v38, v46, v19
    v_fmac_f32 v39, v47, v19
    s_waitcnt vmcnt(3)
    s_mov_b32 s18, 3145728
    buffer_load_dwordx4 v[96:99], v138, s[28:31], s18 offen nt
    v_lshlrev_b32 v40, 16, v80
    v_and_b32 v41, s40, v80
    v_lshlrev_b32 v42, 16, v81
    v_and_b32 v43, s40, v81
    v_lshlrev_b32 v44, 16, v82
    v_and_b32 v45, s40, v82
    v_lshlrev_b32 v46, 16, v83
    v_and_b32 v47, s40, v83
    v_fmac_f32 v32, v40, v20
    v_fmac_f32 v33, v41, v20
    v_fmac_f32 v34, v42, v20
    v_fmac_f32 v35, v43, v20
    v_fmac_f32 v36, v44, v20
    v_fmac_f32 v37, v45, v20
    v_fmac_f32 v38, v46, v20
    v_fmac_f32 v39, v47, v20
    s_waitcnt vmcnt(3)
    s_mov_b32 s18, 3538944
    buffer_load_dwordx4 v[100:103], v138, s[28:31], s18 offen nt
    v_lshlrev_b32 v40, 16, v84
    v_and_b32 v41, s40, v84
    v_lshlrev_b32 v42, 16, v85
    v_and_b32 v43, s40, v85
    v_lshlrev_b32 v44, 16, v86
    v_and_b32 v45, s40, v86
    v_lshlrev_b32 v46, 16, v87
    v_and_b32 v47, s40, v87
    v_fmac_f32 v32, v40, v21
    v_fmac_f32 v33, v41, v21
    v_fmac_f32 v34, v42, v21
    v_fmac_f32 v35, v43, v21
    v_fmac_f32 v36, v44, v21
    v_fmac_f32 v37, v45, v21
    v_fmac_f32 v38, v46, v21
    v_fmac_f32 v39, v47, v21
    s_waitcnt vmcnt(3)
    s_mov_b32 s18, 3932160
    buffer_load_dwordx4 v[104:107], v138, s[28:31], s18 offen nt
    v_lshlrev_b32 v40, 16, v88
    v_and_b32 v41, s40, v88
    v_lshlrev_b32 v42, 16, v89
    v_and_b32 v43, s40, v89
    v_lshlrev_b32 v44, 16, v90
    v_and_b32 v45, s40, v90
    v_lshlrev_b32 v46, 16, v91
    v_and_b32 v47, s40, v91
    v_fmac_f32 v32, v40, v22
    v_fmac_f32 v33, v41, v22
    v_fmac_f32 v34, v42, v22
    v_fmac_f32 v35, v43, v22
    v_fmac_f32 v36, v44, v22
    v_fmac_f32 v37, v45, v22
    v_fmac_f32 v38, v46, v22
    v_fmac_f32 v39, v47, v22
    s_waitcnt vmcnt(3)
    s_mov_b32 s18, 4325376
    buffer_load_dwordx4 v[108:111], v138, s[28:31], s18 offen nt
    v_lshlrev_b32 v40, 16, v92
    v_and_b32 v41, s40, v92
    v_lshlrev_b32 v42, 16, v93
    v_and_b32 v43, s40, v93
    v_lshlrev_b32 v44, 16, v94
    v_and_b32 v45, s40, v94
    v_lshlrev_b32 v46, 16, v95
    v_and_b32 v47, s40, v95
    v_fmac_f32 v32, v40, v23
    v_fmac_f32 v33, v41, v23
    v_fmac_f32 v34, v42, v23
    v_fmac_f32 v35, v43, v23
    v_fmac_f32 v36, v44, v23
    v_fmac_f32 v37, v45, v23
    v_fmac_f32 v38, v46, v23
    v_fmac_f32 v39, v47, v23
    s_waitcnt vmcnt(3)
    s_mov_b32 s18, 4718592
    buffer_load_dwordx4 v[112:115], v138, s[28:31], s18 offen nt
    v_lshlrev_b32 v40, 16, v96
    v_and_b32 v41, s40, v96
    v_lshlrev_b32 v42, 16, v97
    v_and_b32 v43, s40, v97
    v_lshlrev_b32 v44, 16, v98
    v_and_b32 v45, s40, v98
    v_lshlrev_b32 v46, 16, v99
    v_and_b32 v47, s40, v99
    v_fmac_f32 v32, v40, v24
    v_fmac_f32 v33, v41, v24
    v_fmac_f32 v34, v42, v24
    v_fmac_f32 v35, v43, v24
    v_fmac_f32 v36, v44, v24
    v_fmac_f32 v37, v45, v24
    v_fmac_f32 v38, v46, v24
    v_fmac_f32 v39, v47, v24
    s_waitcnt vmcnt(3)
    s_mov_b32 s18, 5111808
    buffer_load_dwordx4 v[116:119], v138, s[28:31], s18 offen nt
    v_lshlrev_b32 v40, 16, v100
    v_and_b32 v41, s40, v100
    v_lshlrev_b32 v42, 16, v101
    v_and_b32 v43, s40, v101
    v_lshlrev_b32 v44, 16, v102
    v_and_b32 v45, s40, v102
    v_lshlrev_b32 v46, 16, v103
    v_and_b32 v47, s40, v103
    v_fmac_f32 v32, v40, v25
    v_fmac_f32 v33, v41, v25
    v_fmac_f32 v34, v42, v25
    v_fmac_f32 v35, v43, v25
    v_fmac_f32 v36, v44, v25
    v_fmac_f32 v37, v45, v25
    v_fmac_f32 v38, v46, v25
    v_fmac_f32 v39, v47, v25
    s_waitcnt vmcnt(3)
    s_mov_b32 s18, 5505024
    buffer_load_dwordx4 v[120:123], v138, s[28:31], s18 offen nt
    v_lshlrev_b32 v40, 16, v104
    v_and_b32 v41, s40, v104
    v_lshlrev_b32 v42, 16, v105
    v_and_b32 v43, s40, v105
    v_lshlrev_b32 v44, 16, v106
    v_and_b32 v45, s40, v106
    v_lshlrev_b32 v46, 16, v107
    v_and_b32 v47, s40, v107
    v_fmac_f32 v32, v40, v26
    v_fmac_f32 v33, v41, v26
    v_fmac_f32 v34, v42, v26
    v_fmac_f32 v35, v43, v26
    v_fmac_f32 v36, v44, v26
    v_fmac_f32 v37, v45, v26
    v_fmac_f32 v38, v46, v26
    v_fmac_f32 v39, v47, v26
    s_waitcnt vmcnt(3)
    s_mov_b32 s18, 5898240
    buffer_load_dwordx4 v[124:127], v138, s[28:31], s18 offen nt
    v_lshlrev_b32 v40, 16, v108
    v_and_b32 v41, s40, v108
    v_lshlrev_b32 v42, 16, v109
    v_and_b32 v43, s40, v109
    v_lshlrev_b32 v44, 16, v110
    v_and_b32 v45, s40, v110
    v_lshlrev_b32 v46, 16, v111
    v_and_b32 v47, s40, v111
    v_fmac_f32 v32, v40, v27
    v_fmac_f32 v33, v41, v27
    v_fmac_f32 v34, v42, v27
    v_fmac_f32 v35, v43, v27
    v_fmac_f32 v36, v44, v27
    v_fmac_f32 v37, v45, v27
    v_fmac_f32 v38, v46, v27
    v_fmac_f32 v39, v47, v27
    s_waitcnt vmcnt(3)
    v_lshlrev_b32 v40, 16, v112
    v_and_b32 v41, s40, v112
    v_lshlrev_b32 v42, 16, v113
    v_and_b32 v43, s40, v113
    v_lshlrev_b32 v44, 16, v114
    v_and_b32 v45, s40, v114
    v_lshlrev_b32 v46, 16, v115
    v_and_b32 v47, s40, v115
    v_fmac_f32 v32, v40, v28
    v_fmac_f32 v33, v41, v28
    v_fmac_f32 v34, v42, v28
    v_fmac_f32 v35, v43, v28
    v_fmac_f32 v36, v44, v28
    v_fmac_f32 v37, v45, v28
    v_fmac_f32 v38, v46, v28
    v_fmac_f32 v39, v47, v28
    s_waitcnt vmcnt(2)
    v_lshlrev_b32 v40, 16, v116
    v_and_b32 v41, s40, v116
    v_lshlrev_b32 v42, 16, v117
    v_and_b32 v43, s40, v117
    v_lshlrev_b32 v44, 16, v118
    v_and_b32 v45, s40, v118
    v_lshlrev_b32 v46, 16, v119
    v_and_b32 v47, s40, v119
    v_fmac_f32 v32, v40, v29
    v_fmac_f32 v33, v41, v29
    v_fmac_f32 v34, v42, v29
    v_fmac_f32 v35, v43, v29
    v_fmac_f32 v36, v44, v29
    v_fmac_f32 v37, v45, v29
    v_fmac_f32 v38, v46, v29
    v_fmac_f32 v39, v47, v29
    s_waitcnt vmcnt(1)
    v_lshlrev_b32 v40, 16, v120
    v_and_b32 v41, s40, v120
    v_lshlrev_b32 v42, 16, v121
    v_and_b32 v43, s40, v121
    v_lshlrev_b32 v44, 16, v122
    v_and_b32 v45, s40, v122
    v_lshlrev_b32 v46, 16, v123
    v_and_b32 v47, s40, v123
    v_fmac_f32 v32, v40, v30
    v_fmac_f32 v33, v41, v30
    v_fmac_f32 v34, v42, v30
    v_fmac_f32 v35, v43, v30
    v_fmac_f32 v36, v44, v30
    v_fmac_f32 v37, v45, v30
    v_fmac_f32 v38, v46, v30
    v_fmac_f32 v39, v47, v30
    s_waitcnt vmcnt(0)
    v_lshlrev_b32 v40, 16, v124
    v_and_b32 v41, s40, v124
    v_lshlrev_b32 v42, 16, v125
    v_and_b32 v43, s40, v125
    v_lshlrev_b32 v44, 16, v126
    v_and_b32 v45, s40, v126
    v_lshlrev_b32 v46, 16, v127
    v_and_b32 v47, s40, v127
    v_fmac_f32 v32, v40, v31
    v_fmac_f32 v33, v41, v31
    v_fmac_f32 v34, v42, v31
    v_fmac_f32 v35, v43, v31
    v_fmac_f32 v36, v44, v31
    v_fmac_f32 v37, v45, v31
    v_fmac_f32 v38, v46, v31
    v_fmac_f32 v39, v47, v31
    v_lshlrev_b32 v1, 5, v3
    v_add_u32 v1, 105472, v1
    ds_write_b128 v1, v[32:35]
    ds_write_b128 v1, v[36:39] offset:16
    s_waitcnt lgkmcnt(0)
    v_mov_b32 v4, 113664
    v_mov_b32 v5, 1
    s_mov_b64 exec, 1
    ds_add_u32 v4, v5
    s_mov_b64 exec, -1
    s_mul_i32 s18, s2, 16384
    v_lshlrev_b32 v6, 4, v3
    v_add_u32 v6, s18, v6
    s_mov_b32 s8, s56
    s_and_b32 s9, s57, 0xffff
    s_mov_b32 s10, 7340032
    s_mov_b32 s11, 0x00020000
    s_mov_b32 s18, 0
    buffer_load_dwordx4 v[64:67], v6, s[8:11], s18 offen
    s_mov_b32 s18, 4096
    buffer_load_dwordx4 v[68:71], v6, s[8:11], s18 offen
    s_mov_b32 s18, 8192
    buffer_load_dwordx4 v[72:75], v6, s[8:11], s18 offen
    s_mov_b32 s18, 12288
    buffer_load_dwordx4 v[76:79], v6, s[8:11], s18 offen
    s_mov_b32 s8, s58
    s_and_b32 s9, s59, 0xffff
    s_mov_b32 s10, 7340032
    s_mov_b32 s11, 0x00020000
    s_mov_b32 s18, 0
    buffer_load_dwordx4 v[80:83], v6, s[8:11], s18 offen
    s_mov_b32 s18, 4096
    buffer_load_dwordx4 v[84:87], v6, s[8:11], s18 offen
    s_mov_b32 s18, 8192
    buffer_load_dwordx4 v[88:91], v6, s[8:11], s18 offen
    s_mov_b32 s18, 12288
    buffer_load_dwordx4 v[92:95], v6, s[8:11], s18 offen
    s_cmp_lg_u32 s43, 0
    s_cbranch_scc1 Lauxd_15
    s_cmp_ge_u32 s2, 192
    s_cbranch_scc1 Lauxd_15
    s_mov_b32 s18, 200000
Lsp_16:
    ds_read_b32 v5, v4
    s_waitcnt lgkmcnt(0)
    v_readfirstlane_b32 s19, v5
    s_nop 3
    s_cmp_ge_u32 s19, 4
    s_cbranch_scc1 Lsd_17
    s_sub_u32 s18, s18, 1
    s_cmp_lg_u32 s18, 0
    s_sleep 1
    s_cbranch_scc1 Lsp_16
Lsd_17:
    v_lshlrev_b32 v1, 2, v2
    v_add_u32 v6, 105472, v1
    ds_read_b32 v16, v6 offset:0
    ds_read_b32 v17, v6 offset:256
    ds_read_b32 v18, v6 offset:512
    ds_read_b32 v19, v6 offset:768
    ds_read_b32 v20, v6 offset:1024
    ds_read_b32 v21, v6 offset:1280
    ds_read_b32 v22, v6 offset:1536
    ds_read_b32 v23, v6 offset:1792
    ds_read_b32 v24, v6 offset:2048
    ds_read_b32 v25, v6 offset:2304
    ds_read_b32 v26, v6 offset:2560
    ds_read_b32 v27, v6 offset:2816
    ds_read_b32 v28, v6 offset:3072
    ds_read_b32 v29, v6 offset:3328
    ds_read_b32 v30, v6 offset:3584
    ds_read_b32 v31, v6 offset:3840
    ds_read_b32 v32, v6 offset:4096
    ds_read_b32 v33, v6 offset:4352
    ds_read_b32 v34, v6 offset:4608
    ds_read_b32 v35, v6 offset:4864
    ds_read_b32 v36, v6 offset:5120
    ds_read_b32 v37, v6 offset:5376
    ds_read_b32 v38, v6 offset:5632
    ds_read_b32 v39, v6 offset:5888
    ds_read_b32 v40, v6 offset:6144
    ds_read_b32 v41, v6 offset:6400
    ds_read_b32 v42, v6 offset:6656
    ds_read_b32 v43, v6 offset:6912
    ds_read_b32 v44, v6 offset:7168
    ds_read_b32 v45, v6 offset:7424
    ds_read_b32 v46, v6 offset:7680
    ds_read_b32 v47, v6 offset:7936
    s_waitcnt lgkmcnt(0)
    v_add_f32 v16, v16, v32
    v_add_f32 v17, v17, v33
    v_add_f32 v18, v18, v34
    v_add_f32 v19, v19, v35
    v_add_f32 v20, v20, v36
    v_add_f32 v21, v21, v37
    v_add_f32 v22, v22, v38
    v_add_f32 v23, v23, v39
    v_add_f32 v24, v24, v40
    v_add_f32 v25, v25, v41
    v_add_f32 v26, v26, v42
    v_add_f32 v27, v27, v43
    v_add_f32 v28, v28, v44
    v_add_f32 v29, v29, v45
    v_add_f32 v30, v30, v46
    v_add_f32 v31, v31, v47
    v_add_f32 v16, v16, v24
    v_add_f32 v17, v17, v25
    v_add_f32 v18, v18, v26
    v_add_f32 v19, v19, v27
    v_add_f32 v20, v20, v28
    v_add_f32 v21, v21, v29
    v_add_f32 v22, v22, v30
    v_add_f32 v23, v23, v31
    v_add_f32 v16, v16, v20
    v_add_f32 v17, v17, v21
    v_add_f32 v18, v18, v22
    v_add_f32 v19, v19, v23
    v_add_f32 v16, v16, v18
    v_add_f32 v17, v17, v19
    v_add_f32 v16, v16, v17
    s_add_u32 s8, s70, 0
    s_addc_u32 s9, s71, 0
    s_and_b32 s9, s9, 0xffff
    s_mov_b32 s10, 49152
    s_mov_b32 s11, 0x00020000
    s_lshl_b32 s18, s55, 8
    s_mul_i32 s19, s54, 24576
    s_add_u32 s18, s18, s19
    v_add_u32 v1, s18, v1
    buffer_store_dword v16, v1, s[8:11], 0 offen sc1
Lauxd_15:
    s_waitcnt vmcnt(0)
    v_readfirstlane_b32 s93, v137
    s_nop 3
    s_cmp_lg_u32 s93, 0
    s_cbranch_scc1 Lgot_18
    s_mov_b32 s55, 200000
    v_mov_b32 v24, 0
Lnr_19:
    buffer_load_dword v25, v24, s[72:75], 0 offen sc1
    s_waitcnt vmcnt(0)
    v_readfirstlane_b32 s93, v25
    s_nop 3
    s_cmp_lg_u32 s93, 0
    s_cbranch_scc1 Lnd_20
    s_sub_u32 s55, s55, 1
    s_cmp_lg_u32 s55, 0
    s_sleep 1
    s_cbranch_scc1 Lnr_19
Lnd_20:
Lgot_18:
Ljoin_4:
    s_waitcnt vmcnt(0)
    s_barrier
    s_cmp_lg_u32 s16, 0
    s_cbranch_scc1 Lpub_21
    s_lshl_b32 s38, s2, 7
    s_add_u32 s39, s93, 2
    v_mov_b32 v24, s38
    v_mov_b32 v25, s39
    s_mov_b64 exec, 1
    buffer_store_dword v25, v24, s[32:35], 0 offen sc1
    s_mov_b64 exec, -1
Lpub_21:
    s_mov_b64 s[76:77], s[32:33]
    s_mov_b64 s[78:79], s[34:35]
    s_add_u32 s88, s70, 33587200
    s_addc_u32 s89, s71, 0
    s_and_b32 s89, s89, 0xffff
    s_mov_b32 s90, 294912
    s_mov_b32 s91, 0x00020000
    s_load_dwordx2 s[34:35], s[0:1], 112
    s_waitcnt lgkmcnt(0)
    s_add_u32 s8, s34, 1048576
    s_addc_u32 s9, s35, 0
    s_and_b32 s9, s9, 0xffff
    s_mov_b32 s10, 4194304
    s_mov_b32 s11, 0x00020000
    s_add_u32 s12, s34, 0
    s_addc_u32 s13, s35, 0
    s_and_b32 s13, s13, 0xffff
    s_mov_b32 s14, 49152
    s_mov_b32 s15, 0x00020000
    s_add_u32 s20, s34, 5242880
    s_addc_u32 s21, s35, 0
    s_and_b32 s21, s21, 0xffff
    s_mov_b32 s22, 4194304
    s_mov_b32 s23, 0x00020000
    s_add_u32 s24, s34, 9437184
    s_addc_u32 s25, s35, 0
    s_and_b32 s25, s25, 0xffff
    s_mov_b32 s26, 4194304
    s_mov_b32 s27, 0x00020000
    s_lshl_b32 s17, s92, 4
    s_add_u32 s17, s17, s3
    s_lshl_b32 s19, s17, 3
    s_add_u32 s19, s19, s16
    s_lshl_b32 s19, s19, 11
    v_lshlrev_b32 v4, 4, v2
    v_add_u32 v4, s19, v4
    v_lshlrev_b32 v72, 16, v128
    v_and_b32 v73, s40, v128
    v_lshlrev_b32 v74, 16, v129
    v_and_b32 v75, s40, v129
    v_lshlrev_b32 v76, 16, v130
    v_and_b32 v77, s40, v130
    v_lshlrev_b32 v78, 16, v131
    v_and_b32 v79, s40, v131
    v_lshlrev_b32 v80, 16, v132
    v_and_b32 v81, s40, v132
    v_lshlrev_b32 v82, 16, v133
    v_and_b32 v83, s40, v133
    v_lshlrev_b32 v84, 16, v134
    v_and_b32 v85, s40, v134
    v_lshlrev_b32 v86, 16, v135
    v_and_b32 v87, s40, v135
    v_mov_b32 v125, 0
    v_pk_add_f32 v[104:105], v[72:73], v[74:75]
    v_pk_add_f32 v[106:107], v[76:77], v[78:79]
    v_pk_add_f32 v[104:105], v[104:105], v[80:81]
    v_pk_add_f32 v[106:107], v[106:107], v[82:83]
    v_pk_add_f32 v[104:105], v[104:105], v[84:85]
    v_pk_add_f32 v[106:107], v[106:107], v[86:87]
    v_pk_add_f32 v[104:105], v[104:105], v[106:107]
    v_add_f32 v104, v104, v105
    s_nop 1
    v_add_f32_dpp v104, v104, v104 quad_perm:[1,0,3,2] row_mask:0xf bank_mask:0xf
    s_nop 1
    v_add_f32_dpp v104, v104, v104 quad_perm:[2,3,0,1] row_mask:0xf bank_mask:0xf
    s_nop 1
    v_add_f32_dpp v104, v104, v104 row_half_mirror row_mask:0xf bank_mask:0xf
    s_nop 1
    v_add_f32_dpp v104, v104, v104 row_mirror row_mask:0xf bank_mask:0xf
    s_nop 1
    v_add_f32_dpp v104, v104, v104 row_bcast:15 row_mask:0xa bank_mask:0xf
    s_nop 1
    v_add_f32_dpp v104, v104, v104 row_bcast:31 row_mask:0xc bank_mask:0xf
    s_nop 1
    v_readlane_b32 s44, v104, 63
    s_nop 1
    v_mov_b32 v120, s44
    v_mul_f32 v120, 0x3a800000, v120
    v_pk_add_f32 v[88:89], v[72:73], v[120:121] op_sel_hi:[1,0] neg_lo:[0,1] neg_hi:[0,1]
    v_pk_add_f32 v[90:91], v[74:75], v[120:121] op_sel_hi:[1,0] neg_lo:[0,1] neg_hi:[0,1]
    v_pk_add_f32 v[92:93], v[76:77], v[120:121] op_sel_hi:[1,0] neg_lo:[0,1] neg_hi:[0,1]
    v_pk_add_f32 v[94:95], v[78:79], v[120:121] op_sel_hi:[1,0] neg_lo:[0,1] neg_hi:[0,1]
    v_pk_add_f32 v[96:97], v[80:81], v[120:121] op_sel_hi:[1,0] neg_lo:[0,1] neg_hi:[0,1]
    v_pk_add_f32 v[98:99], v[82:83], v[120:121] op_sel_hi:[1,0] neg_lo:[0,1] neg_hi:[0,1]
    v_pk_add_f32 v[100:101], v[84:85], v[120:121] op_sel_hi:[1,0] neg_lo:[0,1] neg_hi:[0,1]
    v_pk_add_f32 v[102:103], v[86:87], v[120:121] op_sel_hi:[1,0] neg_lo:[0,1] neg_hi:[0,1]
    v_pk_mul_f32 v[104:105], v[88:89], v[88:89]
    v_pk_mul_f32 v[106:107], v[90:91], v[90:91]
    v_pk_fma_f32 v[104:105], v[92:93], v[92:93], v[104:105]
    v_pk_fma_f32 v[106:107], v[94:95], v[94:95], v[106:107]
    v_pk_fma_f32 v[104:105], v[96:97], v[96:97], v[104:105]
    v_pk_fma_f32 v[106:107], v[98:99], v[98:99], v[106:107]
    v_pk_fma_f32 v[104:105], v[100:101], v[100:101], v[104:105]
    v_pk_fma_f32 v[106:107], v[102:103], v[102:103], v[106:107]
    v_pk_add_f32 v[104:105], v[104:105], v[106:107]
    v_add_f32 v104, v104, v105
    s_nop 1
    v_add_f32_dpp v104, v104, v104 quad_perm:[1,0,3,2] row_mask:0xf bank_mask:0xf
    s_nop 1
    v_add_f32_dpp v104, v104, v104 quad_perm:[2,3,0,1] row_mask:0xf bank_mask:0xf
    s_nop 1
    v_add_f32_dpp v104, v104, v104 row_half_mirror row_mask:0xf bank_mask:0xf
    s_nop 1
    v_add_f32_dpp v104, v104, v104 row_mirror row_mask:0xf bank_mask:0xf
    s_nop 1
    v_add_f32_dpp v104, v104, v104 row_bcast:15 row_mask:0xa bank_mask:0xf
    s_nop 1
    v_add_f32_dpp v104, v104, v104 row_bcast:31 row_mask:0xc bank_mask:0xf
    s_nop 1
    v_readlane_b32 s44, v104, 63
    s_nop 1
    v_mov_b32 v124, s44
    v_mul_f32 v124, 0x3a800000, v124
    v_cvt_pk_bf16_f32 v104, v124, v120
    v_lshlrev_b32 v124, 16, v104
    v_and_b32 v120, s40, v104
    v_add_f32 v124, 0x3727c5ac, v124
    v_cvt_pk_bf16_f32 v104, v124, v125
    v_lshlrev_b32 v124, 16, v104
    v_and_b32 v125, s40, v104
    v_sqrt_f32 v124, v124
    s_nop 0
    v_cvt_pk_bf16_f32 v104, v124, v125
    v_lshlrev_b32 v124, 16, v104
    v_and_b32 v125, s40, v104
    v_rcp_f32 v126, v124
    s_nop 0
    v_pk_add_f32 v[88:89], v[72:73], v[120:121] op_sel_hi:[1,0] neg_lo:[0,1] neg_hi:[0,1]
    v_cvt_pk_bf16_f32 v104, v88, v89
    v_lshlrev_b32 v88, 16, v104
    v_and_b32 v89, s40, v104
    v_pk_mul_f32 v[88:89], v[88:89], v[126:127] op_sel_hi:[1,0]
    v_cvt_pk_bf16_f32 v108, v88, v89
    v_lshlrev_b32 v88, 16, v108
    v_and_b32 v89, s40, v108
    v_pk_add_f32 v[90:91], v[74:75], v[120:121] op_sel_hi:[1,0] neg_lo:[0,1] neg_hi:[0,1]
    v_cvt_pk_bf16_f32 v105, v90, v91
    v_lshlrev_b32 v90, 16, v105
    v_and_b32 v91, s40, v105
    v_pk_mul_f32 v[90:91], v[90:91], v[126:127] op_sel_hi:[1,0]
    v_cvt_pk_bf16_f32 v109, v90, v91
    v_lshlrev_b32 v90, 16, v109
    v_and_b32 v91, s40, v109
    v_pk_add_f32 v[92:93], v[76:77], v[120:121] op_sel_hi:[1,0] neg_lo:[0,1] neg_hi:[0,1]
    v_cvt_pk_bf16_f32 v106, v92, v93
    v_lshlrev_b32 v92, 16, v106
    v_and_b32 v93, s40, v106
    v_pk_mul_f32 v[92:93], v[92:93], v[126:127] op_sel_hi:[1,0]
    v_cvt_pk_bf16_f32 v110, v92, v93
    v_lshlrev_b32 v92, 16, v110
    v_and_b32 v93, s40, v110
    v_pk_add_f32 v[94:95], v[78:79], v[120:121] op_sel_hi:[1,0] neg_lo:[0,1] neg_hi:[0,1]
    v_cvt_pk_bf16_f32 v107, v94, v95
    v_lshlrev_b32 v94, 16, v107
    v_and_b32 v95, s40, v107
    v_pk_mul_f32 v[94:95], v[94:95], v[126:127] op_sel_hi:[1,0]
    v_cvt_pk_bf16_f32 v111, v94, v95
    v_lshlrev_b32 v94, 16, v111
    v_and_b32 v95, s40, v111
    v_pk_add_f32 v[96:97], v[80:81], v[120:121] op_sel_hi:[1,0] neg_lo:[0,1] neg_hi:[0,1]
    v_cvt_pk_bf16_f32 v104, v96, v97
    v_lshlrev_b32 v96, 16, v104
    v_and_b32 v97, s40, v104
    v_pk_mul_f32 v[96:97], v[96:97], v[126:127] op_sel_hi:[1,0]
    v_cvt_pk_bf16_f32 v108, v96, v97
    v_lshlrev_b32 v96, 16, v108
    v_and_b32 v97, s40, v108
    v_pk_add_f32 v[98:99], v[82:83], v[120:121] op_sel_hi:[1,0] neg_lo:[0,1] neg_hi:[0,1]
    v_cvt_pk_bf16_f32 v105, v98, v99
    v_lshlrev_b32 v98, 16, v105
    v_and_b32 v99, s40, v105
    v_pk_mul_f32 v[98:99], v[98:99], v[126:127] op_sel_hi:[1,0]
    v_cvt_pk_bf16_f32 v109, v98, v99
    v_lshlrev_b32 v98, 16, v109
    v_and_b32 v99, s40, v109
    v_pk_add_f32 v[100:101], v[84:85], v[120:121] op_sel_hi:[1,0] neg_lo:[0,1] neg_hi:[0,1]
    v_cvt_pk_bf16_f32 v106, v100, v101
    v_lshlrev_b32 v100, 16, v106
    v_and_b32 v101, s40, v106
    v_pk_mul_f32 v[100:101], v[100:101], v[126:127] op_sel_hi:[1,0]
    v_cvt_pk_bf16_f32 v110, v100, v101
    v_lshlrev_b32 v100, 16, v110
    v_and_b32 v101, s40, v110
    v_pk_add_f32 v[102:103], v[86:87], v[120:121] op_sel_hi:[1,0] neg_lo:[0,1] neg_hi:[0,1]
    v_cvt_pk_bf16_f32 v107, v102, v103
    v_lshlrev_b32 v102, 16, v107
    v_and_b32 v103, s40, v107
    v_pk_mul_f32 v[102:103], v[102:103], v[126:127] op_sel_hi:[1,0]
    v_cvt_pk_bf16_f32 v111, v102, v103
    v_lshlrev_b32 v102, 16, v111
    v_and_b32 v103, s40, v111
    s_load_dwordx2 s[64:65], s[0:1], 56
    s_load_dwordx2 s[66:67], s[0:1], 64
    v_mbcnt_lo_u32_b32 v134, -1, 0
    v_mbcnt_hi_u32_b32 v134, -1, v134
    s_and_b32 s69, s16, 3
    s_mul_i32 s68, s69, 3
    s_min_u32 s69, s69, 2
    s_add_u32 s68, s68, s69
    s_lshl_b32 s68, s68, 6
    s_mul_i32 s69, s3, 448
    v_add_u32 v130, s68, v134
    v_mul_u32_u24 v131, 2341, v130
    v_lshrrev_b32 v131, 16, v131
    v_mul_u32_u24 v132, 28, v131
    v_sub_u32 v132, v130, v132
    v_lshrrev_b32 v133, 2, v131
    v_and_b32 v133, 1, v133
    v_lshlrev_b32 v133, 1, v133
    v_xor_b32 v132, v132, v133
    v_lshlrev_b32 v132, 4, v132
    v_mul_u32_u24 v131, 7168, v131
    v_add3_u32 v140, v131, v132, s69
    v_add_u32 v130, s68, v134
    v_add_u32 v130, 64, v130
    v_mul_u32_u24 v131, 2341, v130
    v_lshrrev_b32 v131, 16, v131
    v_mul_u32_u24 v132, 28, v131
    v_sub_u32 v132, v130, v132
    v_lshrrev_b32 v133, 2, v131
    v_and_b32 v133, 1, v133
    v_lshlrev_b32 v133, 1, v133
    v_xor_b32 v132, v132, v133
    v_lshlrev_b32 v132, 4, v132
    v_mul_u32_u24 v131, 7168, v131
    v_add3_u32 v141, v131, v132, s69
    v_add_u32 v130, s68, v134
    v_add_u32 v130, 128, v130
    v_mul_u32_u24 v131, 2341, v130
    v_lshrrev_b32 v131, 16, v131
    v_mul_u32_u24 v132, 28, v131
    v_sub_u32 v132, v130, v132
    v_lshrrev_b32 v133, 2, v131
    v_and_b32 v133, 1, v133
    v_lshlrev_b32 v133, 1, v133
    v_xor_b32 v132, v132, v133
    v_lshlrev_b32 v132, 4, v132
    v_mul_u32_u24 v131, 7168, v131
    v_add3_u32 v142, v131, v132, s69
    v_add_u32 v130, s68, v134
    v_add_u32 v130, 192, v130
    v_mul_u32_u24 v131, 2341, v130
    v_lshrrev_b32 v131, 16, v131
    v_mul_u32_u24 v132, 28, v131
    v_sub_u32 v132, v130, v132
    v_lshrrev_b32 v133, 2, v131
    v_and_b32 v133, 1, v133
    v_lshlrev_b32 v133, 1, v133
    v_xor_b32 v132, v132, v133
    v_lshlrev_b32 v132, 4, v132
    v_mul_u32_u24 v131, 7168, v131
    v_add3_u32 v143, v131, v132, s69
    s_and_b32 s69, s16, 3
    s_cmp_ge_u32 s69, 2
    s_cselect_b32 s69, 0x40000000, 0
    v_add_u32 v143, s69, v143
    s_waitcnt lgkmcnt(0)
    s_cmp_ge_u32 s16, 4
    s_cselect_b32 s64, s66, s64
    s_cselect_b32 s65, s67, s65
    s_mov_b32 s60, s64
    s_and_b32 s61, s65, 0xffff
    s_mov_b32 s62, 7340032
    s_mov_b32 s63, 0x00020000
    s_and_b32 s69, s16, 3
    s_mul_i32 s68, s69, 3
    s_min_u32 s69, s69, 2
    s_add_u32 s68, s68, s69
    s_lshl_b32 s68, s68, 10
    s_add_u32 s68, s68, 8192
    s_cmp_ge_u32 s16, 4
    s_cselect_b32 s69, 14336, 0
    s_add_u32 s68, s68, s69
    s_and_b32 s70, s16, 3
    s_cmp_ge_u32 s70, 2
    s_cselect_b32 s70, 1, 0
    s_mov_b32 s69, 0
    s_add_u32 m0, s68, 0
    s_nop 0
    buffer_load_dwordx4 v140, s[60:63], s69 offen lds
    s_add_u32 m0, s68, 1024
    s_nop 0
    buffer_load_dwordx4 v141, s[60:63], s69 offen lds
    s_add_u32 m0, s68, 2048
    s_nop 0
    buffer_load_dwordx4 v142, s[60:63], s69 offen lds
    s_add_u32 m0, s68, 3072
    s_cmp_eq_u32 s70, 1
    s_cselect_b32 m0, 110592, m0
    s_nop 0
    buffer_load_dwordx4 v143, s[60:63], s69 offen lds
    s_mov_b32 s69, 229376
    s_add_u32 m0, s68, 36864
    s_nop 0
    buffer_load_dwordx4 v140, s[60:63], s69 offen lds
    s_add_u32 m0, s68, 37888
    s_nop 0
    buffer_load_dwordx4 v141, s[60:63], s69 offen lds
    s_add_u32 m0, s68, 38912
    s_nop 0
    buffer_load_dwordx4 v142, s[60:63], s69 offen lds
    s_add_u32 m0, s68, 39936
    s_cmp_eq_u32 s70, 1
    s_cselect_b32 m0, 110592, m0
    s_nop 0
    buffer_load_dwordx4 v143, s[60:63], s69 offen lds
    s_mov_b32 s69, 458752
    s_add_u32 m0, s68, 73728
    s_nop 0
    buffer_load_dwordx4 v140, s[60:63], s69 offen lds
    s_add_u32 m0, s68, 74752
    s_nop 0
    buffer_load_dwordx4 v141, s[60:63], s69 offen lds
    s_add_u32 m0, s68, 75776
    s_nop 0
    buffer_load_dwordx4 v142, s[60:63], s69 offen lds
    s_add_u32 m0, s68, 76800
    s_cmp_eq_u32 s70, 1
    s_cselect_b32 m0, 110592, m0
    s_nop 0
    buffer_load_dwordx4 v143, s[60:63], s69 offen lds
    s_mov_b32 s69, 688128
    s_add_u32 m0, s68, 110592
    s_nop 0
    buffer_load_dwordx4 v140, s[60:63], s69 offen lds
    s_add_u32 m0, s68, 111616
    s_nop 0
    buffer_load_dwordx4 v141, s[60:63], s69 offen lds
    s_add_u32 m0, s68, 112640
    s_nop 0
    buffer_load_dwordx4 v142, s[60:63], s69 offen lds
    s_add_u32 m0, s68, 113664
    s_cmp_eq_u32 s70, 1
    s_cselect_b32 m0, 110592, m0
    s_nop 0
    buffer_load_dwordx4 v143, s[60:63], s69 offen lds
    s_lshl_b32 s18, s16, 5
    v_and_b32 v5, 31, v2
    v_add_u32 v5, s18, v5
    v_lshlrev_b32 v5, 7, v5
    s_mov_b32 s55, 200000
    s_add_u32 s46, s93, 2
Lpoll_22:
    buffer_load_dword v6, v5, s[76:79], 0 offen sc1
    s_waitcnt vmcnt(0)
    v_subrev_u32 v6, s46, v6
    v_cmp_gt_u32 vcc, 6, v6
    s_nop 1
    s_cmp_eq_u64 vcc, -1
    s_cbranch_scc1 Lpd_23
    s_sub_u32 s55, s55, 1
    s_cmp_lg_u32 s55, 0
    s_sleep 1
    s_cbranch_scc1 Lpoll_22
Lpd_23:
    s_barrier
    s_cmp_ge_u32 s16, 4
    s_cbranch_scc1 Llna_24
    v_lshlrev_b32 v5, 4, v0
    s_mov_b32 s18, 0
    s_mov_b32 s19, 24576
    buffer_load_dwordx4 v[24:27], v5, s[12:15], s18 offen sc1
    buffer_load_dwordx4 v[44:47], v5, s[12:15], s19 offen sc1
    s_mov_b32 s18, 4096
    s_mov_b32 s19, 28672
    buffer_load_dwordx4 v[28:31], v5, s[12:15], s18 offen sc1
    buffer_load_dwordx4 v[48:51], v5, s[12:15], s19 offen sc1
    s_mov_b32 s18, 8192
    s_mov_b32 s19, 32768
    buffer_load_dwordx4 v[32:35], v5, s[12:15], s18 offen sc1
    buffer_load_dwordx4 v[52:55], v5, s[12:15], s19 offen sc1
    s_mov_b32 s18, 12288
    s_mov_b32 s19, 36864
    buffer_load_dwordx4 v[36:39], v5, s[12:15], s18 offen sc1
    buffer_load_dwordx4 v[56:59], v5, s[12:15], s19 offen sc1
    s_mov_b32 s18, 16384
    s_mov_b32 s19, 40960
    buffer_load_dwordx4 v[40:43], v5, s[12:15], s18 offen sc1
    buffer_load_dwordx4 v[60:63], v5, s[12:15], s19 offen sc1
    s_waitcnt vmcnt(0)
    v_add_u32 v6, 65536, v5
    v_pk_add_f32 v[24:25], v[24:25], v[44:45]
    v_cvt_pk_bf16_f32 v64, v24, v25
    v_lshlrev_b32 v24, 16, v64
    v_and_b32 v25, s40, v64
    v_pk_add_f32 v[26:27], v[26:27], v[46:47]
    v_cvt_pk_bf16_f32 v65, v26, v27
    v_lshlrev_b32 v26, 16, v65
    v_and_b32 v27, s40, v65
    ds_write_b128 v5, v[24:27] offset:0
    v_pk_add_f32 v[28:29], v[28:29], v[48:49]
    v_cvt_pk_bf16_f32 v64, v28, v29
    v_lshlrev_b32 v28, 16, v64
    v_and_b32 v29, s40, v64
    v_pk_add_f32 v[28:29], v[28:29], 1.0 op_sel_hi:[1,0]
    v_cvt_pk_bf16_f32 v64, v28, v29
    v_lshlrev_b32 v28, 16, v64
    v_and_b32 v29, s40, v64
    v_pk_add_f32 v[30:31], v[30:31], v[50:51]
    v_cvt_pk_bf16_f32 v65, v30, v31
    v_lshlrev_b32 v30, 16, v65
    v_and_b32 v31, s40, v65
    v_pk_add_f32 v[30:31], v[30:31], 1.0 op_sel_hi:[1,0]
    v_cvt_pk_bf16_f32 v65, v30, v31
    v_lshlrev_b32 v30, 16, v65
    v_and_b32 v31, s40, v65
    ds_write_b128 v5, v[28:31] offset:4096
    v_pk_add_f32 v[32:33], v[32:33], v[52:53]
    v_cvt_pk_bf16_f32 v64, v32, v33
    v_lshlrev_b32 v32, 16, v64
    v_and_b32 v33, s40, v64
    v_pk_add_f32 v[34:35], v[34:35], v[54:55]
    v_cvt_pk_bf16_f32 v65, v34, v35
    v_lshlrev_b32 v34, 16, v65
    v_and_b32 v35, s40, v65
    ds_write_b128 v5, v[32:35] offset:36864
    v_pk_add_f32 v[36:37], v[36:37], v[56:57]
    v_cvt_pk_bf16_f32 v64, v36, v37
    v_lshlrev_b32 v36, 16, v64
    v_and_b32 v37, s40, v64
    v_pk_add_f32 v[38:39], v[38:39], v[58:59]
    v_cvt_pk_bf16_f32 v65, v38, v39
    v_lshlrev_b32 v38, 16, v65
    v_and_b32 v39, s40, v65
    ds_write_b128 v5, v[36:39] offset:40960
    v_pk_add_f32 v[40:41], v[40:41], v[60:61]
    v_cvt_pk_bf16_f32 v64, v40, v41
    v_lshlrev_b32 v40, 16, v64
    v_and_b32 v41, s40, v64
    v_pk_add_f32 v[40:41], v[40:41], 1.0 op_sel_hi:[1,0]
    v_cvt_pk_bf16_f32 v64, v40, v41
    v_lshlrev_b32 v40, 16, v64
    v_and_b32 v41, s40, v64
    v_pk_add_f32 v[42:43], v[42:43], v[62:63]
    v_cvt_pk_bf16_f32 v65, v42, v43
    v_lshlrev_b32 v42, 16, v65
    v_and_b32 v43, s40, v65
    v_pk_add_f32 v[42:43], v[42:43], 1.0 op_sel_hi:[1,0]
    v_cvt_pk_bf16_f32 v65, v42, v43
    v_lshlrev_b32 v42, 16, v65
    v_and_b32 v43, s40, v65
    ds_write_b128 v6, v[40:43] offset:8192
    s_branch Llnj_25
Llna_24:
    v_subrev_u32 v3, 256, v0
    v_lshlrev_b32 v5, 14, v3
    s_lshl_b32 s18, s17, 4
    v_add_u32 v5, s18, v5
    s_mov_b32 s18, 0
    buffer_load_dwordx4 v[24:27], v5, s[8:11], s18 offen sc1
    s_mov_b32 s18, 4096
    buffer_load_dwordx4 v[28:31], v5, s[8:11], s18 offen sc1
    s_mov_b32 s18, 8192
    buffer_load_dwordx4 v[32:35], v5, s[8:11], s18 offen sc1
    s_mov_b32 s18, 12288
    buffer_load_dwordx4 v[36:39], v5, s[8:11], s18 offen sc1
    s_mov_b32 s18, 0x05040100
    s_mov_b32 s19, 0x07060302
    v_lshlrev_b32 v6, 3, v3
    v_add_u32 v6, 147456, v6
    s_waitcnt vmcnt(0)
    v_perm_b32 v40, v28, v24, s18
    v_perm_b32 v41, v36, v32, s18
    ds_write_b64 v6, v[40:41] offset:0
    v_perm_b32 v42, v28, v24, s19
    v_perm_b32 v43, v36, v32, s19
    ds_write_b64 v6, v[42:43] offset:2048
    v_perm_b32 v44, v29, v25, s18
    v_perm_b32 v45, v37, v33, s18
    ds_write_b64 v6, v[44:45] offset:4096
    v_perm_b32 v46, v29, v25, s19
    v_perm_b32 v47, v37, v33, s19
    ds_write_b64 v6, v[46:47] offset:6144
    v_perm_b32 v40, v30, v26, s18
    v_perm_b32 v41, v38, v34, s18
    ds_write_b64 v6, v[40:41] offset:8192
    v_perm_b32 v42, v30, v26, s19
    v_perm_b32 v43, v38, v34, s19
    ds_write_b64 v6, v[42:43] offset:10240
    v_perm_b32 v44, v31, v27, s18
    v_perm_b32 v45, v39, v35, s18
    ds_write_b64 v6, v[44:45] offset:12288
    v_perm_b32 v46, v31, v27, s19
    v_perm_b32 v47, v39, v35, s19
    ds_write_b64 v6, v[46:47] offset:14336
Llnj_25:
    s_waitcnt lgkmcnt(0)
    s_barrier
    s_lshl_b32 s18, s16, 11
    s_add_u32 s18, s18, 147456
    v_lshlrev_b32 v6, 4, v2
    v_add_u32 v6, s18, v6
    ds_read_b128 v[16:19], v6 offset:0
    ds_read_b128 v[20:23], v6 offset:1024
    v_lshlrev_b32 v5, 5, v2
    v_add_u32 v7, 65536, v5
    ds_read_b128 v[24:27], v5 offset:0
    ds_read_b128 v[28:31], v5 offset:16
    ds_read_b128 v[32:35], v5 offset:2048
    ds_read_b128 v[36:39], v5 offset:2064
    ds_read_b128 v[40:43], v5 offset:4096
    ds_read_b128 v[44:47], v5 offset:4112
    ds_read_b128 v[48:51], v5 offset:6144
    ds_read_b128 v[52:55], v5 offset:6160
    ds_read_b128 v[56:59], v5 offset:36864
    ds_read_b128 v[60:63], v5 offset:36880
    ds_read_b128 v[64:67], v5 offset:38912
    ds_read_b128 v[68:71], v5 offset:38928
    s_waitcnt lgkmcnt(0)
    s_barrier
    v_pk_mul_f32 v[88:89], v[88:89], v[40:41]
    v_cvt_pk_bf16_f32 v104, v88, v89
    v_lshlrev_b32 v88, 16, v104
    v_and_b32 v89, s40, v104
    v_pk_add_f32 v[88:89], v[88:89], v[24:25]
    v_cvt_pk_bf16_f32 v104, v88, v89
    v_lshlrev_b32 v88, 16, v104
    v_and_b32 v89, s40, v104
    v_lshlrev_b32 v112, 16, v16
    v_and_b32 v113, s40, v16
    v_pk_mul_f32 v[88:89], v[88:89], v[112:113]
    v_cvt_pk_bf16_f32 v104, v88, v89
    v_lshlrev_b32 v88, 16, v104
    v_and_b32 v89, s40, v104
    v_pk_mul_f32 v[88:89], v[88:89], v[56:57]
    v_cvt_pk_bf16_f32 v104, v88, v89
    v_lshlrev_b32 v88, 16, v104
    v_and_b32 v89, s40, v104
    v_pk_add_f32 v[72:73], v[72:73], v[88:89]
    v_cvt_pk_bf16_f32 v8, v72, v73
    v_lshlrev_b32 v72, 16, v8
    v_and_b32 v73, s40, v8
    v_pk_mul_f32 v[90:91], v[90:91], v[42:43]
    v_cvt_pk_bf16_f32 v105, v90, v91
    v_lshlrev_b32 v90, 16, v105
    v_and_b32 v91, s40, v105
    v_pk_add_f32 v[90:91], v[90:91], v[26:27]
    v_cvt_pk_bf16_f32 v105, v90, v91
    v_lshlrev_b32 v90, 16, v105
    v_and_b32 v91, s40, v105
    v_lshlrev_b32 v114, 16, v17
    v_and_b32 v115, s40, v17
    v_pk_mul_f32 v[90:91], v[90:91], v[114:115]
    v_cvt_pk_bf16_f32 v105, v90, v91
    v_lshlrev_b32 v90, 16, v105
    v_and_b32 v91, s40, v105
    v_pk_mul_f32 v[90:91], v[90:91], v[58:59]
    v_cvt_pk_bf16_f32 v105, v90, v91
    v_lshlrev_b32 v90, 16, v105
    v_and_b32 v91, s40, v105
    v_pk_add_f32 v[74:75], v[74:75], v[90:91]
    v_cvt_pk_bf16_f32 v9, v74, v75
    v_lshlrev_b32 v74, 16, v9
    v_and_b32 v75, s40, v9
    v_pk_mul_f32 v[92:93], v[92:93], v[44:45]
    v_cvt_pk_bf16_f32 v106, v92, v93
    v_lshlrev_b32 v92, 16, v106
    v_and_b32 v93, s40, v106
    v_pk_add_f32 v[92:93], v[92:93], v[28:29]
    v_cvt_pk_bf16_f32 v106, v92, v93
    v_lshlrev_b32 v92, 16, v106
    v_and_b32 v93, s40, v106
    v_lshlrev_b32 v116, 16, v18
    v_and_b32 v117, s40, v18
    v_pk_mul_f32 v[92:93], v[92:93], v[116:117]
    v_cvt_pk_bf16_f32 v106, v92, v93
    v_lshlrev_b32 v92, 16, v106
    v_and_b32 v93, s40, v106
    v_pk_mul_f32 v[92:93], v[92:93], v[60:61]
    v_cvt_pk_bf16_f32 v106, v92, v93
    v_lshlrev_b32 v92, 16, v106
    v_and_b32 v93, s40, v106
    v_pk_add_f32 v[76:77], v[76:77], v[92:93]
    v_cvt_pk_bf16_f32 v10, v76, v77
    v_lshlrev_b32 v76, 16, v10
    v_and_b32 v77, s40, v10
    v_pk_mul_f32 v[94:95], v[94:95], v[46:47]
    v_cvt_pk_bf16_f32 v107, v94, v95
    v_lshlrev_b32 v94, 16, v107
    v_and_b32 v95, s40, v107
    v_pk_add_f32 v[94:95], v[94:95], v[30:31]
    v_cvt_pk_bf16_f32 v107, v94, v95
    v_lshlrev_b32 v94, 16, v107
    v_and_b32 v95, s40, v107
    v_lshlrev_b32 v118, 16, v19
    v_and_b32 v119, s40, v19
    v_pk_mul_f32 v[94:95], v[94:95], v[118:119]
    v_cvt_pk_bf16_f32 v107, v94, v95
    v_lshlrev_b32 v94, 16, v107
    v_and_b32 v95, s40, v107
    v_pk_mul_f32 v[94:95], v[94:95], v[62:63]
    v_cvt_pk_bf16_f32 v107, v94, v95
    v_lshlrev_b32 v94, 16, v107
    v_and_b32 v95, s40, v107
    v_pk_add_f32 v[78:79], v[78:79], v[94:95]
    v_cvt_pk_bf16_f32 v11, v78, v79
    v_lshlrev_b32 v78, 16, v11
    v_and_b32 v79, s40, v11
    v_pk_mul_f32 v[96:97], v[96:97], v[48:49]
    v_cvt_pk_bf16_f32 v104, v96, v97
    v_lshlrev_b32 v96, 16, v104
    v_and_b32 v97, s40, v104
    v_pk_add_f32 v[96:97], v[96:97], v[32:33]
    v_cvt_pk_bf16_f32 v104, v96, v97
    v_lshlrev_b32 v96, 16, v104
    v_and_b32 v97, s40, v104
    v_lshlrev_b32 v112, 16, v20
    v_and_b32 v113, s40, v20
    v_pk_mul_f32 v[96:97], v[96:97], v[112:113]
    v_cvt_pk_bf16_f32 v104, v96, v97
    v_lshlrev_b32 v96, 16, v104
    v_and_b32 v97, s40, v104
    v_pk_mul_f32 v[96:97], v[96:97], v[64:65]
    v_cvt_pk_bf16_f32 v104, v96, v97
    v_lshlrev_b32 v96, 16, v104
    v_and_b32 v97, s40, v104
    v_pk_add_f32 v[80:81], v[80:81], v[96:97]
    v_cvt_pk_bf16_f32 v12, v80, v81
    v_lshlrev_b32 v80, 16, v12
    v_and_b32 v81, s40, v12
    v_pk_mul_f32 v[98:99], v[98:99], v[50:51]
    v_cvt_pk_bf16_f32 v105, v98, v99
    v_lshlrev_b32 v98, 16, v105
    v_and_b32 v99, s40, v105
    v_pk_add_f32 v[98:99], v[98:99], v[34:35]
    v_cvt_pk_bf16_f32 v105, v98, v99
    v_lshlrev_b32 v98, 16, v105
    v_and_b32 v99, s40, v105
    v_lshlrev_b32 v114, 16, v21
    v_and_b32 v115, s40, v21
    v_pk_mul_f32 v[98:99], v[98:99], v[114:115]
    v_cvt_pk_bf16_f32 v105, v98, v99
    v_lshlrev_b32 v98, 16, v105
    v_and_b32 v99, s40, v105
    v_pk_mul_f32 v[98:99], v[98:99], v[66:67]
    v_cvt_pk_bf16_f32 v105, v98, v99
    v_lshlrev_b32 v98, 16, v105
    v_and_b32 v99, s40, v105
    v_pk_add_f32 v[82:83], v[82:83], v[98:99]
    v_cvt_pk_bf16_f32 v13, v82, v83
    v_lshlrev_b32 v82, 16, v13
    v_and_b32 v83, s40, v13
    v_pk_mul_f32 v[100:101], v[100:101], v[52:53]
    v_cvt_pk_bf16_f32 v106, v100, v101
    v_lshlrev_b32 v100, 16, v106
    v_and_b32 v101, s40, v106
    v_pk_add_f32 v[100:101], v[100:101], v[36:37]
    v_cvt_pk_bf16_f32 v106, v100, v101
    v_lshlrev_b32 v100, 16, v106
    v_and_b32 v101, s40, v106
    v_lshlrev_b32 v116, 16, v22
    v_and_b32 v117, s40, v22
    v_pk_mul_f32 v[100:101], v[100:101], v[116:117]
    v_cvt_pk_bf16_f32 v106, v100, v101
    v_lshlrev_b32 v100, 16, v106
    v_and_b32 v101, s40, v106
    v_pk_mul_f32 v[100:101], v[100:101], v[68:69]
    v_cvt_pk_bf16_f32 v106, v100, v101
    v_lshlrev_b32 v100, 16, v106
    v_and_b32 v101, s40, v106
    v_pk_add_f32 v[84:85], v[84:85], v[100:101]
    v_cvt_pk_bf16_f32 v14, v84, v85
    v_lshlrev_b32 v84, 16, v14
    v_and_b32 v85, s40, v14
    v_pk_mul_f32 v[102:103], v[102:103], v[54:55]
    v_cvt_pk_bf16_f32 v107, v102, v103
    v_lshlrev_b32 v102, 16, v107
    v_and_b32 v103, s40, v107
    v_pk_add_f32 v[102:103], v[102:103], v[38:39]
    v_cvt_pk_bf16_f32 v107, v102, v103
    v_lshlrev_b32 v102, 16, v107
    v_and_b32 v103, s40, v107
    v_lshlrev_b32 v118, 16, v23
    v_and_b32 v119, s40, v23
    v_pk_mul_f32 v[102:103], v[102:103], v[118:119]
    v_cvt_pk_bf16_f32 v107, v102, v103
    v_lshlrev_b32 v102, 16, v107
    v_and_b32 v103, s40, v107
    v_pk_mul_f32 v[102:103], v[102:103], v[70:71]
    v_cvt_pk_bf16_f32 v107, v102, v103
    v_lshlrev_b32 v102, 16, v107
    v_and_b32 v103, s40, v107
    v_pk_add_f32 v[86:87], v[86:87], v[102:103]
    v_cvt_pk_bf16_f32 v15, v86, v87
    v_lshlrev_b32 v86, 16, v15
    v_and_b32 v87, s40, v15
    buffer_store_dwordx4 v[8:11], v4, s[20:23], 0 offen offset:0 sc1
    buffer_store_dwordx4 v[12:15], v4, s[20:23], 0 offen offset:1024 sc1
    ds_read_b128 v[24:27], v5 offset:40960
    ds_read_b128 v[28:31], v5 offset:40976
    ds_read_b128 v[32:35], v5 offset:43008
    ds_read_b128 v[36:39], v5 offset:43024
    ds_read_b128 v[40:43], v7 offset:8192
    ds_read_b128 v[44:47], v7 offset:8208
    ds_read_b128 v[48:51], v7 offset:10240
    ds_read_b128 v[52:55], v7 offset:10256
    v_pk_add_f32 v[104:105], v[72:73], v[74:75]
    v_pk_add_f32 v[106:107], v[76:77], v[78:79]
    v_pk_add_f32 v[104:105], v[104:105], v[80:81]
    v_pk_add_f32 v[106:107], v[106:107], v[82:83]
    v_pk_add_f32 v[104:105], v[104:105], v[84:85]
    v_pk_add_f32 v[106:107], v[106:107], v[86:87]
    v_pk_add_f32 v[104:105], v[104:105], v[106:107]
    v_add_f32 v104, v104, v105
    s_nop 1
    v_add_f32_dpp v104, v104, v104 quad_perm:[1,0,3,2] row_mask:0xf bank_mask:0xf
    s_nop 1
    v_add_f32_dpp v104, v104, v104 quad_perm:[2,3,0,1] row_mask:0xf bank_mask:0xf
    s_nop 1
    v_add_f32_dpp v104, v104, v104 row_half_mirror row_mask:0xf bank_mask:0xf
    s_nop 1
    v_add_f32_dpp v104, v104, v104 row_mirror row_mask:0xf bank_mask:0xf
    s_nop 1
    v_add_f32_dpp v104, v104, v104 row_bcast:15 row_mask:0xa bank_mask:0xf
    s_nop 1
    v_add_f32_dpp v104, v104, v104 row_bcast:31 row_mask:0xc bank_mask:0xf
    s_nop 1
    v_readlane_b32 s44, v104, 63
    s_nop 1
    v_mov_b32 v120, s44
    v_mul_f32 v120, 0x3a800000, v120
    v_pk_add_f32 v[88:89], v[72:73], v[120:121] op_sel_hi:[1,0] neg_lo:[0,1] neg_hi:[0,1]
    v_pk_add_f32 v[90:91], v[74:75], v[120:121] op_sel_hi:[1,0] neg_lo:[0,1] neg_hi:[0,1]
    v_pk_add_f32 v[92:93], v[76:77], v[120:121] op_sel_hi:[1,0] neg_lo:[0,1] neg_hi:[0,1]
    v_pk_add_f32 v[94:95], v[78:79], v[120:121] op_sel_hi:[1,0] neg_lo:[0,1] neg_hi:[0,1]
    v_pk_add_f32 v[96:97], v[80:81], v[120:121] op_sel_hi:[1,0] neg_lo:[0,1] neg_hi:[0,1]
    v_pk_add_f32 v[98:99], v[82:83], v[120:121] op_sel_hi:[1,0] neg_lo:[0,1] neg_hi:[0,1]
    v_pk_add_f32 v[100:101], v[84:85], v[120:121] op_sel_hi:[1,0] neg_lo:[0,1] neg_hi:[0,1]
    v_pk_add_f32 v[102:103], v[86:87], v[120:121] op_sel_hi:[1,0] neg_lo:[0,1] neg_hi:[0,1]
    v_pk_mul_f32 v[104:105], v[88:89], v[88:89]
    v_pk_mul_f32 v[106:107], v[90:91], v[90:91]
    v_pk_fma_f32 v[104:105], v[92:93], v[92:93], v[104:105]
    v_pk_fma_f32 v[106:107], v[94:95], v[94:95], v[106:107]
    v_pk_fma_f32 v[104:105], v[96:97], v[96:97], v[104:105]
    v_pk_fma_f32 v[106:107], v[98:99], v[98:99], v[106:107]
    v_pk_fma_f32 v[104:105], v[100:101], v[100:101], v[104:105]
    v_pk_fma_f32 v[106:107], v[102:103], v[102:103], v[106:107]
    v_pk_add_f32 v[104:105], v[104:105], v[106:107]
    v_add_f32 v104, v104, v105
    s_nop 1
    v_add_f32_dpp v104, v104, v104 quad_perm:[1,0,3,2] row_mask:0xf bank_mask:0xf
    s_nop 1
    v_add_f32_dpp v104, v104, v104 quad_perm:[2,3,0,1] row_mask:0xf bank_mask:0xf
    s_nop 1
    v_add_f32_dpp v104, v104, v104 row_half_mirror row_mask:0xf bank_mask:0xf
    s_nop 1
    v_add_f32_dpp v104, v104, v104 row_mirror row_mask:0xf bank_mask:0xf
    s_nop 1
    v_add_f32_dpp v104, v104, v104 row_bcast:15 row_mask:0xa bank_mask:0xf
    s_nop 1
    v_add_f32_dpp v104, v104, v104 row_bcast:31 row_mask:0xc bank_mask:0xf
    s_nop 1
    v_readlane_b32 s44, v104, 63
    s_nop 1
    v_mov_b32 v124, s44
    v_mul_f32 v124, 0x3a800000, v124
    v_cvt_pk_bf16_f32 v104, v124, v120
    v_lshlrev_b32 v124, 16, v104
    v_and_b32 v120, s40, v104
    v_add_f32 v124, 0x3727c5ac, v124
    v_cvt_pk_bf16_f32 v104, v124, v125
    v_lshlrev_b32 v124, 16, v104
    v_and_b32 v125, s40, v104
    v_sqrt_f32 v124, v124
    s_nop 0
    v_cvt_pk_bf16_f32 v104, v124, v125
    v_lshlrev_b32 v124, 16, v104
    v_and_b32 v125, s40, v104
    v_rcp_f32 v126, v124
    s_nop 0
    v_pk_add_f32 v[88:89], v[72:73], v[120:121] op_sel_hi:[1,0] neg_lo:[0,1] neg_hi:[0,1]
    v_cvt_pk_bf16_f32 v104, v88, v89
    v_lshlrev_b32 v88, 16, v104
    v_and_b32 v89, s40, v104
    v_pk_mul_f32 v[88:89], v[88:89], v[126:127] op_sel_hi:[1,0]
    v_cvt_pk_bf16_f32 v108, v88, v89
    v_lshlrev_b32 v88, 16, v108
    v_and_b32 v89, s40, v108
    v_pk_add_f32 v[90:91], v[74:75], v[120:121] op_sel_hi:[1,0] neg_lo:[0,1] neg_hi:[0,1]
    v_cvt_pk_bf16_f32 v105, v90, v91
    v_lshlrev_b32 v90, 16, v105
    v_and_b32 v91, s40, v105
    v_pk_mul_f32 v[90:91], v[90:91], v[126:127] op_sel_hi:[1,0]
    v_cvt_pk_bf16_f32 v109, v90, v91
    v_lshlrev_b32 v90, 16, v109
    v_and_b32 v91, s40, v109
    v_pk_add_f32 v[92:93], v[76:77], v[120:121] op_sel_hi:[1,0] neg_lo:[0,1] neg_hi:[0,1]
    v_cvt_pk_bf16_f32 v106, v92, v93
    v_lshlrev_b32 v92, 16, v106
    v_and_b32 v93, s40, v106
    v_pk_mul_f32 v[92:93], v[92:93], v[126:127] op_sel_hi:[1,0]
    v_cvt_pk_bf16_f32 v110, v92, v93
    v_lshlrev_b32 v92, 16, v110
    v_and_b32 v93, s40, v110
    v_pk_add_f32 v[94:95], v[78:79], v[120:121] op_sel_hi:[1,0] neg_lo:[0,1] neg_hi:[0,1]
    v_cvt_pk_bf16_f32 v107, v94, v95
    v_lshlrev_b32 v94, 16, v107
    v_and_b32 v95, s40, v107
    v_pk_mul_f32 v[94:95], v[94:95], v[126:127] op_sel_hi:[1,0]
    v_cvt_pk_bf16_f32 v111, v94, v95
    v_lshlrev_b32 v94, 16, v111
    v_and_b32 v95, s40, v111
    v_pk_add_f32 v[96:97], v[80:81], v[120:121] op_sel_hi:[1,0] neg_lo:[0,1] neg_hi:[0,1]
    v_cvt_pk_bf16_f32 v104, v96, v97
    v_lshlrev_b32 v96, 16, v104
    v_and_b32 v97, s40, v104
    v_pk_mul_f32 v[96:97], v[96:97], v[126:127] op_sel_hi:[1,0]
    v_cvt_pk_bf16_f32 v108, v96, v97
    v_lshlrev_b32 v96, 16, v108
    v_and_b32 v97, s40, v108
    v_pk_add_f32 v[98:99], v[82:83], v[120:121] op_sel_hi:[1,0] neg_lo:[0,1] neg_hi:[0,1]
    v_cvt_pk_bf16_f32 v105, v98, v99
    v_lshlrev_b32 v98, 16, v105
    v_and_b32 v99, s40, v105
    v_pk_mul_f32 v[98:99], v[98:99], v[126:127] op_sel_hi:[1,0]
    v_cvt_pk_bf16_f32 v109, v98, v99
    v_lshlrev_b32 v98, 16, v109
    v_and_b32 v99, s40, v109
    v_pk_add_f32 v[100:101], v[84:85], v[120:121] op_sel_hi:[1,0] neg_lo:[0,1] neg_hi:[0,1]
    v_cvt_pk_bf16_f32 v106, v100, v101
    v_lshlrev_b32 v100, 16, v106
    v_and_b32 v101, s40, v106
    v_pk_mul_f32 v[100:101], v[100:101], v[126:127] op_sel_hi:[1,0]
    v_cvt_pk_bf16_f32 v110, v100, v101
    v_lshlrev_b32 v100, 16, v110
    v_and_b32 v101, s40, v110
    v_pk_add_f32 v[102:103], v[86:87], v[120:121] op_sel_hi:[1,0] neg_lo:[0,1] neg_hi:[0,1]
    v_cvt_pk_bf16_f32 v107, v102, v103
    v_lshlrev_b32 v102, 16, v107
    v_and_b32 v103, s40, v107
    v_pk_mul_f32 v[102:103], v[102:103], v[126:127] op_sel_hi:[1,0]
    v_cvt_pk_bf16_f32 v111, v102, v103
    v_lshlrev_b32 v102, 16, v111
    v_and_b32 v103, s40, v111
    s_waitcnt lgkmcnt(0)
    v_pk_mul_f32 v[88:89], v[88:89], v[40:41]
    v_cvt_pk_bf16_f32 v104, v88, v89
    v_lshlrev_b32 v88, 16, v104
    v_and_b32 v89, s40, v104
    v_pk_add_f32 v[88:89], v[88:89], v[24:25]
    v_cvt_pk_bf16_f32 v16, v88, v89
    v_pk_mul_f32 v[90:91], v[90:91], v[42:43]
    v_cvt_pk_bf16_f32 v105, v90, v91
    v_lshlrev_b32 v90, 16, v105
    v_and_b32 v91, s40, v105
    v_pk_add_f32 v[90:91], v[90:91], v[26:27]
    v_cvt_pk_bf16_f32 v17, v90, v91
    v_pk_mul_f32 v[92:93], v[92:93], v[44:45]
    v_cvt_pk_bf16_f32 v106, v92, v93
    v_lshlrev_b32 v92, 16, v106
    v_and_b32 v93, s40, v106
    v_pk_add_f32 v[92:93], v[92:93], v[28:29]
    v_cvt_pk_bf16_f32 v18, v92, v93
    v_pk_mul_f32 v[94:95], v[94:95], v[46:47]
    v_cvt_pk_bf16_f32 v107, v94, v95
    v_lshlrev_b32 v94, 16, v107
    v_and_b32 v95, s40, v107
    v_pk_add_f32 v[94:95], v[94:95], v[30:31]
    v_cvt_pk_bf16_f32 v19, v94, v95
    v_pk_mul_f32 v[96:97], v[96:97], v[48:49]
    v_cvt_pk_bf16_f32 v104, v96, v97
    v_lshlrev_b32 v96, 16, v104
    v_and_b32 v97, s40, v104
    v_pk_add_f32 v[96:97], v[96:97], v[32:33]
    v_cvt_pk_bf16_f32 v20, v96, v97
    v_pk_mul_f32 v[98:99], v[98:99], v[50:51]
    v_cvt_pk_bf16_f32 v105, v98, v99
    v_lshlrev_b32 v98, 16, v105
    v_and_b32 v99, s40, v105
    v_pk_add_f32 v[98:99], v[98:99], v[34:35]
    v_cvt_pk_bf16_f32 v21, v98, v99
    v_pk_mul_f32 v[100:101], v[100:101], v[52:53]
    v_cvt_pk_bf16_f32 v106, v100, v101
    v_lshlrev_b32 v100, 16, v106
    v_and_b32 v101, s40, v106
    v_pk_add_f32 v[100:101], v[100:101], v[36:37]
    v_cvt_pk_bf16_f32 v22, v100, v101
    v_pk_mul_f32 v[102:103], v[102:103], v[54:55]
    v_cvt_pk_bf16_f32 v107, v102, v103
    v_lshlrev_b32 v102, 16, v107
    v_and_b32 v103, s40, v107
    v_pk_add_f32 v[102:103], v[102:103], v[38:39]
    v_cvt_pk_bf16_f32 v23, v102, v103
    v_lshrrev_b32 v5, 2, v2
    v_lshlrev_b32 v5, 9, v5
    v_and_b32 v6, 1, v2
    v_lshl_add_u32 v5, v6, 8, v5
    v_bfe_u32 v6, v2, 1, 1
    v_lshl_add_u32 v5, v6, 3, v5
    s_lshl_b32 s18, s16, 4
    s_add_u32 s18, s18, 147456
    v_add_u32 v5, s18, v5
    ds_write_b64 v5, v[16:17] offset:0
    ds_write_b64 v5, v[18:19] offset:128
    ds_write_b64 v5, v[20:21] offset:8192
    ds_write_b64 v5, v[22:23] offset:8320
    s_waitcnt lgkmcnt(0)
    s_barrier
    v_lshrrev_b32 v5, 5, v0
    v_lshlrev_b32 v6, 4, v0
    v_add_u32 v6, 147456, v6
    v_lshlrev_b32 v7, 10, v5
    v_bfe_u32 v5, v0, 3, 2
    v_lshl_add_u32 v7, v5, 8, v7
    v_and_b32 v5, 7, v0
    v_lshl_add_u32 v7, v5, 4, v7
    s_lshr_b32 s18, s17, 1
    s_lshl_b32 s18, s18, 15
    s_and_b32 s19, s17, 1
    s_lshl_b32 s19, s19, 7
    s_add_u32 s18, s18, s19
    v_add_u32 v7, s18, v7
    ds_read_b128 v[24:27], v6 offset:0
    ds_read_b128 v[28:31], v6 offset:8192
    s_waitcnt lgkmcnt(1)
    s_mov_b32 s19, 0
    buffer_store_dwordx4 v[24:27], v7, s[24:27], s19 offen sc1
    s_waitcnt lgkmcnt(0)
    s_mov_b32 s19, 16384
    buffer_store_dwordx4 v[28:31], v7, s[24:27], s19 offen sc1
    s_waitcnt vmcnt(0)
    s_barrier
    s_cmp_lg_u32 s16, 0
    s_cbranch_scc1 Lpub_26
    s_lshl_b32 s76, s92, 4
    s_add_u32 s76, s76, s3
    s_lshl_b32 s76, s76, 7
    s_add_u32 s77, s93, 3
    v_mov_b32 v24, s76
    v_mov_b32 v25, s77
    s_mov_b64 exec, 1
    buffer_store_dword v25, v24, s[88:91], 0 offen sc1
    s_mov_b64 exec, -1
Lpub_26:
    s_load_dwordx2 s[32:33], s[0:1], 56
    s_load_dwordx2 s[34:35], s[0:1], 64
    s_load_dwordx2 s[36:37], s[0:1], 112
    s_load_dwordx2 s[38:39], s[0:1], 96
    v_mbcnt_lo_u32_b32 v112, -1, 0
    v_mbcnt_hi_u32_b32 v112, -1, v112
    s_mov_b32 s26, s92
    s_mov_b32 s27, s3
    s_and_b32 s24, s16, 3
    s_lshr_b32 s57, s16, 2
    s_lshr_b32 s28, s24, 1
    s_and_b32 s29, s24, 1
    s_mul_i32 s24, s26, 8
    s_mul_i32 s25, s16, 1
    s_add_u32 s24, s24, s25
    s_mul_i32 s24, s24, 32768
    v_lshlrev_b32 v114, 4, v112
    v_add_u32 v118, s24, v114
    s_and_b32 s24, s16, 3
    s_mul_i32 s20, s24, 3
    s_min_u32 s24, s24, 2
    s_add_u32 s20, s20, s24
    s_lshl_b32 s20, s20, 10
    s_add_u32 s20, s20, 8192
    s_cmp_ge_u32 s16, 4
    s_cselect_b32 s24, 14336, 0
    s_add_u32 s20, s20, s24
    s_and_b32 s41, s16, 3
    s_cmp_ge_u32 s41, 2
    s_cselect_b32 s41, 1, 0
    s_mul_i32 s21, s16, 1024
    s_waitcnt lgkmcnt(0)
    s_add_u32 s8, s36, 9437184
    s_addc_u32 s9, s37, 0
    s_and_b32 s9, s9, 0xffff
    s_mov_b32 s10, 4194304
    s_mov_b32 s11, 0x00020000
    v_and_b32 v114, 15, v112
    s_lshl_b32 s58, s92, 4
    v_add_u32 v114, s58, v114
    v_lshlrev_b32 v114, 7, v114
    s_mov_b32 s59, 200000
    s_add_u32 s76, s93, 3
Lpoll_27:
    buffer_load_dword v115, v114, s[88:91], 0 offen sc1
    s_waitcnt vmcnt(0)
    v_subrev_u32 v115, s76, v115
    v_cmp_gt_u32 vcc, 5, v115
    s_nop 1
    s_cmp_eq_u64 vcc, -1
    s_cbranch_scc1 Lpd_28
    s_sub_u32 s59, s59, 1
    s_cmp_lg_u32 s59, 0
    s_sleep 1
    s_cbranch_scc1 Lpoll_27
Lpd_28:
    s_mov_b32 s18, 0
    s_add_u32 m0, s21, 0
    s_nop 0
    buffer_load_dwordx4 v118, s[8:11], s18 offen sc1 lds
    s_add_u32 s18, s18, 1024
    s_add_u32 m0, s21, 36864
    s_nop 0
    buffer_load_dwordx4 v118, s[8:11], s18 offen sc1 lds
    s_add_u32 s18, s18, 1024
    s_add_u32 m0, s21, 73728
    s_nop 0
    buffer_load_dwordx4 v118, s[8:11], s18 offen sc1 lds
    s_add_u32 s18, s18, 1024
    s_add_u32 m0, s21, 110592
    s_nop 0
    buffer_load_dwordx4 v118, s[8:11], s18 offen sc1 lds
    s_add_u32 s18, s18, 1024
    s_mul_i32 s17, s18, 224
    s_mov_b32 s31, 110592
    s_cmp_ge_u32 s16, 4
    s_cselect_b32 s24, s34, s32
    s_cselect_b32 s25, s35, s33
    s_mov_b32 s4, s24
    s_and_b32 s5, s25, 0xffff
    s_mov_b32 s6, 7340032
    s_mov_b32 s7, 0x00020000
    s_mul_i32 s24, s28, 4096
    v_lshl_add_u32 v119, v112, 4, s24
    v_lshrrev_b32 v114, 2, v112
    v_and_b32 v115, 3, v112
    v_mul_u32_u24 v116, 448, v114
    v_lshl_add_u32 v116, v115, 3, v116
    s_mul_i32 s24, s57, 14336
    s_add_u32 s24, s24, 8192
    v_add_u32 v116, s24, v116
    v_lshrrev_b32 v117, 2, v114
    v_and_b32 v117, 1, v117
    s_mul_i32 s24, s29, 7
    s_add_u32 s25, s24, 0
    v_xor_b32 v115, s25, v117
    v_lshl_add_u32 v120, v115, 5, v116
    s_add_u32 s25, s24, 1
    v_xor_b32 v115, s25, v117
    v_lshl_add_u32 v121, v115, 5, v116
    s_load_dwordx2 s[80:81], s[0:1], 72
    s_and_b32 s24, s16, 3
    s_lshl_b32 s25, s2, 2
    s_add_u32 s24, s24, s25
    s_lshl_b32 s24, s24, 10
    v_lshl_add_u32 v122, v112, 4, s24
    s_lshl_b32 s25, s2, 3
    s_add_u32 s24, s25, s16
    s_lshl_b32 s24, s24, 10
    v_lshl_add_u32 v123, v112, 4, s24
    s_mov_b32 s84, 1835008
    s_mov_b32 s85, 0
    s_waitcnt lgkmcnt(0)
    s_mov_b32 s60, s80
    s_and_b32 s61, s81, 0xffff
    s_mov_b32 s62, 7340032
    s_mov_b32 s63, 0x00020000
    v_mov_b32 v0, 0
    v_mov_b32 v1, 0
    v_mov_b32 v2, 0
    v_mov_b32 v3, 0
    v_mov_b32 v4, 0
    v_mov_b32 v5, 0
    v_mov_b32 v6, 0
    v_mov_b32 v7, 0
    v_mov_b32 v8, 0
    v_mov_b32 v9, 0
    v_mov_b32 v10, 0
    v_mov_b32 v11, 0
    v_mov_b32 v12, 0
    v_mov_b32 v13, 0
    v_mov_b32 v14, 0
    v_mov_b32 v15, 0
    v_mov_b32 v16, 0
    v_mov_b32 v17, 0
    v_mov_b32 v18, 0
    v_mov_b32 v19, 0
    v_mov_b32 v20, 0
    v_mov_b32 v21, 0
    v_mov_b32 v22, 0
    v_mov_b32 v23, 0
    v_mov_b32 v24, 0
    v_mov_b32 v25, 0
    v_mov_b32 v26, 0
    v_mov_b32 v27, 0
    v_mov_b32 v28, 0
    v_mov_b32 v29, 0
    v_mov_b32 v30, 0
    v_mov_b32 v31, 0
    v_mov_b32 v32, 0
    v_mov_b32 v33, 0
    v_mov_b32 v34, 0
    v_mov_b32 v35, 0
    v_mov_b32 v36, 0
    v_mov_b32 v37, 0
    v_mov_b32 v38, 0
    v_mov_b32 v39, 0
    v_mov_b32 v40, 0
    v_mov_b32 v41, 0
    v_mov_b32 v42, 0
    v_mov_b32 v43, 0
    v_mov_b32 v44, 0
    v_mov_b32 v45, 0
    v_mov_b32 v46, 0
    v_mov_b32 v47, 0
    v_mov_b32 v48, 0
    v_mov_b32 v49, 0
    v_mov_b32 v50, 0
    v_mov_b32 v51, 0
    v_mov_b32 v52, 0
    v_mov_b32 v53, 0
    v_mov_b32 v54, 0
    v_mov_b32 v55, 0
    v_mov_b32 v56, 0
    v_mov_b32 v57, 0
    v_mov_b32 v58, 0
    v_mov_b32 v59, 0
    v_mov_b32 v60, 0
    v_mov_b32 v61, 0
    v_mov_b32 v62, 0
    v_mov_b32 v63, 0
    v_mov_b32 v64, 0
    v_mov_b32 v65, 0
    v_mov_b32 v66, 0
    v_mov_b32 v67, 0
    v_mov_b32 v68, 0
    v_mov_b32 v69, 0
    v_mov_b32 v70, 0
    v_mov_b32 v71, 0
    v_mov_b32 v72, 0
    v_mov_b32 v73, 0
    v_mov_b32 v74, 0
    v_mov_b32 v75, 0
    v_mov_b32 v76, 0
    v_mov_b32 v77, 0
    v_mov_b32 v78, 0
    v_mov_b32 v79, 0
    v_mov_b32 v80, 0
    v_mov_b32 v81, 0
    v_mov_b32 v82, 0
    v_mov_b32 v83, 0
    v_mov_b32 v84, 0
    v_mov_b32 v85, 0
    v_mov_b32 v86, 0
    v_mov_b32 v87, 0
    v_mov_b32 v88, 0
    v_mov_b32 v89, 0
    v_mov_b32 v90, 0
    v_mov_b32 v91, 0
    v_mov_b32 v92, 0
    v_mov_b32 v93, 0
    v_mov_b32 v94, 0
    v_mov_b32 v95, 0
    v_mov_b32 v96, 0
    v_mov_b32 v97, 0
    v_mov_b32 v98, 0
    v_mov_b32 v99, 0
    v_mov_b32 v100, 0
    v_mov_b32 v101, 0
    v_mov_b32 v102, 0
    v_mov_b32 v103, 0
    v_mov_b32 v104, 0
    v_mov_b32 v105, 0
    v_mov_b32 v106, 0
    v_mov_b32 v107, 0
    v_mov_b32 v108, 0
    v_mov_b32 v109, 0
    v_mov_b32 v110, 0
    v_mov_b32 v111, 0
    s_waitcnt vmcnt(3)
    s_barrier
    v_add_u32 v124, 0, v119
    v_add_u32 v125, 0, v120
    v_add_u32 v126, 0, v121
    ds_read_b128 a[28:31], v124 offset:0
    ds_read_b128 a[32:35], v124 offset:1024
    ds_read_b128 a[36:39], v124 offset:2048
    ds_read_b128 a[40:43], v124 offset:3072
    ds_read_b64_tr_b16 a[0:1], v125 offset:0
    ds_read_b64_tr_b16 a[2:3], v125 offset:7168
    ds_read_b64_tr_b16 a[4:5], v126 offset:0
    ds_read_b64_tr_b16 a[6:7], v126 offset:7168
    ds_read_b64_tr_b16 a[8:9], v125 offset:64
    ds_read_b64_tr_b16 a[10:11], v125 offset:7232
    ds_read_b64_tr_b16 a[12:13], v126 offset:64
    ds_read_b64_tr_b16 a[14:15], v126 offset:7232
    ds_read_b64_tr_b16 a[16:17], v125 offset:128
    ds_read_b64_tr_b16 a[18:19], v125 offset:7296
    ds_read_b64_tr_b16 a[20:21], v126 offset:128
    ds_read_b64_tr_b16 a[22:23], v126 offset:7296
    ds_read_b64_tr_b16 a[24:25], v125 offset:192
    ds_read_b64_tr_b16 a[26:27], v125 offset:7360
    s_mov_b32 s22, 0
    s_mov_b32 s56, 36864
    v_add_u32 v127, s56, v119
    v_add_u32 v128, s56, v120
    v_add_u32 v129, s56, v121
    s_waitcnt vmcnt(2) lgkmcnt(0)
    s_barrier
    v_mfma_f32_16x16x32_bf16 v[0:3], a[0:3], a[28:31], v[0:3]
    ds_read_b128 a[72:75], v127 offset:0
    s_add_u32 s23, s22, s21
    s_add_u32 s30, s22, s20
    s_cmp_eq_u32 s41, 1
    s_cselect_b32 s42, 144384, s30
    v_mfma_f32_16x16x32_bf16 v[4:7], a[0:3], a[32:35], v[4:7]
    ds_read_b128 a[76:79], v127 offset:1024
    s_mov_b32 s22, s56
    s_add_u32 s56, s56, 36864
    s_cmp_eq_u32 s56, 147456
    s_cselect_b32 s56, 0, s56
    v_mfma_f32_16x16x32_bf16 v[8:11], a[0:3], a[36:39], v[8:11]
    ds_read_b128 a[80:83], v127 offset:2048
    s_add_u32 m0, s23, 0
    v_mfma_f32_16x16x32_bf16 v[12:15], a[0:3], a[40:43], v[12:15]
    ds_read_b128 a[84:87], v127 offset:3072
    buffer_load_dwordx4 v118, s[8:11], s18 offen sc1 lds
    v_mfma_f32_16x16x32_bf16 v[16:19], a[4:7], a[28:31], v[16:19]
    ds_read_b64_tr_b16 a[44:45], v128 offset:0
    v_mfma_f32_16x16x32_bf16 v[20:23], a[4:7], a[32:35], v[20:23]
    ds_read_b64_tr_b16 a[46:47], v128 offset:7168
    v_mfma_f32_16x16x32_bf16 v[24:27], a[4:7], a[36:39], v[24:27]
    ds_read_b64_tr_b16 a[48:49], v129 offset:0
    s_add_u32 m0, s30, 0
    v_mfma_f32_16x16x32_bf16 v[28:31], a[4:7], a[40:43], v[28:31]
    ds_read_b64_tr_b16 a[50:51], v129 offset:7168
    buffer_load_dwordx4 v140, s[4:7], s17 offen lds
    v_mfma_f32_16x16x32_bf16 v[32:35], a[8:11], a[28:31], v[32:35]
    ds_read_b64_tr_b16 a[52:53], v128 offset:64
    v_mfma_f32_16x16x32_bf16 v[36:39], a[8:11], a[32:35], v[36:39]
    ds_read_b64_tr_b16 a[54:55], v128 offset:7232
    v_mfma_f32_16x16x32_bf16 v[40:43], a[8:11], a[36:39], v[40:43]
    ds_read_b64_tr_b16 a[56:57], v129 offset:64
    s_add_u32 m0, s30, 1024
    v_mfma_f32_16x16x32_bf16 v[44:47], a[8:11], a[40:43], v[44:47]
    ds_read_b64_tr_b16 a[58:59], v129 offset:7232
    buffer_load_dwordx4 v141, s[4:7], s17 offen lds
    v_mfma_f32_16x16x32_bf16 v[48:51], a[12:15], a[28:31], v[48:51]
    ds_read_b64_tr_b16 a[60:61], v128 offset:128
    v_mfma_f32_16x16x32_bf16 v[52:55], a[12:15], a[32:35], v[52:55]
    ds_read_b64_tr_b16 a[62:63], v128 offset:7296
    v_mfma_f32_16x16x32_bf16 v[56:59], a[12:15], a[36:39], v[56:59]
    ds_read_b64_tr_b16 a[64:65], v129 offset:128
    s_add_u32 m0, s30, 2048
    v_mfma_f32_16x16x32_bf16 v[60:63], a[12:15], a[40:43], v[60:63]
    ds_read_b64_tr_b16 a[66:67], v129 offset:7296
    buffer_load_dwordx4 v142, s[4:7], s17 offen lds
    v_mfma_f32_16x16x32_bf16 v[64:67], a[16:19], a[28:31], v[64:67]
    ds_read_b64_tr_b16 a[68:69], v128 offset:192
    v_mfma_f32_16x16x32_bf16 v[68:71], a[16:19], a[32:35], v[68:71]
    ds_read_b64_tr_b16 a[70:71], v128 offset:7360
    v_mfma_f32_16x16x32_bf16 v[72:75], a[16:19], a[36:39], v[72:75]
    s_add_u32 m0, s42, 3072
    v_mfma_f32_16x16x32_bf16 v[76:79], a[16:19], a[40:43], v[76:79]
    buffer_load_dwordx4 v143, s[4:7], s17 offen lds
    v_mfma_f32_16x16x32_bf16 v[80:83], a[20:23], a[28:31], v[80:83]
    v_mfma_f32_16x16x32_bf16 v[84:87], a[20:23], a[32:35], v[84:87]
    v_mfma_f32_16x16x32_bf16 v[88:91], a[20:23], a[36:39], v[88:91]
    v_mfma_f32_16x16x32_bf16 v[92:95], a[20:23], a[40:43], v[92:95]
    v_mfma_f32_16x16x32_bf16 v[96:99], a[24:27], a[28:31], v[96:99]
    buffer_load_dwordx4 a[88:91], v122, s[4:7], s84 offen
    s_add_u32 s84, s84, 917504
    v_mfma_f32_16x16x32_bf16 v[100:103], a[24:27], a[32:35], v[100:103]
    v_mfma_f32_16x16x32_bf16 v[104:107], a[24:27], a[36:39], v[104:107]
    buffer_load_dwordx4 a[92:95], v123, s[60:63], s85 offen
    s_add_u32 s85, s85, 2097152
    v_mfma_f32_16x16x32_bf16 v[108:111], a[24:27], a[40:43], v[108:111]
    s_add_u32 s18, s18, 1024
    s_add_u32 s17, s17, 229376
    v_add_u32 v124, s56, v119
    v_add_u32 v125, s56, v120
    v_add_u32 v126, s56, v121
    s_waitcnt vmcnt(8) lgkmcnt(0)
    s_barrier
    v_mfma_f32_16x16x32_bf16 v[0:3], a[44:47], a[72:75], v[0:3]
    ds_read_b128 a[28:31], v124 offset:0
    s_add_u32 s23, s22, s21
    s_add_u32 s30, s22, s20
    s_cmp_eq_u32 s41, 1
    s_cselect_b32 s42, 144384, s30
    v_mfma_f32_16x16x32_bf16 v[4:7], a[44:47], a[76:79], v[4:7]
    ds_read_b128 a[32:35], v124 offset:1024
    s_mov_b32 s22, s56
    s_add_u32 s56, s56, 36864
    s_cmp_eq_u32 s56, 147456
    s_cselect_b32 s56, 0, s56
    v_mfma_f32_16x16x32_bf16 v[8:11], a[44:47], a[80:83], v[8:11]
    ds_read_b128 a[36:39], v124 offset:2048
    s_add_u32 m0, s23, 0
    v_mfma_f32_16x16x32_bf16 v[12:15], a[44:47], a[84:87], v[12:15]
    ds_read_b128 a[40:43], v124 offset:3072
    buffer_load_dwordx4 v118, s[8:11], s18 offen sc1 lds
    v_mfma_f32_16x16x32_bf16 v[16:19], a[48:51], a[72:75], v[16:19]
    ds_read_b64_tr_b16 a[0:1], v125 offset:0
    v_mfma_f32_16x16x32_bf16 v[20:23], a[48:51], a[76:79], v[20:23]
    ds_read_b64_tr_b16 a[2:3], v125 offset:7168
    v_mfma_f32_16x16x32_bf16 v[24:27], a[48:51], a[80:83], v[24:27]
    ds_read_b64_tr_b16 a[4:5], v126 offset:0
    s_add_u32 m0, s30, 0
    v_mfma_f32_16x16x32_bf16 v[28:31], a[48:51], a[84:87], v[28:31]
    ds_read_b64_tr_b16 a[6:7], v126 offset:7168
    buffer_load_dwordx4 v140, s[4:7], s17 offen lds
    v_mfma_f32_16x16x32_bf16 v[32:35], a[52:55], a[72:75], v[32:35]
    ds_read_b64_tr_b16 a[8:9], v125 offset:64
    v_mfma_f32_16x16x32_bf16 v[36:39], a[52:55], a[76:79], v[36:39]
    ds_read_b64_tr_b16 a[10:11], v125 offset:7232
    v_mfma_f32_16x16x32_bf16 v[40:43], a[52:55], a[80:83], v[40:43]
    ds_read_b64_tr_b16 a[12:13], v126 offset:64
    s_add_u32 m0, s30, 1024
    v_mfma_f32_16x16x32_bf16 v[44:47], a[52:55], a[84:87], v[44:47]
    ds_read_b64_tr_b16 a[14:15], v126 offset:7232
    buffer_load_dwordx4 v141, s[4:7], s17 offen lds
    v_mfma_f32_16x16x32_bf16 v[48:51], a[56:59], a[72:75], v[48:51]
    ds_read_b64_tr_b16 a[16:17], v125 offset:128
    v_mfma_f32_16x16x32_bf16 v[52:55], a[56:59], a[76:79], v[52:55]
    ds_read_b64_tr_b16 a[18:19], v125 offset:7296
    v_mfma_f32_16x16x32_bf16 v[56:59], a[56:59], a[80:83], v[56:59]
    ds_read_b64_tr_b16 a[20:21], v126 offset:128
    s_add_u32 m0, s30, 2048
    v_mfma_f32_16x16x32_bf16 v[60:63], a[56:59], a[84:87], v[60:63]
    ds_read_b64_tr_b16 a[22:23], v126 offset:7296
    buffer_load_dwordx4 v142, s[4:7], s17 offen lds
    v_mfma_f32_16x16x32_bf16 v[64:67], a[60:63], a[72:75], v[64:67]
    ds_read_b64_tr_b16 a[24:25], v125 offset:192
    v_mfma_f32_16x16x32_bf16 v[68:71], a[60:63], a[76:79], v[68:71]
    ds_read_b64_tr_b16 a[26:27], v125 offset:7360
    v_mfma_f32_16x16x32_bf16 v[72:75], a[60:63], a[80:83], v[72:75]
    s_add_u32 m0, s42, 3072
    v_mfma_f32_16x16x32_bf16 v[76:79], a[60:63], a[84:87], v[76:79]
    buffer_load_dwordx4 v143, s[4:7], s17 offen lds
    v_mfma_f32_16x16x32_bf16 v[80:83], a[64:67], a[72:75], v[80:83]
    v_mfma_f32_16x16x32_bf16 v[84:87], a[64:67], a[76:79], v[84:87]
    v_mfma_f32_16x16x32_bf16 v[88:91], a[64:67], a[80:83], v[88:91]
    v_mfma_f32_16x16x32_bf16 v[92:95], a[64:67], a[84:87], v[92:95]
    v_mfma_f32_16x16x32_bf16 v[96:99], a[68:71], a[72:75], v[96:99]
    v_mfma_f32_16x16x32_bf16 v[100:103], a[68:71], a[76:79], v[100:103]
    v_mfma_f32_16x16x32_bf16 v[104:107], a[68:71], a[80:83], v[104:107]
    v_mfma_f32_16x16x32_bf16 v[108:111], a[68:71], a[84:87], v[108:111]
    s_add_u32 s18, s18, 1024
    s_add_u32 s17, s17, 229376
    v_add_u32 v127, s56, v119
    v_add_u32 v128, s56, v120
    v_add_u32 v129, s56, v121
    s_waitcnt vmcnt(12) lgkmcnt(0)
    s_barrier
    v_mfma_f32_16x16x32_bf16 v[0:3], a[0:3], a[28:31], v[0:3]
    ds_read_b128 a[72:75], v127 offset:0
    s_add_u32 s23, s22, s21
    s_add_u32 s30, s22, s20
    s_cmp_eq_u32 s41, 1
    s_cselect_b32 s42, 144384, s30
    v_mfma_f32_16x16x32_bf16 v[4:7], a[0:3], a[32:35], v[4:7]
    ds_read_b128 a[76:79], v127 offset:1024
    s_mov_b32 s22, s56
    s_add_u32 s56, s56, 36864
    s_cmp_eq_u32 s56, 147456
    s_cselect_b32 s56, 0, s56
    v_mfma_f32_16x16x32_bf16 v[8:11], a[0:3], a[36:39], v[8:11]
    ds_read_b128 a[80:83], v127 offset:2048
    s_add_u32 m0, s23, 0
    v_mfma_f32_16x16x32_bf16 v[12:15], a[0:3], a[40:43], v[12:15]
    ds_read_b128 a[84:87], v127 offset:3072
    buffer_load_dwordx4 v118, s[8:11], s18 offen sc1 lds
    v_mfma_f32_16x16x32_bf16 v[16:19], a[4:7], a[28:31], v[16:19]
    ds_read_b64_tr_b16 a[44:45], v128 offset:0
    v_mfma_f32_16x16x32_bf16 v[20:23], a[4:7], a[32:35], v[20:23]
    ds_read_b64_tr_b16 a[46:47], v128 offset:7168
    v_mfma_f32_16x16x32_bf16 v[24:27], a[4:7], a[36:39], v[24:27]
    ds_read_b64_tr_b16 a[48:49], v129 offset:0
    s_add_u32 m0, s30, 0
    v_mfma_f32_16x16x32_bf16 v[28:31], a[4:7], a[40:43], v[28:31]
    ds_read_b64_tr_b16 a[50:51], v129 offset:7168
    buffer_load_dwordx4 v140, s[4:7], s17 offen lds
    v_mfma_f32_16x16x32_bf16 v[32:35], a[8:11], a[28:31], v[32:35]
    ds_read_b64_tr_b16 a[52:53], v128 offset:64
    v_mfma_f32_16x16x32_bf16 v[36:39], a[8:11], a[32:35], v[36:39]
    ds_read_b64_tr_b16 a[54:55], v128 offset:7232
    v_mfma_f32_16x16x32_bf16 v[40:43], a[8:11], a[36:39], v[40:43]
    ds_read_b64_tr_b16 a[56:57], v129 offset:64
    s_add_u32 m0, s30, 1024
    v_mfma_f32_16x16x32_bf16 v[44:47], a[8:11], a[40:43], v[44:47]
    ds_read_b64_tr_b16 a[58:59], v129 offset:7232
    buffer_load_dwordx4 v141, s[4:7], s17 offen lds
    v_mfma_f32_16x16x32_bf16 v[48:51], a[12:15], a[28:31], v[48:51]
    ds_read_b64_tr_b16 a[60:61], v128 offset:128
    v_mfma_f32_16x16x32_bf16 v[52:55], a[12:15], a[32:35], v[52:55]
    ds_read_b64_tr_b16 a[62:63], v128 offset:7296
    v_mfma_f32_16x16x32_bf16 v[56:59], a[12:15], a[36:39], v[56:59]
    ds_read_b64_tr_b16 a[64:65], v129 offset:128
    s_add_u32 m0, s30, 2048
    v_mfma_f32_16x16x32_bf16 v[60:63], a[12:15], a[40:43], v[60:63]
    ds_read_b64_tr_b16 a[66:67], v129 offset:7296
    buffer_load_dwordx4 v142, s[4:7], s17 offen lds
    v_mfma_f32_16x16x32_bf16 v[64:67], a[16:19], a[28:31], v[64:67]
    ds_read_b64_tr_b16 a[68:69], v128 offset:192
    v_mfma_f32_16x16x32_bf16 v[68:71], a[16:19], a[32:35], v[68:71]
    ds_read_b64_tr_b16 a[70:71], v128 offset:7360
    v_mfma_f32_16x16x32_bf16 v[72:75], a[16:19], a[36:39], v[72:75]
    s_add_u32 m0, s42, 3072
    v_mfma_f32_16x16x32_bf16 v[76:79], a[16:19], a[40:43], v[76:79]
    buffer_load_dwordx4 v143, s[4:7], s17 offen lds
    v_mfma_f32_16x16x32_bf16 v[80:83], a[20:23], a[28:31], v[80:83]
    v_mfma_f32_16x16x32_bf16 v[84:87], a[20:23], a[32:35], v[84:87]
    v_mfma_f32_16x16x32_bf16 v[88:91], a[20:23], a[36:39], v[88:91]
    v_mfma_f32_16x16x32_bf16 v[92:95], a[20:23], a[40:43], v[92:95]
    v_mfma_f32_16x16x32_bf16 v[96:99], a[24:27], a[28:31], v[96:99]
    v_mfma_f32_16x16x32_bf16 v[100:103], a[24:27], a[32:35], v[100:103]
    v_mfma_f32_16x16x32_bf16 v[104:107], a[24:27], a[36:39], v[104:107]
    v_mfma_f32_16x16x32_bf16 v[108:111], a[24:27], a[40:43], v[108:111]
    s_add_u32 s18, s18, 1024
    s_add_u32 s17, s17, 229376
    v_add_u32 v124, s56, v119
    v_add_u32 v125, s56, v120
    v_add_u32 v126, s56, v121
    s_waitcnt vmcnt(12) lgkmcnt(0)
    s_barrier
    v_mfma_f32_16x16x32_bf16 v[0:3], a[44:47], a[72:75], v[0:3]
    ds_read_b128 a[28:31], v124 offset:0
    s_add_u32 s23, s22, s21
    s_add_u32 s30, s22, s20
    s_cmp_eq_u32 s41, 1
    s_cselect_b32 s42, 144384, s30
    v_mfma_f32_16x16x32_bf16 v[4:7], a[44:47], a[76:79], v[4:7]
    ds_read_b128 a[32:35], v124 offset:1024
    s_mov_b32 s22, s56
    s_add_u32 s56, s56, 36864
    s_cmp_eq_u32 s56, 147456
    s_cselect_b32 s56, 0, s56
    v_mfma_f32_16x16x32_bf16 v[8:11], a[44:47], a[80:83], v[8:11]
    ds_read_b128 a[36:39], v124 offset:2048
    s_add_u32 m0, s23, 0
    v_mfma_f32_16x16x32_bf16 v[12:15], a[44:47], a[84:87], v[12:15]
    ds_read_b128 a[40:43], v124 offset:3072
    buffer_load_dwordx4 v118, s[8:11], s18 offen sc1 lds
    v_mfma_f32_16x16x32_bf16 v[16:19], a[48:51], a[72:75], v[16:19]
    ds_read_b64_tr_b16 a[0:1], v125 offset:0
    v_mfma_f32_16x16x32_bf16 v[20:23], a[48:51], a[76:79], v[20:23]
    ds_read_b64_tr_b16 a[2:3], v125 offset:7168
    v_mfma_f32_16x16x32_bf16 v[24:27], a[48:51], a[80:83], v[24:27]
    ds_read_b64_tr_b16 a[4:5], v126 offset:0
    s_add_u32 m0, s30, 0
    v_mfma_f32_16x16x32_bf16 v[28:31], a[48:51], a[84:87], v[28:31]
    ds_read_b64_tr_b16 a[6:7], v126 offset:7168
    buffer_load_dwordx4 v140, s[4:7], s17 offen lds
    v_mfma_f32_16x16x32_bf16 v[32:35], a[52:55], a[72:75], v[32:35]
    ds_read_b64_tr_b16 a[8:9], v125 offset:64
    v_mfma_f32_16x16x32_bf16 v[36:39], a[52:55], a[76:79], v[36:39]
    ds_read_b64_tr_b16 a[10:11], v125 offset:7232
    v_mfma_f32_16x16x32_bf16 v[40:43], a[52:55], a[80:83], v[40:43]
    ds_read_b64_tr_b16 a[12:13], v126 offset:64
    s_add_u32 m0, s30, 1024
    v_mfma_f32_16x16x32_bf16 v[44:47], a[52:55], a[84:87], v[44:47]
    ds_read_b64_tr_b16 a[14:15], v126 offset:7232
    buffer_load_dwordx4 v141, s[4:7], s17 offen lds
    v_mfma_f32_16x16x32_bf16 v[48:51], a[56:59], a[72:75], v[48:51]
    ds_read_b64_tr_b16 a[16:17], v125 offset:128
    v_mfma_f32_16x16x32_bf16 v[52:55], a[56:59], a[76:79], v[52:55]
    ds_read_b64_tr_b16 a[18:19], v125 offset:7296
    v_mfma_f32_16x16x32_bf16 v[56:59], a[56:59], a[80:83], v[56:59]
    ds_read_b64_tr_b16 a[20:21], v126 offset:128
    s_add_u32 m0, s30, 2048
    v_mfma_f32_16x16x32_bf16 v[60:63], a[56:59], a[84:87], v[60:63]
    ds_read_b64_tr_b16 a[22:23], v126 offset:7296
    buffer_load_dwordx4 v142, s[4:7], s17 offen lds
    v_mfma_f32_16x16x32_bf16 v[64:67], a[60:63], a[72:75], v[64:67]
    ds_read_b64_tr_b16 a[24:25], v125 offset:192
    v_mfma_f32_16x16x32_bf16 v[68:71], a[60:63], a[76:79], v[68:71]
    ds_read_b64_tr_b16 a[26:27], v125 offset:7360
    v_mfma_f32_16x16x32_bf16 v[72:75], a[60:63], a[80:83], v[72:75]
    s_add_u32 m0, s42, 3072
    v_mfma_f32_16x16x32_bf16 v[76:79], a[60:63], a[84:87], v[76:79]
    buffer_load_dwordx4 v143, s[4:7], s17 offen lds
    v_mfma_f32_16x16x32_bf16 v[80:83], a[64:67], a[72:75], v[80:83]
    v_mfma_f32_16x16x32_bf16 v[84:87], a[64:67], a[76:79], v[84:87]
    v_mfma_f32_16x16x32_bf16 v[88:91], a[64:67], a[80:83], v[88:91]
    v_mfma_f32_16x16x32_bf16 v[92:95], a[64:67], a[84:87], v[92:95]
    v_mfma_f32_16x16x32_bf16 v[96:99], a[68:71], a[72:75], v[96:99]
    v_mfma_f32_16x16x32_bf16 v[100:103], a[68:71], a[76:79], v[100:103]
    v_mfma_f32_16x16x32_bf16 v[104:107], a[68:71], a[80:83], v[104:107]
    v_mfma_f32_16x16x32_bf16 v[108:111], a[68:71], a[84:87], v[108:111]
    s_add_u32 s18, s18, 1024
    s_add_u32 s17, s17, 229376
    v_add_u32 v127, s56, v119
    v_add_u32 v128, s56, v120
    v_add_u32 v129, s56, v121
    s_mov_b32 s19, 6
Lloop_29:
    s_waitcnt vmcnt(10) lgkmcnt(0)
    s_barrier
    v_mfma_f32_16x16x32_bf16 v[0:3], a[0:3], a[28:31], v[0:3]
    ds_read_b128 a[72:75], v127 offset:0
    s_add_u32 s23, s22, s21
    s_add_u32 s30, s22, s20
    s_cmp_eq_u32 s41, 1
    s_cselect_b32 s42, 144384, s30
    v_mfma_f32_16x16x32_bf16 v[4:7], a[0:3], a[32:35], v[4:7]
    ds_read_b128 a[76:79], v127 offset:1024
    s_mov_b32 s22, s56
    s_add_u32 s56, s56, 36864
    s_cmp_eq_u32 s56, 147456
    s_cselect_b32 s56, 0, s56
    v_mfma_f32_16x16x32_bf16 v[8:11], a[0:3], a[36:39], v[8:11]
    ds_read_b128 a[80:83], v127 offset:2048
    s_add_u32 m0, s23, 0
    v_mfma_f32_16x16x32_bf16 v[12:15], a[0:3], a[40:43], v[12:15]
    ds_read_b128 a[84:87], v127 offset:3072
    buffer_load_dwordx4 v118, s[8:11], s18 offen sc1 lds
    v_mfma_f32_16x16x32_bf16 v[16:19], a[4:7], a[28:31], v[16:19]
    ds_read_b64_tr_b16 a[44:45], v128 offset:0
    v_mfma_f32_16x16x32_bf16 v[20:23], a[4:7], a[32:35], v[20:23]
    ds_read_b64_tr_b16 a[46:47], v128 offset:7168
    v_mfma_f32_16x16x32_bf16 v[24:27], a[4:7], a[36:39], v[24:27]
    ds_read_b64_tr_b16 a[48:49], v129 offset:0
    s_add_u32 m0, s30, 0
    v_mfma_f32_16x16x32_bf16 v[28:31], a[4:7], a[40:43], v[28:31]
    ds_read_b64_tr_b16 a[50:51], v129 offset:7168
    buffer_load_dwordx4 v140, s[4:7], s17 offen lds
    v_mfma_f32_16x16x32_bf16 v[32:35], a[8:11], a[28:31], v[32:35]
    ds_read_b64_tr_b16 a[52:53], v128 offset:64
    v_mfma_f32_16x16x32_bf16 v[36:39], a[8:11], a[32:35], v[36:39]
    ds_read_b64_tr_b16 a[54:55], v128 offset:7232
    v_mfma_f32_16x16x32_bf16 v[40:43], a[8:11], a[36:39], v[40:43]
    ds_read_b64_tr_b16 a[56:57], v129 offset:64
    s_add_u32 m0, s30, 1024
    v_mfma_f32_16x16x32_bf16 v[44:47], a[8:11], a[40:43], v[44:47]
    ds_read_b64_tr_b16 a[58:59], v129 offset:7232
    buffer_load_dwordx4 v141, s[4:7], s17 offen lds
    v_mfma_f32_16x16x32_bf16 v[48:51], a[12:15], a[28:31], v[48:51]
    ds_read_b64_tr_b16 a[60:61], v128 offset:128
    v_mfma_f32_16x16x32_bf16 v[52:55], a[12:15], a[32:35], v[52:55]
    ds_read_b64_tr_b16 a[62:63], v128 offset:7296
    v_mfma_f32_16x16x32_bf16 v[56:59], a[12:15], a[36:39], v[56:59]
    ds_read_b64_tr_b16 a[64:65], v129 offset:128
    s_add_u32 m0, s30, 2048
    v_mfma_f32_16x16x32_bf16 v[60:63], a[12:15], a[40:43], v[60:63]
    ds_read_b64_tr_b16 a[66:67], v129 offset:7296
    buffer_load_dwordx4 v142, s[4:7], s17 offen lds
    v_mfma_f32_16x16x32_bf16 v[64:67], a[16:19], a[28:31], v[64:67]
    ds_read_b64_tr_b16 a[68:69], v128 offset:192
    v_mfma_f32_16x16x32_bf16 v[68:71], a[16:19], a[32:35], v[68:71]
    ds_read_b64_tr_b16 a[70:71], v128 offset:7360
    v_mfma_f32_16x16x32_bf16 v[72:75], a[16:19], a[36:39], v[72:75]
    s_add_u32 m0, s42, 3072
    v_mfma_f32_16x16x32_bf16 v[76:79], a[16:19], a[40:43], v[76:79]
    buffer_load_dwordx4 v143, s[4:7], s17 offen lds
    v_mfma_f32_16x16x32_bf16 v[80:83], a[20:23], a[28:31], v[80:83]
    v_mfma_f32_16x16x32_bf16 v[84:87], a[20:23], a[32:35], v[84:87]
    v_mfma_f32_16x16x32_bf16 v[88:91], a[20:23], a[36:39], v[88:91]
    v_mfma_f32_16x16x32_bf16 v[92:95], a[20:23], a[40:43], v[92:95]
    v_mfma_f32_16x16x32_bf16 v[96:99], a[24:27], a[28:31], v[96:99]
    buffer_load_dwordx4 a[88:91], v122, s[4:7], s84 offen
    s_add_u32 s84, s84, 917504
    v_mfma_f32_16x16x32_bf16 v[100:103], a[24:27], a[32:35], v[100:103]
    v_mfma_f32_16x16x32_bf16 v[104:107], a[24:27], a[36:39], v[104:107]
    buffer_load_dwordx4 a[92:95], v123, s[60:63], s85 offen
    s_add_u32 s85, s85, 2097152
    v_mfma_f32_16x16x32_bf16 v[108:111], a[24:27], a[40:43], v[108:111]
    s_add_u32 s18, s18, 1024
    s_add_u32 s17, s17, 229376
    v_add_u32 v124, s56, v119
    v_add_u32 v125, s56, v120
    v_add_u32 v126, s56, v121
    s_waitcnt vmcnt(12) lgkmcnt(0)
    s_barrier
    v_mfma_f32_16x16x32_bf16 v[0:3], a[44:47], a[72:75], v[0:3]
    ds_read_b128 a[28:31], v124 offset:0
    s_add_u32 s23, s22, s21
    s_add_u32 s30, s22, s20
    s_cmp_eq_u32 s41, 1
    s_cselect_b32 s42, 144384, s30
    v_mfma_f32_16x16x32_bf16 v[4:7], a[44:47], a[76:79], v[4:7]
    ds_read_b128 a[32:35], v124 offset:1024
    s_mov_b32 s22, s56
    s_add_u32 s56, s56, 36864
    s_cmp_eq_u32 s56, 147456
    s_cselect_b32 s56, 0, s56
    v_mfma_f32_16x16x32_bf16 v[8:11], a[44:47], a[80:83], v[8:11]
    ds_read_b128 a[36:39], v124 offset:2048
    s_add_u32 m0, s23, 0
    v_mfma_f32_16x16x32_bf16 v[12:15], a[44:47], a[84:87], v[12:15]
    ds_read_b128 a[40:43], v124 offset:3072
    buffer_load_dwordx4 v118, s[8:11], s18 offen sc1 lds
    v_mfma_f32_16x16x32_bf16 v[16:19], a[48:51], a[72:75], v[16:19]
    ds_read_b64_tr_b16 a[0:1], v125 offset:0
    v_mfma_f32_16x16x32_bf16 v[20:23], a[48:51], a[76:79], v[20:23]
    ds_read_b64_tr_b16 a[2:3], v125 offset:7168
    v_mfma_f32_16x16x32_bf16 v[24:27], a[48:51], a[80:83], v[24:27]
    ds_read_b64_tr_b16 a[4:5], v126 offset:0
    s_add_u32 m0, s30, 0
    v_mfma_f32_16x16x32_bf16 v[28:31], a[48:51], a[84:87], v[28:31]
    ds_read_b64_tr_b16 a[6:7], v126 offset:7168
    buffer_load_dwordx4 v140, s[4:7], s17 offen lds
    v_mfma_f32_16x16x32_bf16 v[32:35], a[52:55], a[72:75], v[32:35]
    ds_read_b64_tr_b16 a[8:9], v125 offset:64
    v_mfma_f32_16x16x32_bf16 v[36:39], a[52:55], a[76:79], v[36:39]
    ds_read_b64_tr_b16 a[10:11], v125 offset:7232
    v_mfma_f32_16x16x32_bf16 v[40:43], a[52:55], a[80:83], v[40:43]
    ds_read_b64_tr_b16 a[12:13], v126 offset:64
    s_add_u32 m0, s30, 1024
    v_mfma_f32_16x16x32_bf16 v[44:47], a[52:55], a[84:87], v[44:47]
    ds_read_b64_tr_b16 a[14:15], v126 offset:7232
    buffer_load_dwordx4 v141, s[4:7], s17 offen lds
    v_mfma_f32_16x16x32_bf16 v[48:51], a[56:59], a[72:75], v[48:51]
    ds_read_b64_tr_b16 a[16:17], v125 offset:128
    v_mfma_f32_16x16x32_bf16 v[52:55], a[56:59], a[76:79], v[52:55]
    ds_read_b64_tr_b16 a[18:19], v125 offset:7296
    v_mfma_f32_16x16x32_bf16 v[56:59], a[56:59], a[80:83], v[56:59]
    ds_read_b64_tr_b16 a[20:21], v126 offset:128
    s_add_u32 m0, s30, 2048
    v_mfma_f32_16x16x32_bf16 v[60:63], a[56:59], a[84:87], v[60:63]
    ds_read_b64_tr_b16 a[22:23], v126 offset:7296
    buffer_load_dwordx4 v142, s[4:7], s17 offen lds
    v_mfma_f32_16x16x32_bf16 v[64:67], a[60:63], a[72:75], v[64:67]
    ds_read_b64_tr_b16 a[24:25], v125 offset:192
    v_mfma_f32_16x16x32_bf16 v[68:71], a[60:63], a[76:79], v[68:71]
    ds_read_b64_tr_b16 a[26:27], v125 offset:7360
    v_mfma_f32_16x16x32_bf16 v[72:75], a[60:63], a[80:83], v[72:75]
    s_add_u32 m0, s42, 3072
    v_mfma_f32_16x16x32_bf16 v[76:79], a[60:63], a[84:87], v[76:79]
    buffer_load_dwordx4 v143, s[4:7], s17 offen lds
    v_mfma_f32_16x16x32_bf16 v[80:83], a[64:67], a[72:75], v[80:83]
    v_mfma_f32_16x16x32_bf16 v[84:87], a[64:67], a[76:79], v[84:87]
    v_mfma_f32_16x16x32_bf16 v[88:91], a[64:67], a[80:83], v[88:91]
    v_mfma_f32_16x16x32_bf16 v[92:95], a[64:67], a[84:87], v[92:95]
    v_mfma_f32_16x16x32_bf16 v[96:99], a[68:71], a[72:75], v[96:99]
    v_mfma_f32_16x16x32_bf16 v[100:103], a[68:71], a[76:79], v[100:103]
    v_mfma_f32_16x16x32_bf16 v[104:107], a[68:71], a[80:83], v[104:107]
    v_mfma_f32_16x16x32_bf16 v[108:111], a[68:71], a[84:87], v[108:111]
    s_add_u32 s18, s18, 1024
    s_add_u32 s17, s17, 229376
    v_add_u32 v127, s56, v119
    v_add_u32 v128, s56, v120
    v_add_u32 v129, s56, v121
    s_waitcnt vmcnt(12) lgkmcnt(0)
    s_barrier
    v_mfma_f32_16x16x32_bf16 v[0:3], a[0:3], a[28:31], v[0:3]
    ds_read_b128 a[72:75], v127 offset:0
    s_add_u32 s23, s22, s21
    s_add_u32 s30, s22, s20
    s_cmp_eq_u32 s41, 1
    s_cselect_b32 s42, 144384, s30
    v_mfma_f32_16x16x32_bf16 v[4:7], a[0:3], a[32:35], v[4:7]
    ds_read_b128 a[76:79], v127 offset:1024
    s_mov_b32 s22, s56
    s_add_u32 s56, s56, 36864
    s_cmp_eq_u32 s56, 147456
    s_cselect_b32 s56, 0, s56
    v_mfma_f32_16x16x32_bf16 v[8:11], a[0:3], a[36:39], v[8:11]
    ds_read_b128 a[80:83], v127 offset:2048
    s_add_u32 m0, s23, 0
    v_mfma_f32_16x16x32_bf16 v[12:15], a[0:3], a[40:43], v[12:15]
    ds_read_b128 a[84:87], v127 offset:3072
    buffer_load_dwordx4 v118, s[8:11], s18 offen sc1 lds
    v_mfma_f32_16x16x32_bf16 v[16:19], a[4:7], a[28:31], v[16:19]
    ds_read_b64_tr_b16 a[44:45], v128 offset:0
    v_mfma_f32_16x16x32_bf16 v[20:23], a[4:7], a[32:35], v[20:23]
    ds_read_b64_tr_b16 a[46:47], v128 offset:7168
    v_mfma_f32_16x16x32_bf16 v[24:27], a[4:7], a[36:39], v[24:27]
    ds_read_b64_tr_b16 a[48:49], v129 offset:0
    s_add_u32 m0, s30, 0
    v_mfma_f32_16x16x32_bf16 v[28:31], a[4:7], a[40:43], v[28:31]
    ds_read_b64_tr_b16 a[50:51], v129 offset:7168
    buffer_load_dwordx4 v140, s[4:7], s17 offen lds
    v_mfma_f32_16x16x32_bf16 v[32:35], a[8:11], a[28:31], v[32:35]
    ds_read_b64_tr_b16 a[52:53], v128 offset:64
    v_mfma_f32_16x16x32_bf16 v[36:39], a[8:11], a[32:35], v[36:39]
    ds_read_b64_tr_b16 a[54:55], v128 offset:7232
    v_mfma_f32_16x16x32_bf16 v[40:43], a[8:11], a[36:39], v[40:43]
    ds_read_b64_tr_b16 a[56:57], v129 offset:64
    s_add_u32 m0, s30, 1024
    v_mfma_f32_16x16x32_bf16 v[44:47], a[8:11], a[40:43], v[44:47]
    ds_read_b64_tr_b16 a[58:59], v129 offset:7232
    buffer_load_dwordx4 v141, s[4:7], s17 offen lds
    v_mfma_f32_16x16x32_bf16 v[48:51], a[12:15], a[28:31], v[48:51]
    ds_read_b64_tr_b16 a[60:61], v128 offset:128
    v_mfma_f32_16x16x32_bf16 v[52:55], a[12:15], a[32:35], v[52:55]
    ds_read_b64_tr_b16 a[62:63], v128 offset:7296
    v_mfma_f32_16x16x32_bf16 v[56:59], a[12:15], a[36:39], v[56:59]
    ds_read_b64_tr_b16 a[64:65], v129 offset:128
    s_add_u32 m0, s30, 2048
    v_mfma_f32_16x16x32_bf16 v[60:63], a[12:15], a[40:43], v[60:63]
    ds_read_b64_tr_b16 a[66:67], v129 offset:7296
    buffer_load_dwordx4 v142, s[4:7], s17 offen lds
    v_mfma_f32_16x16x32_bf16 v[64:67], a[16:19], a[28:31], v[64:67]
    ds_read_b64_tr_b16 a[68:69], v128 offset:192
    v_mfma_f32_16x16x32_bf16 v[68:71], a[16:19], a[32:35], v[68:71]
    ds_read_b64_tr_b16 a[70:71], v128 offset:7360
    v_mfma_f32_16x16x32_bf16 v[72:75], a[16:19], a[36:39], v[72:75]
    s_add_u32 m0, s42, 3072
    v_mfma_f32_16x16x32_bf16 v[76:79], a[16:19], a[40:43], v[76:79]
    buffer_load_dwordx4 v143, s[4:7], s17 offen lds
    v_mfma_f32_16x16x32_bf16 v[80:83], a[20:23], a[28:31], v[80:83]
    v_mfma_f32_16x16x32_bf16 v[84:87], a[20:23], a[32:35], v[84:87]
    v_mfma_f32_16x16x32_bf16 v[88:91], a[20:23], a[36:39], v[88:91]
    v_mfma_f32_16x16x32_bf16 v[92:95], a[20:23], a[40:43], v[92:95]
    v_mfma_f32_16x16x32_bf16 v[96:99], a[24:27], a[28:31], v[96:99]
    v_mfma_f32_16x16x32_bf16 v[100:103], a[24:27], a[32:35], v[100:103]
    v_mfma_f32_16x16x32_bf16 v[104:107], a[24:27], a[36:39], v[104:107]
    v_mfma_f32_16x16x32_bf16 v[108:111], a[24:27], a[40:43], v[108:111]
    s_add_u32 s18, s18, 1024
    s_add_u32 s17, s17, 229376
    v_add_u32 v124, s56, v119
    v_add_u32 v125, s56, v120
    v_add_u32 v126, s56, v121
    s_waitcnt vmcnt(12) lgkmcnt(0)
    s_barrier
    v_mfma_f32_16x16x32_bf16 v[0:3], a[44:47], a[72:75], v[0:3]
    ds_read_b128 a[28:31], v124 offset:0
    s_add_u32 s23, s22, s21
    s_add_u32 s30, s22, s20
    s_cmp_eq_u32 s41, 1
    s_cselect_b32 s42, 144384, s30
    v_mfma_f32_16x16x32_bf16 v[4:7], a[44:47], a[76:79], v[4:7]
    ds_read_b128 a[32:35], v124 offset:1024
    s_mov_b32 s22, s56
    s_add_u32 s56, s56, 36864
    s_cmp_eq_u32 s56, 147456
    s_cselect_b32 s56, 0, s56
    v_mfma_f32_16x16x32_bf16 v[8:11], a[44:47], a[80:83], v[8:11]
    ds_read_b128 a[36:39], v124 offset:2048
    s_add_u32 m0, s23, 0
    v_mfma_f32_16x16x32_bf16 v[12:15], a[44:47], a[84:87], v[12:15]
    ds_read_b128 a[40:43], v124 offset:3072
    buffer_load_dwordx4 v118, s[8:11], s18 offen sc1 lds
    v_mfma_f32_16x16x32_bf16 v[16:19], a[48:51], a[72:75], v[16:19]
    ds_read_b64_tr_b16 a[0:1], v125 offset:0
    v_mfma_f32_16x16x32_bf16 v[20:23], a[48:51], a[76:79], v[20:23]
    ds_read_b64_tr_b16 a[2:3], v125 offset:7168
    v_mfma_f32_16x16x32_bf16 v[24:27], a[48:51], a[80:83], v[24:27]
    ds_read_b64_tr_b16 a[4:5], v126 offset:0
    s_add_u32 m0, s30, 0
    v_mfma_f32_16x16x32_bf16 v[28:31], a[48:51], a[84:87], v[28:31]
    ds_read_b64_tr_b16 a[6:7], v126 offset:7168
    buffer_load_dwordx4 v140, s[4:7], s17 offen lds
    v_mfma_f32_16x16x32_bf16 v[32:35], a[52:55], a[72:75], v[32:35]
    ds_read_b64_tr_b16 a[8:9], v125 offset:64
    v_mfma_f32_16x16x32_bf16 v[36:39], a[52:55], a[76:79], v[36:39]
    ds_read_b64_tr_b16 a[10:11], v125 offset:7232
    v_mfma_f32_16x16x32_bf16 v[40:43], a[52:55], a[80:83], v[40:43]
    ds_read_b64_tr_b16 a[12:13], v126 offset:64
    s_add_u32 m0, s30, 1024
    v_mfma_f32_16x16x32_bf16 v[44:47], a[52:55], a[84:87], v[44:47]
    ds_read_b64_tr_b16 a[14:15], v126 offset:7232
    buffer_load_dwordx4 v141, s[4:7], s17 offen lds
    v_mfma_f32_16x16x32_bf16 v[48:51], a[56:59], a[72:75], v[48:51]
    ds_read_b64_tr_b16 a[16:17], v125 offset:128
    v_mfma_f32_16x16x32_bf16 v[52:55], a[56:59], a[76:79], v[52:55]
    ds_read_b64_tr_b16 a[18:19], v125 offset:7296
    v_mfma_f32_16x16x32_bf16 v[56:59], a[56:59], a[80:83], v[56:59]
    ds_read_b64_tr_b16 a[20:21], v126 offset:128
    s_add_u32 m0, s30, 2048
    v_mfma_f32_16x16x32_bf16 v[60:63], a[56:59], a[84:87], v[60:63]
    ds_read_b64_tr_b16 a[22:23], v126 offset:7296
    buffer_load_dwordx4 v142, s[4:7], s17 offen lds
    v_mfma_f32_16x16x32_bf16 v[64:67], a[60:63], a[72:75], v[64:67]
    ds_read_b64_tr_b16 a[24:25], v125 offset:192
    v_mfma_f32_16x16x32_bf16 v[68:71], a[60:63], a[76:79], v[68:71]
    ds_read_b64_tr_b16 a[26:27], v125 offset:7360
    v_mfma_f32_16x16x32_bf16 v[72:75], a[60:63], a[80:83], v[72:75]
    s_add_u32 m0, s42, 3072
    v_mfma_f32_16x16x32_bf16 v[76:79], a[60:63], a[84:87], v[76:79]
    buffer_load_dwordx4 v143, s[4:7], s17 offen lds
    v_mfma_f32_16x16x32_bf16 v[80:83], a[64:67], a[72:75], v[80:83]
    v_mfma_f32_16x16x32_bf16 v[84:87], a[64:67], a[76:79], v[84:87]
    v_mfma_f32_16x16x32_bf16 v[88:91], a[64:67], a[80:83], v[88:91]
    v_mfma_f32_16x16x32_bf16 v[92:95], a[64:67], a[84:87], v[92:95]
    v_mfma_f32_16x16x32_bf16 v[96:99], a[68:71], a[72:75], v[96:99]
    v_mfma_f32_16x16x32_bf16 v[100:103], a[68:71], a[76:79], v[100:103]
    v_mfma_f32_16x16x32_bf16 v[104:107], a[68:71], a[80:83], v[104:107]
    v_mfma_f32_16x16x32_bf16 v[108:111], a[68:71], a[84:87], v[108:111]
    s_add_u32 s18, s18, 1024
    s_add_u32 s17, s17, 229376
    v_add_u32 v127, s56, v119
    v_add_u32 v128, s56, v120
    v_add_u32 v129, s56, v121
    s_sub_u32 s19, s19, 1
    s_cmp_lg_u32 s19, 0
    s_cbranch_scc1 Lloop_29
    s_waitcnt vmcnt(10) lgkmcnt(0)
    s_barrier
    v_mfma_f32_16x16x32_bf16 v[0:3], a[0:3], a[28:31], v[0:3]
    ds_read_b128 a[72:75], v127 offset:0
    s_mov_b32 s22, s56
    s_add_u32 s56, s56, 36864
    v_mfma_f32_16x16x32_bf16 v[4:7], a[0:3], a[32:35], v[4:7]
    ds_read_b128 a[76:79], v127 offset:1024
    s_cmp_eq_u32 s56, 147456
    s_cselect_b32 s56, 0, s56
    v_mfma_f32_16x16x32_bf16 v[8:11], a[0:3], a[36:39], v[8:11]
    ds_read_b128 a[80:83], v127 offset:2048
    v_mfma_f32_16x16x32_bf16 v[12:15], a[0:3], a[40:43], v[12:15]
    ds_read_b128 a[84:87], v127 offset:3072
    v_mfma_f32_16x16x32_bf16 v[16:19], a[4:7], a[28:31], v[16:19]
    ds_read_b64_tr_b16 a[44:45], v128 offset:0
    v_mfma_f32_16x16x32_bf16 v[20:23], a[4:7], a[32:35], v[20:23]
    ds_read_b64_tr_b16 a[46:47], v128 offset:7168
    v_mfma_f32_16x16x32_bf16 v[24:27], a[4:7], a[36:39], v[24:27]
    ds_read_b64_tr_b16 a[48:49], v129 offset:0
    v_mfma_f32_16x16x32_bf16 v[28:31], a[4:7], a[40:43], v[28:31]
    ds_read_b64_tr_b16 a[50:51], v129 offset:7168
    v_mfma_f32_16x16x32_bf16 v[32:35], a[8:11], a[28:31], v[32:35]
    ds_read_b64_tr_b16 a[52:53], v128 offset:64
    v_mfma_f32_16x16x32_bf16 v[36:39], a[8:11], a[32:35], v[36:39]
    ds_read_b64_tr_b16 a[54:55], v128 offset:7232
    v_mfma_f32_16x16x32_bf16 v[40:43], a[8:11], a[36:39], v[40:43]
    ds_read_b64_tr_b16 a[56:57], v129 offset:64
    v_mfma_f32_16x16x32_bf16 v[44:47], a[8:11], a[40:43], v[44:47]
    ds_read_b64_tr_b16 a[58:59], v129 offset:7232
    v_mfma_f32_16x16x32_bf16 v[48:51], a[12:15], a[28:31], v[48:51]
    ds_read_b64_tr_b16 a[60:61], v128 offset:128
    v_mfma_f32_16x16x32_bf16 v[52:55], a[12:15], a[32:35], v[52:55]
    ds_read_b64_tr_b16 a[62:63], v128 offset:7296
    v_mfma_f32_16x16x32_bf16 v[56:59], a[12:15], a[36:39], v[56:59]
    ds_read_b64_tr_b16 a[64:65], v129 offset:128
    v_mfma_f32_16x16x32_bf16 v[60:63], a[12:15], a[40:43], v[60:63]
    ds_read_b64_tr_b16 a[66:67], v129 offset:7296
    v_mfma_f32_16x16x32_bf16 v[64:67], a[16:19], a[28:31], v[64:67]
    ds_read_b64_tr_b16 a[68:69], v128 offset:192
    v_mfma_f32_16x16x32_bf16 v[68:71], a[16:19], a[32:35], v[68:71]
    ds_read_b64_tr_b16 a[70:71], v128 offset:7360
    v_mfma_f32_16x16x32_bf16 v[72:75], a[16:19], a[36:39], v[72:75]
    v_mfma_f32_16x16x32_bf16 v[76:79], a[16:19], a[40:43], v[76:79]
    v_mfma_f32_16x16x32_bf16 v[80:83], a[20:23], a[28:31], v[80:83]
    v_mfma_f32_16x16x32_bf16 v[84:87], a[20:23], a[32:35], v[84:87]
    v_mfma_f32_16x16x32_bf16 v[88:91], a[20:23], a[36:39], v[88:91]
    v_mfma_f32_16x16x32_bf16 v[92:95], a[20:23], a[40:43], v[92:95]
    v_mfma_f32_16x16x32_bf16 v[96:99], a[24:27], a[28:31], v[96:99]
    v_mfma_f32_16x16x32_bf16 v[100:103], a[24:27], a[32:35], v[100:103]
    v_mfma_f32_16x16x32_bf16 v[104:107], a[24:27], a[36:39], v[104:107]
    v_mfma_f32_16x16x32_bf16 v[108:111], a[24:27], a[40:43], v[108:111]
    v_add_u32 v124, s56, v119
    v_add_u32 v125, s56, v120
    v_add_u32 v126, s56, v121
    s_waitcnt vmcnt(5) lgkmcnt(0)
    s_barrier
    v_mfma_f32_16x16x32_bf16 v[0:3], a[44:47], a[72:75], v[0:3]
    ds_read_b128 a[28:31], v124 offset:0
    s_mov_b32 s22, s56
    s_add_u32 s56, s56, 36864
    v_mfma_f32_16x16x32_bf16 v[4:7], a[44:47], a[76:79], v[4:7]
    ds_read_b128 a[32:35], v124 offset:1024
    s_cmp_eq_u32 s56, 147456
    s_cselect_b32 s56, 0, s56
    v_mfma_f32_16x16x32_bf16 v[8:11], a[44:47], a[80:83], v[8:11]
    ds_read_b128 a[36:39], v124 offset:2048
    v_mfma_f32_16x16x32_bf16 v[12:15], a[44:47], a[84:87], v[12:15]
    ds_read_b128 a[40:43], v124 offset:3072
    v_mfma_f32_16x16x32_bf16 v[16:19], a[48:51], a[72:75], v[16:19]
    ds_read_b64_tr_b16 a[0:1], v125 offset:0
    v_mfma_f32_16x16x32_bf16 v[20:23], a[48:51], a[76:79], v[20:23]
    ds_read_b64_tr_b16 a[2:3], v125 offset:7168
    v_mfma_f32_16x16x32_bf16 v[24:27], a[48:51], a[80:83], v[24:27]
    ds_read_b64_tr_b16 a[4:5], v126 offset:0
    v_mfma_f32_16x16x32_bf16 v[28:31], a[48:51], a[84:87], v[28:31]
    ds_read_b64_tr_b16 a[6:7], v126 offset:7168
    v_mfma_f32_16x16x32_bf16 v[32:35], a[52:55], a[72:75], v[32:35]
    ds_read_b64_tr_b16 a[8:9], v125 offset:64
    v_mfma_f32_16x16x32_bf16 v[36:39], a[52:55], a[76:79], v[36:39]
    ds_read_b64_tr_b16 a[10:11], v125 offset:7232
    v_mfma_f32_16x16x32_bf16 v[40:43], a[52:55], a[80:83], v[40:43]
    ds_read_b64_tr_b16 a[12:13], v126 offset:64
    v_mfma_f32_16x16x32_bf16 v[44:47], a[52:55], a[84:87], v[44:47]
    ds_read_b64_tr_b16 a[14:15], v126 offset:7232
    v_mfma_f32_16x16x32_bf16 v[48:51], a[56:59], a[72:75], v[48:51]
    ds_read_b64_tr_b16 a[16:17], v125 offset:128
    v_mfma_f32_16x16x32_bf16 v[52:55], a[56:59], a[76:79], v[52:55]
    ds_read_b64_tr_b16 a[18:19], v125 offset:7296
    v_mfma_f32_16x16x32_bf16 v[56:59], a[56:59], a[80:83], v[56:59]
    ds_read_b64_tr_b16 a[20:21], v126 offset:128
    v_mfma_f32_16x16x32_bf16 v[60:63], a[56:59], a[84:87], v[60:63]
    ds_read_b64_tr_b16 a[22:23], v126 offset:7296
    v_mfma_f32_16x16x32_bf16 v[64:67], a[60:63], a[72:75], v[64:67]
    ds_read_b64_tr_b16 a[24:25], v125 offset:192
    v_mfma_f32_16x16x32_bf16 v[68:71], a[60:63], a[76:79], v[68:71]
    ds_read_b64_tr_b16 a[26:27], v125 offset:7360
    v_mfma_f32_16x16x32_bf16 v[72:75], a[60:63], a[80:83], v[72:75]
    v_mfma_f32_16x16x32_bf16 v[76:79], a[60:63], a[84:87], v[76:79]
    v_mfma_f32_16x16x32_bf16 v[80:83], a[64:67], a[72:75], v[80:83]
    v_mfma_f32_16x16x32_bf16 v[84:87], a[64:67], a[76:79], v[84:87]
    v_mfma_f32_16x16x32_bf16 v[88:91], a[64:67], a[80:83], v[88:91]
    v_mfma_f32_16x16x32_bf16 v[92:95], a[64:67], a[84:87], v[92:95]
    v_mfma_f32_16x16x32_bf16 v[96:99], a[68:71], a[72:75], v[96:99]
    v_mfma_f32_16x16x32_bf16 v[100:103], a[68:71], a[76:79], v[100:103]
    v_mfma_f32_16x16x32_bf16 v[104:107], a[68:71], a[80:83], v[104:107]
    v_mfma_f32_16x16x32_bf16 v[108:111], a[68:71], a[84:87], v[108:111]
    v_add_u32 v127, s56, v119
    v_add_u32 v128, s56, v120
    v_add_u32 v129, s56, v121
    s_waitcnt vmcnt(0) lgkmcnt(0)
    s_barrier
    v_mfma_f32_16x16x32_bf16 v[0:3], a[0:3], a[28:31], v[0:3]
    ds_read_b128 a[72:75], v127 offset:0
    s_mov_b32 s22, s56
    s_add_u32 s56, s56, 36864
    v_mfma_f32_16x16x32_bf16 v[4:7], a[0:3], a[32:35], v[4:7]
    ds_read_b128 a[76:79], v127 offset:1024
    s_cmp_eq_u32 s56, 147456
    s_cselect_b32 s56, 0, s56
    v_mfma_f32_16x16x32_bf16 v[8:11], a[0:3], a[36:39], v[8:11]
    ds_read_b128 a[80:83], v127 offset:2048
    v_mfma_f32_16x16x32_bf16 v[12:15], a[0:3], a[40:43], v[12:15]
    ds_read_b128 a[84:87], v127 offset:3072
    v_mfma_f32_16x16x32_bf16 v[16:19], a[4:7], a[28:31], v[16:19]
    ds_read_b64_tr_b16 a[44:45], v128 offset:0
    v_mfma_f32_16x16x32_bf16 v[20:23], a[4:7], a[32:35], v[20:23]
    ds_read_b64_tr_b16 a[46:47], v128 offset:7168
    v_mfma_f32_16x16x32_bf16 v[24:27], a[4:7], a[36:39], v[24:27]
    ds_read_b64_tr_b16 a[48:49], v129 offset:0
    v_mfma_f32_16x16x32_bf16 v[28:31], a[4:7], a[40:43], v[28:31]
    ds_read_b64_tr_b16 a[50:51], v129 offset:7168
    v_mfma_f32_16x16x32_bf16 v[32:35], a[8:11], a[28:31], v[32:35]
    ds_read_b64_tr_b16 a[52:53], v128 offset:64
    v_mfma_f32_16x16x32_bf16 v[36:39], a[8:11], a[32:35], v[36:39]
    ds_read_b64_tr_b16 a[54:55], v128 offset:7232
    v_mfma_f32_16x16x32_bf16 v[40:43], a[8:11], a[36:39], v[40:43]
    ds_read_b64_tr_b16 a[56:57], v129 offset:64
    v_mfma_f32_16x16x32_bf16 v[44:47], a[8:11], a[40:43], v[44:47]
    ds_read_b64_tr_b16 a[58:59], v129 offset:7232
    v_mfma_f32_16x16x32_bf16 v[48:51], a[12:15], a[28:31], v[48:51]
    ds_read_b64_tr_b16 a[60:61], v128 offset:128
    v_mfma_f32_16x16x32_bf16 v[52:55], a[12:15], a[32:35], v[52:55]
    ds_read_b64_tr_b16 a[62:63], v128 offset:7296
    v_mfma_f32_16x16x32_bf16 v[56:59], a[12:15], a[36:39], v[56:59]
    ds_read_b64_tr_b16 a[64:65], v129 offset:128
    v_mfma_f32_16x16x32_bf16 v[60:63], a[12:15], a[40:43], v[60:63]
    ds_read_b64_tr_b16 a[66:67], v129 offset:7296
    v_mfma_f32_16x16x32_bf16 v[64:67], a[16:19], a[28:31], v[64:67]
    ds_read_b64_tr_b16 a[68:69], v128 offset:192
    v_mfma_f32_16x16x32_bf16 v[68:71], a[16:19], a[32:35], v[68:71]
    ds_read_b64_tr_b16 a[70:71], v128 offset:7360
    v_mfma_f32_16x16x32_bf16 v[72:75], a[16:19], a[36:39], v[72:75]
    v_mfma_f32_16x16x32_bf16 v[76:79], a[16:19], a[40:43], v[76:79]
    v_mfma_f32_16x16x32_bf16 v[80:83], a[20:23], a[28:31], v[80:83]
    v_mfma_f32_16x16x32_bf16 v[84:87], a[20:23], a[32:35], v[84:87]
    v_mfma_f32_16x16x32_bf16 v[88:91], a[20:23], a[36:39], v[88:91]
    v_mfma_f32_16x16x32_bf16 v[92:95], a[20:23], a[40:43], v[92:95]
    v_mfma_f32_16x16x32_bf16 v[96:99], a[24:27], a[28:31], v[96:99]
    v_mfma_f32_16x16x32_bf16 v[100:103], a[24:27], a[32:35], v[100:103]
    v_mfma_f32_16x16x32_bf16 v[104:107], a[24:27], a[36:39], v[104:107]
    v_mfma_f32_16x16x32_bf16 v[108:111], a[24:27], a[40:43], v[108:111]
    v_add_u32 v124, s56, v119
    v_add_u32 v125, s56, v120
    v_add_u32 v126, s56, v121
    s_waitcnt lgkmcnt(0)
    v_mfma_f32_16x16x32_bf16 v[0:3], a[44:47], a[72:75], v[0:3]
    v_mfma_f32_16x16x32_bf16 v[4:7], a[44:47], a[76:79], v[4:7]
    v_mfma_f32_16x16x32_bf16 v[8:11], a[44:47], a[80:83], v[8:11]
    v_mfma_f32_16x16x32_bf16 v[12:15], a[44:47], a[84:87], v[12:15]
    v_mfma_f32_16x16x32_bf16 v[16:19], a[48:51], a[72:75], v[16:19]
    v_mfma_f32_16x16x32_bf16 v[20:23], a[48:51], a[76:79], v[20:23]
    v_mfma_f32_16x16x32_bf16 v[24:27], a[48:51], a[80:83], v[24:27]
    v_mfma_f32_16x16x32_bf16 v[28:31], a[48:51], a[84:87], v[28:31]
    v_mfma_f32_16x16x32_bf16 v[32:35], a[52:55], a[72:75], v[32:35]
    v_mfma_f32_16x16x32_bf16 v[36:39], a[52:55], a[76:79], v[36:39]
    v_mfma_f32_16x16x32_bf16 v[40:43], a[52:55], a[80:83], v[40:43]
    v_mfma_f32_16x16x32_bf16 v[44:47], a[52:55], a[84:87], v[44:47]
    v_mfma_f32_16x16x32_bf16 v[48:51], a[56:59], a[72:75], v[48:51]
    v_mfma_f32_16x16x32_bf16 v[52:55], a[56:59], a[76:79], v[52:55]
    v_mfma_f32_16x16x32_bf16 v[56:59], a[56:59], a[80:83], v[56:59]
    v_mfma_f32_16x16x32_bf16 v[60:63], a[56:59], a[84:87], v[60:63]
    v_mfma_f32_16x16x32_bf16 v[64:67], a[60:63], a[72:75], v[64:67]
    v_mfma_f32_16x16x32_bf16 v[68:71], a[60:63], a[76:79], v[68:71]
    v_mfma_f32_16x16x32_bf16 v[72:75], a[60:63], a[80:83], v[72:75]
    v_mfma_f32_16x16x32_bf16 v[76:79], a[60:63], a[84:87], v[76:79]
    v_mfma_f32_16x16x32_bf16 v[80:83], a[64:67], a[72:75], v[80:83]
    v_mfma_f32_16x16x32_bf16 v[84:87], a[64:67], a[76:79], v[84:87]
    v_mfma_f32_16x16x32_bf16 v[88:91], a[64:67], a[80:83], v[88:91]
    v_mfma_f32_16x16x32_bf16 v[92:95], a[64:67], a[84:87], v[92:95]
    v_mfma_f32_16x16x32_bf16 v[96:99], a[68:71], a[72:75], v[96:99]
    v_mfma_f32_16x16x32_bf16 v[100:103], a[68:71], a[76:79], v[100:103]
    v_mfma_f32_16x16x32_bf16 v[104:107], a[68:71], a[80:83], v[104:107]
    v_mfma_f32_16x16x32_bf16 v[108:111], a[68:71], a[84:87], v[108:111]
    s_waitcnt vmcnt(0) lgkmcnt(0)
    s_nop 7
    s_nop 7
    s_barrier
    s_and_b32 s82, s2, 7
    s_lshr_b32 s83, s2, 3
    s_and_b32 s47, s83, 1
    s_and_b32 s85, s82, 3
    s_lshl_b32 s85, s85, 2
    s_lshr_b32 s84, s83, 1
    s_and_b32 s84, s84, 3
    s_add_u32 s85, s85, s84
    s_lshr_b32 s86, s82, 2
    s_lshl_b32 s86, s86, 2
    s_lshr_b32 s84, s83, 3
    s_add_u32 s86, s86, s84
    s_xor_b32 s46, s2, 8
    s_mul_i32 s45, s47, 56
    s_mul_i32 s44, s45, 65536
    s_load_dwordx2 s[64:65], s[0:1], 72
    s_load_dwordx2 s[66:67], s[0:1], 72
    v_mbcnt_lo_u32_b32 v138, -1, 0
    v_mbcnt_hi_u32_b32 v138, -1, v138
    s_and_b32 s69, s16, 7
    s_mul_i32 s68, s69, 1
    s_lshl_b32 s68, s68, 6
    s_mul_i32 s69, s86, 256
    v_add_u32 v134, s68, v138
    v_mul_u32_u24 v135, 4096, v134
    v_lshrrev_b32 v135, 16, v135
    v_mul_u32_u24 v136, 16, v135
    v_sub_u32 v136, v134, v136
    v_lshrrev_b32 v137, 0, v135
    v_and_b32 v137, 7, v137
    v_lshlrev_b32 v137, 1, v137
    v_xor_b32 v136, v136, v137
    v_lshlrev_b32 v136, 4, v136
    v_mul_u32_u24 v135, 2048, v135
    v_add3_u32 v143, v135, v136, s69
    s_waitcnt lgkmcnt(0)
    s_mov_b32 s60, s64
    s_and_b32 s61, s65, 0xffff
    s_mov_b32 s62, 7340032
    s_mov_b32 s63, 0x00020000
    s_and_b32 s69, s16, 7
    s_mul_i32 s68, s69, 1
    s_lshl_b32 s68, s68, 10
    s_add_u32 s68, s68, 8192
    s_add_u32 s69, s44, 0
    s_add_u32 m0, s68, 0
    s_nop 0
    buffer_load_dwordx4 v143, s[60:63], s69 offen lds
    s_add_u32 s69, s44, 65536
    s_add_u32 m0, s68, 16384
    s_nop 0
    buffer_load_dwordx4 v143, s[60:63], s69 offen lds
    s_add_u32 s69, s44, 131072
    s_add_u32 m0, s68, 32768
    s_nop 0
    buffer_load_dwordx4 v143, s[60:63], s69 offen lds
    s_add_u32 s69, s44, 196608
    s_add_u32 m0, s68, 49152
    s_nop 0
    buffer_load_dwordx4 v143, s[60:63], s69 offen lds
    s_add_u32 s69, s44, 262144
    s_add_u32 m0, s68, 65536
    s_nop 0
    buffer_load_dwordx4 v143, s[60:63], s69 offen lds
    s_add_u32 s69, s44, 327680
    s_add_u32 m0, s68, 81920
    s_nop 0
    buffer_load_dwordx4 v143, s[60:63], s69 offen lds
    s_add_u32 s69, s44, 393216
    s_add_u32 m0, s68, 98304
    s_nop 0
    buffer_load_dwordx4 v143, s[60:63], s69 offen lds
    s_add_u32 s69, s44, 458752
    s_add_u32 m0, s68, 114688
    s_nop 0
    buffer_load_dwordx4 v143, s[60:63], s69 offen lds
    s_add_u32 s12, s36, 13631488
    s_addc_u32 s13, s37, 0
    s_and_b32 s13, s13, 0xffff
    s_mov_b32 s14, 14680064
    s_mov_b32 s15, 0x00020000
    s_mul_i32 s24, s27, 14
    s_mul_i32 s25, s29, 7
    s_add_u32 s24, s24, s25
    s_lshr_b32 s24, s24, 1
    s_lshl_b32 s24, s24, 10
    s_lshl_b32 s25, s26, 3
    s_lshl_b32 s48, s28, 2
    s_add_u32 s25, s25, s48
    s_mul_i32 s25, s25, 114688
    s_add_u32 s24, s24, s25
    v_lshl_add_u32 v114, v112, 4, s24
    s_mov_b32 s50, 0xbfb8aa3b
    s_mov_b32 s51, 0xbfb8aa3b
    v_cvt_pk_bf16_f32 v0, v0, v1
    v_cvt_pk_bf16_f32 v1, v2, v3
    v_cvt_pk_bf16_f32 v4, v4, v5
    v_cvt_pk_bf16_f32 v5, v6, v7
    v_cvt_pk_bf16_f32 v8, v8, v9
    v_cvt_pk_bf16_f32 v9, v10, v11
    v_cvt_pk_bf16_f32 v12, v12, v13
    v_cvt_pk_bf16_f32 v13, v14, v15
    v_cvt_pk_bf16_f32 v16, v16, v17
    v_cvt_pk_bf16_f32 v17, v18, v19
    v_cvt_pk_bf16_f32 v20, v20, v21
    v_cvt_pk_bf16_f32 v21, v22, v23
    v_cvt_pk_bf16_f32 v24, v24, v25
    v_cvt_pk_bf16_f32 v25, v26, v27
    v_cvt_pk_bf16_f32 v28, v28, v29
    v_cvt_pk_bf16_f32 v29, v30, v31
    v_cvt_pk_bf16_f32 v32, v32, v33
    v_cvt_pk_bf16_f32 v33, v34, v35
    v_cvt_pk_bf16_f32 v36, v36, v37
    v_cvt_pk_bf16_f32 v37, v38, v39
    v_cvt_pk_bf16_f32 v40, v40, v41
    v_cvt_pk_bf16_f32 v41, v42, v43
    v_cvt_pk_bf16_f32 v44, v44, v45
    v_cvt_pk_bf16_f32 v45, v46, v47
    v_cvt_pk_bf16_f32 v48, v48, v49
    v_cvt_pk_bf16_f32 v49, v50, v51
    v_cvt_pk_bf16_f32 v52, v52, v53
    v_cvt_pk_bf16_f32 v53, v54, v55
    v_cvt_pk_bf16_f32 v56, v56, v57
    v_cvt_pk_bf16_f32 v57, v58, v59
    v_cvt_pk_bf16_f32 v60, v60, v61
    v_cvt_pk_bf16_f32 v61, v62, v63
    v_cvt_pk_bf16_f32 v64, v64, v65
    v_cvt_pk_bf16_f32 v65, v66, v67
    v_cvt_pk_bf16_f32 v68, v68, v69
    v_cvt_pk_bf16_f32 v69, v70, v71
    v_cvt_pk_bf16_f32 v72, v72, v73
    v_cvt_pk_bf16_f32 v73, v74, v75
    v_cvt_pk_bf16_f32 v76, v76, v77
    v_cvt_pk_bf16_f32 v77, v78, v79
    v_cvt_pk_bf16_f32 v80, v80, v81
    v_cvt_pk_bf16_f32 v81, v82, v83
    v_cvt_pk_bf16_f32 v84, v84, v85
    v_cvt_pk_bf16_f32 v85, v86, v87
    v_cvt_pk_bf16_f32 v88, v88, v89
    v_cvt_pk_bf16_f32 v89, v90, v91
    v_cvt_pk_bf16_f32 v92, v92, v93
    v_cvt_pk_bf16_f32 v93, v94, v95
    v_cvt_pk_bf16_f32 v96, v96, v97
    v_cvt_pk_bf16_f32 v97, v98, v99
    v_cvt_pk_bf16_f32 v100, v100, v101
    v_cvt_pk_bf16_f32 v101, v102, v103
    v_cvt_pk_bf16_f32 v104, v104, v105
    v_cvt_pk_bf16_f32 v105, v106, v107
    v_cvt_pk_bf16_f32 v108, v108, v109
    v_cvt_pk_bf16_f32 v109, v110, v111
    s_mul_i32 s48, s16, 16384
    s_add_u32 s48, s48, 0
    v_lshl_add_u32 v115, v112, 3, s48
    s_xor_b32 s48, s16, 4
    s_mul_i32 s48, s48, 16384
    s_add_u32 s48, s48, 0
    v_lshl_add_u32 v132, v112, 3, s48
    s_lshl_b32 s48, s57, 1
    s_add_u32 s48, s48, s29
    s_cmp_eq_u32 s48, 1
    s_cbranch_scc1 Lp_31
    s_cmp_eq_u32 s48, 2
    s_cbranch_scc1 Lp_32
    s_cmp_eq_u32 s48, 3
    s_cbranch_scc1 Lp_33
    ds_write_b64 v115, v[8:9] offset:0
    ds_write_b64 v115, v[12:13] offset:512
    ds_write_b64 v115, v[24:25] offset:1024
    ds_write_b64 v115, v[28:29] offset:1536
    ds_write_b64 v115, v[40:41] offset:2048
    ds_write_b64 v115, v[44:45] offset:2560
    ds_write_b64 v115, v[56:57] offset:3072
    ds_write_b64 v115, v[60:61] offset:3584
    ds_write_b64 v115, v[72:73] offset:4096
    ds_write_b64 v115, v[76:77] offset:4608
    ds_write_b64 v115, v[88:89] offset:5120
    ds_write_b64 v115, v[92:93] offset:5632
    ds_write_b64 v115, v[104:105] offset:6144
    ds_write_b64 v115, v[108:109] offset:6656
    s_waitcnt lgkmcnt(0)
    s_barrier
    ds_read_b64 v[2:3], v132 offset:0
    ds_read_b64 v[6:7], v132 offset:512
    ds_read_b64 v[18:19], v132 offset:1024
    ds_read_b64 v[22:23], v132 offset:1536
    ds_read_b64 v[34:35], v132 offset:2048
    ds_read_b64 v[38:39], v132 offset:2560
    ds_read_b64 v[50:51], v132 offset:3072
    ds_read_b64 v[54:55], v132 offset:3584
    ds_read_b64 v[66:67], v132 offset:4096
    ds_read_b64 v[70:71], v132 offset:4608
    ds_read_b64 v[82:83], v132 offset:5120
    ds_read_b64 v[86:87], v132 offset:5632
    ds_read_b64 v[98:99], v132 offset:6144
    ds_read_b64 v[102:103], v132 offset:6656
    s_waitcnt lgkmcnt(0)
    v_lshlrev_b32 v8, 16, v0
    v_and_b32 v9, s40, v0
    v_lshlrev_b32 v10, 16, v1
    v_and_b32 v11, s40, v1
    v_lshlrev_b32 v24, 16, v16
    v_and_b32 v25, s40, v16
    v_lshlrev_b32 v26, 16, v17
    v_and_b32 v27, s40, v17
    v_pk_mul_f32 v[116:117], v[8:9], s[50:51]
    v_pk_mul_f32 v[118:119], v[10:11], s[50:51]
    v_pk_mul_f32 v[124:125], v[24:25], s[50:51]
    v_pk_mul_f32 v[126:127], v[26:27], s[50:51]
    v_exp_f32 v116, v116
    v_exp_f32 v117, v117
    v_exp_f32 v118, v118
    v_exp_f32 v119, v119
    v_exp_f32 v124, v124
    v_exp_f32 v125, v125
    v_exp_f32 v126, v126
    v_exp_f32 v127, v127
    v_lshlrev_b32 v120, 16, v2
    v_and_b32 v121, s40, v2
    v_lshlrev_b32 v122, 16, v3
    v_and_b32 v123, s40, v3
    v_lshlrev_b32 v128, 16, v18
    v_and_b32 v129, s40, v18
    v_lshlrev_b32 v130, 16, v19
    v_and_b32 v131, s40, v19
    v_pk_add_f32 v[116:117], v[116:117], 1.0 op_sel_hi:[1,0]
    v_pk_add_f32 v[118:119], v[118:119], 1.0 op_sel_hi:[1,0]
    v_pk_add_f32 v[124:125], v[124:125], 1.0 op_sel_hi:[1,0]
    v_pk_add_f32 v[126:127], v[126:127], 1.0 op_sel_hi:[1,0]
    v_rcp_f32 v116, v116
    v_rcp_f32 v117, v117
    v_rcp_f32 v118, v118
    v_rcp_f32 v119, v119
    v_rcp_f32 v124, v124
    v_rcp_f32 v125, v125
    v_rcp_f32 v126, v126
    v_rcp_f32 v127, v127
    s_nop 0
    v_pk_mul_f32 v[116:117], v[116:117], v[8:9]
    v_pk_mul_f32 v[118:119], v[118:119], v[10:11]
    v_pk_mul_f32 v[124:125], v[124:125], v[24:25]
    v_pk_mul_f32 v[126:127], v[126:127], v[26:27]
    v_cvt_pk_bf16_f32 v8, v116, v117
    v_cvt_pk_bf16_f32 v9, v118, v119
    v_cvt_pk_bf16_f32 v24, v124, v125
    v_cvt_pk_bf16_f32 v25, v126, v127
    v_lshlrev_b32 v116, 16, v8
    v_and_b32 v117, s40, v8
    v_lshlrev_b32 v118, 16, v9
    v_and_b32 v119, s40, v9
    v_lshlrev_b32 v124, 16, v24
    v_and_b32 v125, s40, v24
    v_lshlrev_b32 v126, 16, v25
    v_and_b32 v127, s40, v25
    v_pk_mul_f32 v[116:117], v[116:117], v[120:121]
    v_pk_mul_f32 v[118:119], v[118:119], v[122:123]
    v_pk_mul_f32 v[124:125], v[124:125], v[128:129]
    v_pk_mul_f32 v[126:127], v[126:127], v[130:131]
    v_cvt_pk_bf16_f32 v8, v116, v117
    v_cvt_pk_bf16_f32 v9, v118, v119
    v_cvt_pk_bf16_f32 v10, v124, v125
    v_cvt_pk_bf16_f32 v11, v126, v127
    s_mov_b32 s53, 0
    buffer_store_dwordx4 v[8:11], v114, s[12:15], s53 offen sc1
    v_lshlrev_b32 v12, 16, v4
    v_and_b32 v13, s40, v4
    v_lshlrev_b32 v14, 16, v5
    v_and_b32 v15, s40, v5
    v_lshlrev_b32 v28, 16, v20
    v_and_b32 v29, s40, v20
    v_lshlrev_b32 v30, 16, v21
    v_and_b32 v31, s40, v21
    v_pk_mul_f32 v[116:117], v[12:13], s[50:51]
    v_pk_mul_f32 v[118:119], v[14:15], s[50:51]
    v_pk_mul_f32 v[124:125], v[28:29], s[50:51]
    v_pk_mul_f32 v[126:127], v[30:31], s[50:51]
    v_exp_f32 v116, v116
    v_exp_f32 v117, v117
    v_exp_f32 v118, v118
    v_exp_f32 v119, v119
    v_exp_f32 v124, v124
    v_exp_f32 v125, v125
    v_exp_f32 v126, v126
    v_exp_f32 v127, v127
    v_lshlrev_b32 v120, 16, v6
    v_and_b32 v121, s40, v6
    v_lshlrev_b32 v122, 16, v7
    v_and_b32 v123, s40, v7
    v_lshlrev_b32 v128, 16, v22
    v_and_b32 v129, s40, v22
    v_lshlrev_b32 v130, 16, v23
    v_and_b32 v131, s40, v23
    v_pk_add_f32 v[116:117], v[116:117], 1.0 op_sel_hi:[1,0]
    v_pk_add_f32 v[118:119], v[118:119], 1.0 op_sel_hi:[1,0]
    v_pk_add_f32 v[124:125], v[124:125], 1.0 op_sel_hi:[1,0]
    v_pk_add_f32 v[126:127], v[126:127], 1.0 op_sel_hi:[1,0]
    v_rcp_f32 v116, v116
    v_rcp_f32 v117, v117
    v_rcp_f32 v118, v118
    v_rcp_f32 v119, v119
    v_rcp_f32 v124, v124
    v_rcp_f32 v125, v125
    v_rcp_f32 v126, v126
    v_rcp_f32 v127, v127
    s_nop 0
    v_pk_mul_f32 v[116:117], v[116:117], v[12:13]
    v_pk_mul_f32 v[118:119], v[118:119], v[14:15]
    v_pk_mul_f32 v[124:125], v[124:125], v[28:29]
    v_pk_mul_f32 v[126:127], v[126:127], v[30:31]
    v_cvt_pk_bf16_f32 v12, v116, v117
    v_cvt_pk_bf16_f32 v13, v118, v119
    v_cvt_pk_bf16_f32 v28, v124, v125
    v_cvt_pk_bf16_f32 v29, v126, v127
    v_lshlrev_b32 v116, 16, v12
    v_and_b32 v117, s40, v12
    v_lshlrev_b32 v118, 16, v13
    v_and_b32 v119, s40, v13
    v_lshlrev_b32 v124, 16, v28
    v_and_b32 v125, s40, v28
    v_lshlrev_b32 v126, 16, v29
    v_and_b32 v127, s40, v29
    v_pk_mul_f32 v[116:117], v[116:117], v[120:121]
    v_pk_mul_f32 v[118:119], v[118:119], v[122:123]
    v_pk_mul_f32 v[124:125], v[124:125], v[128:129]
    v_pk_mul_f32 v[126:127], v[126:127], v[130:131]
    v_cvt_pk_bf16_f32 v12, v116, v117
    v_cvt_pk_bf16_f32 v13, v118, v119
    v_cvt_pk_bf16_f32 v14, v124, v125
    v_cvt_pk_bf16_f32 v15, v126, v127
    s_mov_b32 s53, 114688
    buffer_store_dwordx4 v[12:15], v114, s[12:15], s53 offen sc1
    v_lshlrev_b32 v40, 16, v32
    v_and_b32 v41, s40, v32
    v_lshlrev_b32 v42, 16, v33
    v_and_b32 v43, s40, v33
    v_lshlrev_b32 v56, 16, v48
    v_and_b32 v57, s40, v48
    v_lshlrev_b32 v58, 16, v49
    v_and_b32 v59, s40, v49
    v_pk_mul_f32 v[116:117], v[40:41], s[50:51]
    v_pk_mul_f32 v[118:119], v[42:43], s[50:51]
    v_pk_mul_f32 v[124:125], v[56:57], s[50:51]
    v_pk_mul_f32 v[126:127], v[58:59], s[50:51]
    v_exp_f32 v116, v116
    v_exp_f32 v117, v117
    v_exp_f32 v118, v118
    v_exp_f32 v119, v119
    v_exp_f32 v124, v124
    v_exp_f32 v125, v125
    v_exp_f32 v126, v126
    v_exp_f32 v127, v127
    v_lshlrev_b32 v120, 16, v34
    v_and_b32 v121, s40, v34
    v_lshlrev_b32 v122, 16, v35
    v_and_b32 v123, s40, v35
    v_lshlrev_b32 v128, 16, v50
    v_and_b32 v129, s40, v50
    v_lshlrev_b32 v130, 16, v51
    v_and_b32 v131, s40, v51
    v_pk_add_f32 v[116:117], v[116:117], 1.0 op_sel_hi:[1,0]
    v_pk_add_f32 v[118:119], v[118:119], 1.0 op_sel_hi:[1,0]
    v_pk_add_f32 v[124:125], v[124:125], 1.0 op_sel_hi:[1,0]
    v_pk_add_f32 v[126:127], v[126:127], 1.0 op_sel_hi:[1,0]
    v_rcp_f32 v116, v116
    v_rcp_f32 v117, v117
    v_rcp_f32 v118, v118
    v_rcp_f32 v119, v119
    v_rcp_f32 v124, v124
    v_rcp_f32 v125, v125
    v_rcp_f32 v126, v126
    v_rcp_f32 v127, v127
    s_nop 0
    v_pk_mul_f32 v[116:117], v[116:117], v[40:41]
    v_pk_mul_f32 v[118:119], v[118:119], v[42:43]
    v_pk_mul_f32 v[124:125], v[124:125], v[56:57]
    v_pk_mul_f32 v[126:127], v[126:127], v[58:59]
    v_cvt_pk_bf16_f32 v40, v116, v117
    v_cvt_pk_bf16_f32 v41, v118, v119
    v_cvt_pk_bf16_f32 v56, v124, v125
    v_cvt_pk_bf16_f32 v57, v126, v127
    v_lshlrev_b32 v116, 16, v40
    v_and_b32 v117, s40, v40
    v_lshlrev_b32 v118, 16, v41
    v_and_b32 v119, s40, v41
    v_lshlrev_b32 v124, 16, v56
    v_and_b32 v125, s40, v56
    v_lshlrev_b32 v126, 16, v57
    v_and_b32 v127, s40, v57
    v_pk_mul_f32 v[116:117], v[116:117], v[120:121]
    v_pk_mul_f32 v[118:119], v[118:119], v[122:123]
    v_pk_mul_f32 v[124:125], v[124:125], v[128:129]
    v_pk_mul_f32 v[126:127], v[126:127], v[130:131]
    v_cvt_pk_bf16_f32 v40, v116, v117
    v_cvt_pk_bf16_f32 v41, v118, v119
    v_cvt_pk_bf16_f32 v42, v124, v125
    v_cvt_pk_bf16_f32 v43, v126, v127
    s_mov_b32 s53, 1024
    buffer_store_dwordx4 v[40:43], v114, s[12:15], s53 offen sc1
    v_lshlrev_b32 v44, 16, v36
    v_and_b32 v45, s40, v36
    v_lshlrev_b32 v46, 16, v37
    v_and_b32 v47, s40, v37
    v_lshlrev_b32 v60, 16, v52
    v_and_b32 v61, s40, v52
    v_lshlrev_b32 v62, 16, v53
    v_and_b32 v63, s40, v53
    v_pk_mul_f32 v[116:117], v[44:45], s[50:51]
    v_pk_mul_f32 v[118:119], v[46:47], s[50:51]
    v_pk_mul_f32 v[124:125], v[60:61], s[50:51]
    v_pk_mul_f32 v[126:127], v[62:63], s[50:51]
    v_exp_f32 v116, v116
    v_exp_f32 v117, v117
    v_exp_f32 v118, v118
    v_exp_f32 v119, v119
    v_exp_f32 v124, v124
    v_exp_f32 v125, v125
    v_exp_f32 v126, v126
    v_exp_f32 v127, v127
    v_lshlrev_b32 v120, 16, v38
    v_and_b32 v121, s40, v38
    v_lshlrev_b32 v122, 16, v39
    v_and_b32 v123, s40, v39
    v_lshlrev_b32 v128, 16, v54
    v_and_b32 v129, s40, v54
    v_lshlrev_b32 v130, 16, v55
    v_and_b32 v131, s40, v55
    v_pk_add_f32 v[116:117], v[116:117], 1.0 op_sel_hi:[1,0]
    v_pk_add_f32 v[118:119], v[118:119], 1.0 op_sel_hi:[1,0]
    v_pk_add_f32 v[124:125], v[124:125], 1.0 op_sel_hi:[1,0]
    v_pk_add_f32 v[126:127], v[126:127], 1.0 op_sel_hi:[1,0]
    v_rcp_f32 v116, v116
    v_rcp_f32 v117, v117
    v_rcp_f32 v118, v118
    v_rcp_f32 v119, v119
    v_rcp_f32 v124, v124
    v_rcp_f32 v125, v125
    v_rcp_f32 v126, v126
    v_rcp_f32 v127, v127
    s_nop 0
    v_pk_mul_f32 v[116:117], v[116:117], v[44:45]
    v_pk_mul_f32 v[118:119], v[118:119], v[46:47]
    v_pk_mul_f32 v[124:125], v[124:125], v[60:61]
    v_pk_mul_f32 v[126:127], v[126:127], v[62:63]
    v_cvt_pk_bf16_f32 v44, v116, v117
    v_cvt_pk_bf16_f32 v45, v118, v119
    v_cvt_pk_bf16_f32 v60, v124, v125
    v_cvt_pk_bf16_f32 v61, v126, v127
    v_lshlrev_b32 v116, 16, v44
    v_and_b32 v117, s40, v44
    v_lshlrev_b32 v118, 16, v45
    v_and_b32 v119, s40, v45
    v_lshlrev_b32 v124, 16, v60
    v_and_b32 v125, s40, v60
    v_lshlrev_b32 v126, 16, v61
    v_and_b32 v127, s40, v61
    v_pk_mul_f32 v[116:117], v[116:117], v[120:121]
    v_pk_mul_f32 v[118:119], v[118:119], v[122:123]
    v_pk_mul_f32 v[124:125], v[124:125], v[128:129]
    v_pk_mul_f32 v[126:127], v[126:127], v[130:131]
    v_cvt_pk_bf16_f32 v44, v116, v117
    v_cvt_pk_bf16_f32 v45, v118, v119
    v_cvt_pk_bf16_f32 v46, v124, v125
    v_cvt_pk_bf16_f32 v47, v126, v127
    s_mov_b32 s53, 115712
    buffer_store_dwordx4 v[44:47], v114, s[12:15], s53 offen sc1
    v_lshlrev_b32 v72, 16, v64
    v_and_b32 v73, s40, v64
    v_lshlrev_b32 v74, 16, v65
    v_and_b32 v75, s40, v65
    v_lshlrev_b32 v88, 16, v80
    v_and_b32 v89, s40, v80
    v_lshlrev_b32 v90, 16, v81
    v_and_b32 v91, s40, v81
    v_pk_mul_f32 v[116:117], v[72:73], s[50:51]
    v_pk_mul_f32 v[118:119], v[74:75], s[50:51]
    v_pk_mul_f32 v[124:125], v[88:89], s[50:51]
    v_pk_mul_f32 v[126:127], v[90:91], s[50:51]
    v_exp_f32 v116, v116
    v_exp_f32 v117, v117
    v_exp_f32 v118, v118
    v_exp_f32 v119, v119
    v_exp_f32 v124, v124
    v_exp_f32 v125, v125
    v_exp_f32 v126, v126
    v_exp_f32 v127, v127
    v_lshlrev_b32 v120, 16, v66
    v_and_b32 v121, s40, v66
    v_lshlrev_b32 v122, 16, v67
    v_and_b32 v123, s40, v67
    v_lshlrev_b32 v128, 16, v82
    v_and_b32 v129, s40, v82
    v_lshlrev_b32 v130, 16, v83
    v_and_b32 v131, s40, v83
    v_pk_add_f32 v[116:117], v[116:117], 1.0 op_sel_hi:[1,0]
    v_pk_add_f32 v[118:119], v[118:119], 1.0 op_sel_hi:[1,0]
    v_pk_add_f32 v[124:125], v[124:125], 1.0 op_sel_hi:[1,0]
    v_pk_add_f32 v[126:127], v[126:127], 1.0 op_sel_hi:[1,0]
    v_rcp_f32 v116, v116
    v_rcp_f32 v117, v117
    v_rcp_f32 v118, v118
    v_rcp_f32 v119, v119
    v_rcp_f32 v124, v124
    v_rcp_f32 v125, v125
    v_rcp_f32 v126, v126
    v_rcp_f32 v127, v127
    s_nop 0
    v_pk_mul_f32 v[116:117], v[116:117], v[72:73]
    v_pk_mul_f32 v[118:119], v[118:119], v[74:75]
    v_pk_mul_f32 v[124:125], v[124:125], v[88:89]
    v_pk_mul_f32 v[126:127], v[126:127], v[90:91]
    v_cvt_pk_bf16_f32 v72, v116, v117
    v_cvt_pk_bf16_f32 v73, v118, v119
    v_cvt_pk_bf16_f32 v88, v124, v125
    v_cvt_pk_bf16_f32 v89, v126, v127
    v_lshlrev_b32 v116, 16, v72
    v_and_b32 v117, s40, v72
    v_lshlrev_b32 v118, 16, v73
    v_and_b32 v119, s40, v73
    v_lshlrev_b32 v124, 16, v88
    v_and_b32 v125, s40, v88
    v_lshlrev_b32 v126, 16, v89
    v_and_b32 v127, s40, v89
    v_pk_mul_f32 v[116:117], v[116:117], v[120:121]
    v_pk_mul_f32 v[118:119], v[118:119], v[122:123]
    v_pk_mul_f32 v[124:125], v[124:125], v[128:129]
    v_pk_mul_f32 v[126:127], v[126:127], v[130:131]
    v_cvt_pk_bf16_f32 v72, v116, v117
    v_cvt_pk_bf16_f32 v73, v118, v119
    v_cvt_pk_bf16_f32 v74, v124, v125
    v_cvt_pk_bf16_f32 v75, v126, v127
    s_mov_b32 s53, 2048
    buffer_store_dwordx4 v[72:75], v114, s[12:15], s53 offen sc1
    v_lshlrev_b32 v76, 16, v68
    v_and_b32 v77, s40, v68
    v_lshlrev_b32 v78, 16, v69
    v_and_b32 v79, s40, v69
    v_lshlrev_b32 v92, 16, v84
    v_and_b32 v93, s40, v84
    v_lshlrev_b32 v94, 16, v85
    v_and_b32 v95, s40, v85
    v_pk_mul_f32 v[116:117], v[76:77], s[50:51]
    v_pk_mul_f32 v[118:119], v[78:79], s[50:51]
    v_pk_mul_f32 v[124:125], v[92:93], s[50:51]
    v_pk_mul_f32 v[126:127], v[94:95], s[50:51]
    v_exp_f32 v116, v116
    v_exp_f32 v117, v117
    v_exp_f32 v118, v118
    v_exp_f32 v119, v119
    v_exp_f32 v124, v124
    v_exp_f32 v125, v125
    v_exp_f32 v126, v126
    v_exp_f32 v127, v127
    v_lshlrev_b32 v120, 16, v70
    v_and_b32 v121, s40, v70
    v_lshlrev_b32 v122, 16, v71
    v_and_b32 v123, s40, v71
    v_lshlrev_b32 v128, 16, v86
    v_and_b32 v129, s40, v86
    v_lshlrev_b32 v130, 16, v87
    v_and_b32 v131, s40, v87
    v_pk_add_f32 v[116:117], v[116:117], 1.0 op_sel_hi:[1,0]
    v_pk_add_f32 v[118:119], v[118:119], 1.0 op_sel_hi:[1,0]
    v_pk_add_f32 v[124:125], v[124:125], 1.0 op_sel_hi:[1,0]
    v_pk_add_f32 v[126:127], v[126:127], 1.0 op_sel_hi:[1,0]
    v_rcp_f32 v116, v116
    v_rcp_f32 v117, v117
    v_rcp_f32 v118, v118
    v_rcp_f32 v119, v119
    v_rcp_f32 v124, v124
    v_rcp_f32 v125, v125
    v_rcp_f32 v126, v126
    v_rcp_f32 v127, v127
    s_nop 0
    v_pk_mul_f32 v[116:117], v[116:117], v[76:77]
    v_pk_mul_f32 v[118:119], v[118:119], v[78:79]
    v_pk_mul_f32 v[124:125], v[124:125], v[92:93]
    v_pk_mul_f32 v[126:127], v[126:127], v[94:95]
    v_cvt_pk_bf16_f32 v76, v116, v117
    v_cvt_pk_bf16_f32 v77, v118, v119
    v_cvt_pk_bf16_f32 v92, v124, v125
    v_cvt_pk_bf16_f32 v93, v126, v127
    v_lshlrev_b32 v116, 16, v76
    v_and_b32 v117, s40, v76
    v_lshlrev_b32 v118, 16, v77
    v_and_b32 v119, s40, v77
    v_lshlrev_b32 v124, 16, v92
    v_and_b32 v125, s40, v92
    v_lshlrev_b32 v126, 16, v93
    v_and_b32 v127, s40, v93
    v_pk_mul_f32 v[116:117], v[116:117], v[120:121]
    v_pk_mul_f32 v[118:119], v[118:119], v[122:123]
    v_pk_mul_f32 v[124:125], v[124:125], v[128:129]
    v_pk_mul_f32 v[126:127], v[126:127], v[130:131]
    v_cvt_pk_bf16_f32 v76, v116, v117
    v_cvt_pk_bf16_f32 v77, v118, v119
    v_cvt_pk_bf16_f32 v78, v124, v125
    v_cvt_pk_bf16_f32 v79, v126, v127
    s_mov_b32 s53, 116736
    buffer_store_dwordx4 v[76:79], v114, s[12:15], s53 offen sc1
    v_lshlrev_b32 v104, 16, v96
    v_and_b32 v105, s40, v96
    v_lshlrev_b32 v106, 16, v97
    v_and_b32 v107, s40, v97
    v_pk_mul_f32 v[116:117], v[104:105], s[50:51]
    v_pk_mul_f32 v[118:119], v[106:107], s[50:51]
    v_exp_f32 v116, v116
    v_exp_f32 v117, v117
    v_exp_f32 v118, v118
    v_exp_f32 v119, v119
    v_lshlrev_b32 v120, 16, v98
    v_and_b32 v121, s40, v98
    v_lshlrev_b32 v122, 16, v99
    v_and_b32 v123, s40, v99
    v_pk_add_f32 v[116:117], v[116:117], 1.0 op_sel_hi:[1,0]
    v_pk_add_f32 v[118:119], v[118:119], 1.0 op_sel_hi:[1,0]
    v_rcp_f32 v116, v116
    v_rcp_f32 v117, v117
    v_rcp_f32 v118, v118
    v_rcp_f32 v119, v119
    s_nop 0
    v_pk_mul_f32 v[116:117], v[116:117], v[104:105]
    v_pk_mul_f32 v[118:119], v[118:119], v[106:107]
    v_cvt_pk_bf16_f32 v104, v116, v117
    v_cvt_pk_bf16_f32 v105, v118, v119
    v_lshlrev_b32 v116, 16, v104
    v_and_b32 v117, s40, v104
    v_lshlrev_b32 v118, 16, v105
    v_and_b32 v119, s40, v105
    v_pk_mul_f32 v[116:117], v[116:117], v[120:121]
    v_pk_mul_f32 v[118:119], v[118:119], v[122:123]
    v_cvt_pk_bf16_f32 v104, v116, v117
    v_cvt_pk_bf16_f32 v105, v118, v119
    s_mov_b32 s53, 3072
    buffer_store_dwordx2 v[104:105], v114, s[12:15], s53 offen offset:0 sc1
    v_lshlrev_b32 v108, 16, v100
    v_and_b32 v109, s40, v100
    v_lshlrev_b32 v110, 16, v101
    v_and_b32 v111, s40, v101
    v_pk_mul_f32 v[116:117], v[108:109], s[50:51]
    v_pk_mul_f32 v[118:119], v[110:111], s[50:51]
    v_exp_f32 v116, v116
    v_exp_f32 v117, v117
    v_exp_f32 v118, v118
    v_exp_f32 v119, v119
    v_lshlrev_b32 v120, 16, v102
    v_and_b32 v121, s40, v102
    v_lshlrev_b32 v122, 16, v103
    v_and_b32 v123, s40, v103
    v_pk_add_f32 v[116:117], v[116:117], 1.0 op_sel_hi:[1,0]
    v_pk_add_f32 v[118:119], v[118:119], 1.0 op_sel_hi:[1,0]
    v_rcp_f32 v116, v116
    v_rcp_f32 v117, v117
    v_rcp_f32 v118, v118
    v_rcp_f32 v119, v119
    s_nop 0
    v_pk_mul_f32 v[116:117], v[116:117], v[108:109]
    v_pk_mul_f32 v[118:119], v[118:119], v[110:111]
    v_cvt_pk_bf16_f32 v108, v116, v117
    v_cvt_pk_bf16_f32 v109, v118, v119
    v_lshlrev_b32 v116, 16, v108
    v_and_b32 v117, s40, v108
    v_lshlrev_b32 v118, 16, v109
    v_and_b32 v119, s40, v109
    v_pk_mul_f32 v[116:117], v[116:117], v[120:121]
    v_pk_mul_f32 v[118:119], v[118:119], v[122:123]
    v_cvt_pk_bf16_f32 v108, v116, v117
    v_cvt_pk_bf16_f32 v109, v118, v119
    s_mov_b32 s53, 117760
    buffer_store_dwordx2 v[108:109], v114, s[12:15], s53 offen offset:0 sc1
    s_branch Ljoin_34
Lp_31:
    ds_write_b64 v115, v[8:9] offset:0
    ds_write_b64 v115, v[12:13] offset:512
    ds_write_b64 v115, v[24:25] offset:1024
    ds_write_b64 v115, v[28:29] offset:1536
    ds_write_b64 v115, v[40:41] offset:2048
    ds_write_b64 v115, v[44:45] offset:2560
    ds_write_b64 v115, v[56:57] offset:3072
    ds_write_b64 v115, v[60:61] offset:3584
    ds_write_b64 v115, v[72:73] offset:4096
    ds_write_b64 v115, v[76:77] offset:4608
    ds_write_b64 v115, v[88:89] offset:5120
    ds_write_b64 v115, v[92:93] offset:5632
    ds_write_b64 v115, v[104:105] offset:6144
    ds_write_b64 v115, v[108:109] offset:6656
    s_waitcnt lgkmcnt(0)
    s_barrier
    ds_read_b64 v[2:3], v132 offset:0
    ds_read_b64 v[6:7], v132 offset:512
    ds_read_b64 v[18:19], v132 offset:1024
    ds_read_b64 v[22:23], v132 offset:1536
    ds_read_b64 v[34:35], v132 offset:2048
    ds_read_b64 v[38:39], v132 offset:2560
    ds_read_b64 v[50:51], v132 offset:3072
    ds_read_b64 v[54:55], v132 offset:3584
    ds_read_b64 v[66:67], v132 offset:4096
    ds_read_b64 v[70:71], v132 offset:4608
    ds_read_b64 v[82:83], v132 offset:5120
    ds_read_b64 v[86:87], v132 offset:5632
    ds_read_b64 v[98:99], v132 offset:6144
    ds_read_b64 v[102:103], v132 offset:6656
    s_waitcnt lgkmcnt(0)
    v_lshlrev_b32 v8, 16, v0
    v_and_b32 v9, s40, v0
    v_lshlrev_b32 v10, 16, v1
    v_and_b32 v11, s40, v1
    v_pk_mul_f32 v[116:117], v[8:9], s[50:51]
    v_pk_mul_f32 v[118:119], v[10:11], s[50:51]
    v_exp_f32 v116, v116
    v_exp_f32 v117, v117
    v_exp_f32 v118, v118
    v_exp_f32 v119, v119
    v_lshlrev_b32 v120, 16, v2
    v_and_b32 v121, s40, v2
    v_lshlrev_b32 v122, 16, v3
    v_and_b32 v123, s40, v3
    v_pk_add_f32 v[116:117], v[116:117], 1.0 op_sel_hi:[1,0]
    v_pk_add_f32 v[118:119], v[118:119], 1.0 op_sel_hi:[1,0]
    v_rcp_f32 v116, v116
    v_rcp_f32 v117, v117
    v_rcp_f32 v118, v118
    v_rcp_f32 v119, v119
    s_nop 0
    v_pk_mul_f32 v[116:117], v[116:117], v[8:9]
    v_pk_mul_f32 v[118:119], v[118:119], v[10:11]
    v_cvt_pk_bf16_f32 v8, v116, v117
    v_cvt_pk_bf16_f32 v9, v118, v119
    v_lshlrev_b32 v116, 16, v8
    v_and_b32 v117, s40, v8
    v_lshlrev_b32 v118, 16, v9
    v_and_b32 v119, s40, v9
    v_pk_mul_f32 v[116:117], v[116:117], v[120:121]
    v_pk_mul_f32 v[118:119], v[118:119], v[122:123]
    v_cvt_pk_bf16_f32 v8, v116, v117
    v_cvt_pk_bf16_f32 v9, v118, v119
    s_mov_b32 s53, 0
    buffer_store_dwordx2 v[8:9], v114, s[12:15], s53 offen offset:8 sc1
    v_lshlrev_b32 v12, 16, v4
    v_and_b32 v13, s40, v4
    v_lshlrev_b32 v14, 16, v5
    v_and_b32 v15, s40, v5
    v_pk_mul_f32 v[116:117], v[12:13], s[50:51]
    v_pk_mul_f32 v[118:119], v[14:15], s[50:51]
    v_exp_f32 v116, v116
    v_exp_f32 v117, v117
    v_exp_f32 v118, v118
    v_exp_f32 v119, v119
    v_lshlrev_b32 v120, 16, v6
    v_and_b32 v121, s40, v6
    v_lshlrev_b32 v122, 16, v7
    v_and_b32 v123, s40, v7
    v_pk_add_f32 v[116:117], v[116:117], 1.0 op_sel_hi:[1,0]
    v_pk_add_f32 v[118:119], v[118:119], 1.0 op_sel_hi:[1,0]
    v_rcp_f32 v116, v116
    v_rcp_f32 v117, v117
    v_rcp_f32 v118, v118
    v_rcp_f32 v119, v119
    s_nop 0
    v_pk_mul_f32 v[116:117], v[116:117], v[12:13]
    v_pk_mul_f32 v[118:119], v[118:119], v[14:15]
    v_cvt_pk_bf16_f32 v12, v116, v117
    v_cvt_pk_bf16_f32 v13, v118, v119
    v_lshlrev_b32 v116, 16, v12
    v_and_b32 v117, s40, v12
    v_lshlrev_b32 v118, 16, v13
    v_and_b32 v119, s40, v13
    v_pk_mul_f32 v[116:117], v[116:117], v[120:121]
    v_pk_mul_f32 v[118:119], v[118:119], v[122:123]
    v_cvt_pk_bf16_f32 v12, v116, v117
    v_cvt_pk_bf16_f32 v13, v118, v119
    s_mov_b32 s53, 114688
    buffer_store_dwordx2 v[12:13], v114, s[12:15], s53 offen offset:8 sc1
    v_lshlrev_b32 v24, 16, v16
    v_and_b32 v25, s40, v16
    v_lshlrev_b32 v26, 16, v17
    v_and_b32 v27, s40, v17
    v_lshlrev_b32 v40, 16, v32
    v_and_b32 v41, s40, v32
    v_lshlrev_b32 v42, 16, v33
    v_and_b32 v43, s40, v33
    v_pk_mul_f32 v[116:117], v[24:25], s[50:51]
    v_pk_mul_f32 v[118:119], v[26:27], s[50:51]
    v_pk_mul_f32 v[124:125], v[40:41], s[50:51]
    v_pk_mul_f32 v[126:127], v[42:43], s[50:51]
    v_exp_f32 v116, v116
    v_exp_f32 v117, v117
    v_exp_f32 v118, v118
    v_exp_f32 v119, v119
    v_exp_f32 v124, v124
    v_exp_f32 v125, v125
    v_exp_f32 v126, v126
    v_exp_f32 v127, v127
    v_lshlrev_b32 v120, 16, v18
    v_and_b32 v121, s40, v18
    v_lshlrev_b32 v122, 16, v19
    v_and_b32 v123, s40, v19
    v_lshlrev_b32 v128, 16, v34
    v_and_b32 v129, s40, v34
    v_lshlrev_b32 v130, 16, v35
    v_and_b32 v131, s40, v35
    v_pk_add_f32 v[116:117], v[116:117], 1.0 op_sel_hi:[1,0]
    v_pk_add_f32 v[118:119], v[118:119], 1.0 op_sel_hi:[1,0]
    v_pk_add_f32 v[124:125], v[124:125], 1.0 op_sel_hi:[1,0]
    v_pk_add_f32 v[126:127], v[126:127], 1.0 op_sel_hi:[1,0]
    v_rcp_f32 v116, v116
    v_rcp_f32 v117, v117
    v_rcp_f32 v118, v118
    v_rcp_f32 v119, v119
    v_rcp_f32 v124, v124
    v_rcp_f32 v125, v125
    v_rcp_f32 v126, v126
    v_rcp_f32 v127, v127
    s_nop 0
    v_pk_mul_f32 v[116:117], v[116:117], v[24:25]
    v_pk_mul_f32 v[118:119], v[118:119], v[26:27]
    v_pk_mul_f32 v[124:125], v[124:125], v[40:41]
    v_pk_mul_f32 v[126:127], v[126:127], v[42:43]
    v_cvt_pk_bf16_f32 v24, v116, v117
    v_cvt_pk_bf16_f32 v25, v118, v119
    v_cvt_pk_bf16_f32 v40, v124, v125
    v_cvt_pk_bf16_f32 v41, v126, v127
    v_lshlrev_b32 v116, 16, v24
    v_and_b32 v117, s40, v24
    v_lshlrev_b32 v118, 16, v25
    v_and_b32 v119, s40, v25
    v_lshlrev_b32 v124, 16, v40
    v_and_b32 v125, s40, v40
    v_lshlrev_b32 v126, 16, v41
    v_and_b32 v127, s40, v41
    v_pk_mul_f32 v[116:117], v[116:117], v[120:121]
    v_pk_mul_f32 v[118:119], v[118:119], v[122:123]
    v_pk_mul_f32 v[124:125], v[124:125], v[128:129]
    v_pk_mul_f32 v[126:127], v[126:127], v[130:131]
    v_cvt_pk_bf16_f32 v24, v116, v117
    v_cvt_pk_bf16_f32 v25, v118, v119
    v_cvt_pk_bf16_f32 v26, v124, v125
    v_cvt_pk_bf16_f32 v27, v126, v127
    s_mov_b32 s53, 1024
    buffer_store_dwordx4 v[24:27], v114, s[12:15], s53 offen sc1
    v_lshlrev_b32 v28, 16, v20
    v_and_b32 v29, s40, v20
    v_lshlrev_b32 v30, 16, v21
    v_and_b32 v31, s40, v21
    v_lshlrev_b32 v44, 16, v36
    v_and_b32 v45, s40, v36
    v_lshlrev_b32 v46, 16, v37
    v_and_b32 v47, s40, v37
    v_pk_mul_f32 v[116:117], v[28:29], s[50:51]
    v_pk_mul_f32 v[118:119], v[30:31], s[50:51]
    v_pk_mul_f32 v[124:125], v[44:45], s[50:51]
    v_pk_mul_f32 v[126:127], v[46:47], s[50:51]
    v_exp_f32 v116, v116
    v_exp_f32 v117, v117
    v_exp_f32 v118, v118
    v_exp_f32 v119, v119
    v_exp_f32 v124, v124
    v_exp_f32 v125, v125
    v_exp_f32 v126, v126
    v_exp_f32 v127, v127
    v_lshlrev_b32 v120, 16, v22
    v_and_b32 v121, s40, v22
    v_lshlrev_b32 v122, 16, v23
    v_and_b32 v123, s40, v23
    v_lshlrev_b32 v128, 16, v38
    v_and_b32 v129, s40, v38
    v_lshlrev_b32 v130, 16, v39
    v_and_b32 v131, s40, v39
    v_pk_add_f32 v[116:117], v[116:117], 1.0 op_sel_hi:[1,0]
    v_pk_add_f32 v[118:119], v[118:119], 1.0 op_sel_hi:[1,0]
    v_pk_add_f32 v[124:125], v[124:125], 1.0 op_sel_hi:[1,0]
    v_pk_add_f32 v[126:127], v[126:127], 1.0 op_sel_hi:[1,0]
    v_rcp_f32 v116, v116
    v_rcp_f32 v117, v117
    v_rcp_f32 v118, v118
    v_rcp_f32 v119, v119
    v_rcp_f32 v124, v124
    v_rcp_f32 v125, v125
    v_rcp_f32 v126, v126
    v_rcp_f32 v127, v127
    s_nop 0
    v_pk_mul_f32 v[116:117], v[116:117], v[28:29]
    v_pk_mul_f32 v[118:119], v[118:119], v[30:31]
    v_pk_mul_f32 v[124:125], v[124:125], v[44:45]
    v_pk_mul_f32 v[126:127], v[126:127], v[46:47]
    v_cvt_pk_bf16_f32 v28, v116, v117
    v_cvt_pk_bf16_f32 v29, v118, v119
    v_cvt_pk_bf16_f32 v44, v124, v125
    v_cvt_pk_bf16_f32 v45, v126, v127
    v_lshlrev_b32 v116, 16, v28
    v_and_b32 v117, s40, v28
    v_lshlrev_b32 v118, 16, v29
    v_and_b32 v119, s40, v29
    v_lshlrev_b32 v124, 16, v44
    v_and_b32 v125, s40, v44
    v_lshlrev_b32 v126, 16, v45
    v_and_b32 v127, s40, v45
    v_pk_mul_f32 v[116:117], v[116:117], v[120:121]
    v_pk_mul_f32 v[118:119], v[118:119], v[122:123]
    v_pk_mul_f32 v[124:125], v[124:125], v[128:129]
    v_pk_mul_f32 v[126:127], v[126:127], v[130:131]
    v_cvt_pk_bf16_f32 v28, v116, v117
    v_cvt_pk_bf16_f32 v29, v118, v119
    v_cvt_pk_bf16_f32 v30, v124, v125
    v_cvt_pk_bf16_f32 v31, v126, v127
    s_mov_b32 s53, 115712
    buffer_store_dwordx4 v[28:31], v114, s[12:15], s53 offen sc1
    v_lshlrev_b32 v56, 16, v48
    v_and_b32 v57, s40, v48
    v_lshlrev_b32 v58, 16, v49
    v_and_b32 v59, s40, v49
    v_lshlrev_b32 v72, 16, v64
    v_and_b32 v73, s40, v64
    v_lshlrev_b32 v74, 16, v65
    v_and_b32 v75, s40, v65
    v_pk_mul_f32 v[116:117], v[56:57], s[50:51]
    v_pk_mul_f32 v[118:119], v[58:59], s[50:51]
    v_pk_mul_f32 v[124:125], v[72:73], s[50:51]
    v_pk_mul_f32 v[126:127], v[74:75], s[50:51]
    v_exp_f32 v116, v116
    v_exp_f32 v117, v117
    v_exp_f32 v118, v118
    v_exp_f32 v119, v119
    v_exp_f32 v124, v124
    v_exp_f32 v125, v125
    v_exp_f32 v126, v126
    v_exp_f32 v127, v127
    v_lshlrev_b32 v120, 16, v50
    v_and_b32 v121, s40, v50
    v_lshlrev_b32 v122, 16, v51
    v_and_b32 v123, s40, v51
    v_lshlrev_b32 v128, 16, v66
    v_and_b32 v129, s40, v66
    v_lshlrev_b32 v130, 16, v67
    v_and_b32 v131, s40, v67
    v_pk_add_f32 v[116:117], v[116:117], 1.0 op_sel_hi:[1,0]
    v_pk_add_f32 v[118:119], v[118:119], 1.0 op_sel_hi:[1,0]
    v_pk_add_f32 v[124:125], v[124:125], 1.0 op_sel_hi:[1,0]
    v_pk_add_f32 v[126:127], v[126:127], 1.0 op_sel_hi:[1,0]
    v_rcp_f32 v116, v116
    v_rcp_f32 v117, v117
    v_rcp_f32 v118, v118
    v_rcp_f32 v119, v119
    v_rcp_f32 v124, v124
    v_rcp_f32 v125, v125
    v_rcp_f32 v126, v126
    v_rcp_f32 v127, v127
    s_nop 0
    v_pk_mul_f32 v[116:117], v[116:117], v[56:57]
    v_pk_mul_f32 v[118:119], v[118:119], v[58:59]
    v_pk_mul_f32 v[124:125], v[124:125], v[72:73]
    v_pk_mul_f32 v[126:127], v[126:127], v[74:75]
    v_cvt_pk_bf16_f32 v56, v116, v117
    v_cvt_pk_bf16_f32 v57, v118, v119
    v_cvt_pk_bf16_f32 v72, v124, v125
    v_cvt_pk_bf16_f32 v73, v126, v127
    v_lshlrev_b32 v116, 16, v56
    v_and_b32 v117, s40, v56
    v_lshlrev_b32 v118, 16, v57
    v_and_b32 v119, s40, v57
    v_lshlrev_b32 v124, 16, v72
    v_and_b32 v125, s40, v72
    v_lshlrev_b32 v126, 16, v73
    v_and_b32 v127, s40, v73
    v_pk_mul_f32 v[116:117], v[116:117], v[120:121]
    v_pk_mul_f32 v[118:119], v[118:119], v[122:123]
    v_pk_mul_f32 v[124:125], v[124:125], v[128:129]
    v_pk_mul_f32 v[126:127], v[126:127], v[130:131]
    v_cvt_pk_bf16_f32 v56, v116, v117
    v_cvt_pk_bf16_f32 v57, v118, v119
    v_cvt_pk_bf16_f32 v58, v124, v125
    v_cvt_pk_bf16_f32 v59, v126, v127
    s_mov_b32 s53, 2048
    buffer_store_dwordx4 v[56:59], v114, s[12:15], s53 offen sc1
    v_lshlrev_b32 v60, 16, v52
    v_and_b32 v61, s40, v52
    v_lshlrev_b32 v62, 16, v53
    v_and_b32 v63, s40, v53
    v_lshlrev_b32 v76, 16, v68
    v_and_b32 v77, s40, v68
    v_lshlrev_b32 v78, 16, v69
    v_and_b32 v79, s40, v69
    v_pk_mul_f32 v[116:117], v[60:61], s[50:51]
    v_pk_mul_f32 v[118:119], v[62:63], s[50:51]
    v_pk_mul_f32 v[124:125], v[76:77], s[50:51]
    v_pk_mul_f32 v[126:127], v[78:79], s[50:51]
    v_exp_f32 v116, v116
    v_exp_f32 v117, v117
    v_exp_f32 v118, v118
    v_exp_f32 v119, v119
    v_exp_f32 v124, v124
    v_exp_f32 v125, v125
    v_exp_f32 v126, v126
    v_exp_f32 v127, v127
    v_lshlrev_b32 v120, 16, v54
    v_and_b32 v121, s40, v54
    v_lshlrev_b32 v122, 16, v55
    v_and_b32 v123, s40, v55
    v_lshlrev_b32 v128, 16, v70
    v_and_b32 v129, s40, v70
    v_lshlrev_b32 v130, 16, v71
    v_and_b32 v131, s40, v71
    v_pk_add_f32 v[116:117], v[116:117], 1.0 op_sel_hi:[1,0]
    v_pk_add_f32 v[118:119], v[118:119], 1.0 op_sel_hi:[1,0]
    v_pk_add_f32 v[124:125], v[124:125], 1.0 op_sel_hi:[1,0]
    v_pk_add_f32 v[126:127], v[126:127], 1.0 op_sel_hi:[1,0]
    v_rcp_f32 v116, v116
    v_rcp_f32 v117, v117
    v_rcp_f32 v118, v118
    v_rcp_f32 v119, v119
    v_rcp_f32 v124, v124
    v_rcp_f32 v125, v125
    v_rcp_f32 v126, v126
    v_rcp_f32 v127, v127
    s_nop 0
    v_pk_mul_f32 v[116:117], v[116:117], v[60:61]
    v_pk_mul_f32 v[118:119], v[118:119], v[62:63]
    v_pk_mul_f32 v[124:125], v[124:125], v[76:77]
    v_pk_mul_f32 v[126:127], v[126:127], v[78:79]
    v_cvt_pk_bf16_f32 v60, v116, v117
    v_cvt_pk_bf16_f32 v61, v118, v119
    v_cvt_pk_bf16_f32 v76, v124, v125
    v_cvt_pk_bf16_f32 v77, v126, v127
    v_lshlrev_b32 v116, 16, v60
    v_and_b32 v117, s40, v60
    v_lshlrev_b32 v118, 16, v61
    v_and_b32 v119, s40, v61
    v_lshlrev_b32 v124, 16, v76
    v_and_b32 v125, s40, v76
    v_lshlrev_b32 v126, 16, v77
    v_and_b32 v127, s40, v77
    v_pk_mul_f32 v[116:117], v[116:117], v[120:121]
    v_pk_mul_f32 v[118:119], v[118:119], v[122:123]
    v_pk_mul_f32 v[124:125], v[124:125], v[128:129]
    v_pk_mul_f32 v[126:127], v[126:127], v[130:131]
    v_cvt_pk_bf16_f32 v60, v116, v117
    v_cvt_pk_bf16_f32 v61, v118, v119
    v_cvt_pk_bf16_f32 v62, v124, v125
    v_cvt_pk_bf16_f32 v63, v126, v127
    s_mov_b32 s53, 116736
    buffer_store_dwordx4 v[60:63], v114, s[12:15], s53 offen sc1
    v_lshlrev_b32 v88, 16, v80
    v_and_b32 v89, s40, v80
    v_lshlrev_b32 v90, 16, v81
    v_and_b32 v91, s40, v81
    v_lshlrev_b32 v104, 16, v96
    v_and_b32 v105, s40, v96
    v_lshlrev_b32 v106, 16, v97
    v_and_b32 v107, s40, v97
    v_pk_mul_f32 v[116:117], v[88:89], s[50:51]
    v_pk_mul_f32 v[118:119], v[90:91], s[50:51]
    v_pk_mul_f32 v[124:125], v[104:105], s[50:51]
    v_pk_mul_f32 v[126:127], v[106:107], s[50:51]
    v_exp_f32 v116, v116
    v_exp_f32 v117, v117
    v_exp_f32 v118, v118
    v_exp_f32 v119, v119
    v_exp_f32 v124, v124
    v_exp_f32 v125, v125
    v_exp_f32 v126, v126
    v_exp_f32 v127, v127
    v_lshlrev_b32 v120, 16, v82
    v_and_b32 v121, s40, v82
    v_lshlrev_b32 v122, 16, v83
    v_and_b32 v123, s40, v83
    v_lshlrev_b32 v128, 16, v98
    v_and_b32 v129, s40, v98
    v_lshlrev_b32 v130, 16, v99
    v_and_b32 v131, s40, v99
    v_pk_add_f32 v[116:117], v[116:117], 1.0 op_sel_hi:[1,0]
    v_pk_add_f32 v[118:119], v[118:119], 1.0 op_sel_hi:[1,0]
    v_pk_add_f32 v[124:125], v[124:125], 1.0 op_sel_hi:[1,0]
    v_pk_add_f32 v[126:127], v[126:127], 1.0 op_sel_hi:[1,0]
    v_rcp_f32 v116, v116
    v_rcp_f32 v117, v117
    v_rcp_f32 v118, v118
    v_rcp_f32 v119, v119
    v_rcp_f32 v124, v124
    v_rcp_f32 v125, v125
    v_rcp_f32 v126, v126
    v_rcp_f32 v127, v127
    s_nop 0
    v_pk_mul_f32 v[116:117], v[116:117], v[88:89]
    v_pk_mul_f32 v[118:119], v[118:119], v[90:91]
    v_pk_mul_f32 v[124:125], v[124:125], v[104:105]
    v_pk_mul_f32 v[126:127], v[126:127], v[106:107]
    v_cvt_pk_bf16_f32 v88, v116, v117
    v_cvt_pk_bf16_f32 v89, v118, v119
    v_cvt_pk_bf16_f32 v104, v124, v125
    v_cvt_pk_bf16_f32 v105, v126, v127
    v_lshlrev_b32 v116, 16, v88
    v_and_b32 v117, s40, v88
    v_lshlrev_b32 v118, 16, v89
    v_and_b32 v119, s40, v89
    v_lshlrev_b32 v124, 16, v104
    v_and_b32 v125, s40, v104
    v_lshlrev_b32 v126, 16, v105
    v_and_b32 v127, s40, v105
    v_pk_mul_f32 v[116:117], v[116:117], v[120:121]
    v_pk_mul_f32 v[118:119], v[118:119], v[122:123]
    v_pk_mul_f32 v[124:125], v[124:125], v[128:129]
    v_pk_mul_f32 v[126:127], v[126:127], v[130:131]
    v_cvt_pk_bf16_f32 v88, v116, v117
    v_cvt_pk_bf16_f32 v89, v118, v119
    v_cvt_pk_bf16_f32 v90, v124, v125
    v_cvt_pk_bf16_f32 v91, v126, v127
    s_mov_b32 s53, 3072
    buffer_store_dwordx4 v[88:91], v114, s[12:15], s53 offen sc1
    v_lshlrev_b32 v92, 16, v84
    v_and_b32 v93, s40, v84
    v_lshlrev_b32 v94, 16, v85
    v_and_b32 v95, s40, v85
    v_lshlrev_b32 v108, 16, v100
    v_and_b32 v109, s40, v100
    v_lshlrev_b32 v110, 16, v101
    v_and_b32 v111, s40, v101
    v_pk_mul_f32 v[116:117], v[92:93], s[50:51]
    v_pk_mul_f32 v[118:119], v[94:95], s[50:51]
    v_pk_mul_f32 v[124:125], v[108:109], s[50:51]
    v_pk_mul_f32 v[126:127], v[110:111], s[50:51]
    v_exp_f32 v116, v116
    v_exp_f32 v117, v117
    v_exp_f32 v118, v118
    v_exp_f32 v119, v119
    v_exp_f32 v124, v124
    v_exp_f32 v125, v125
    v_exp_f32 v126, v126
    v_exp_f32 v127, v127
    v_lshlrev_b32 v120, 16, v86
    v_and_b32 v121, s40, v86
    v_lshlrev_b32 v122, 16, v87
    v_and_b32 v123, s40, v87
    v_lshlrev_b32 v128, 16, v102
    v_and_b32 v129, s40, v102
    v_lshlrev_b32 v130, 16, v103
    v_and_b32 v131, s40, v103
    v_pk_add_f32 v[116:117], v[116:117], 1.0 op_sel_hi:[1,0]
    v_pk_add_f32 v[118:119], v[118:119], 1.0 op_sel_hi:[1,0]
    v_pk_add_f32 v[124:125], v[124:125], 1.0 op_sel_hi:[1,0]
    v_pk_add_f32 v[126:127], v[126:127], 1.0 op_sel_hi:[1,0]
    v_rcp_f32 v116, v116
    v_rcp_f32 v117, v117
    v_rcp_f32 v118, v118
    v_rcp_f32 v119, v119
    v_rcp_f32 v124, v124
    v_rcp_f32 v125, v125
    v_rcp_f32 v126, v126
    v_rcp_f32 v127, v127
    s_nop 0
    v_pk_mul_f32 v[116:117], v[116:117], v[92:93]
    v_pk_mul_f32 v[118:119], v[118:119], v[94:95]
    v_pk_mul_f32 v[124:125], v[124:125], v[108:109]
    v_pk_mul_f32 v[126:127], v[126:127], v[110:111]
    v_cvt_pk_bf16_f32 v92, v116, v117
    v_cvt_pk_bf16_f32 v93, v118, v119
    v_cvt_pk_bf16_f32 v108, v124, v125
    v_cvt_pk_bf16_f32 v109, v126, v127
    v_lshlrev_b32 v116, 16, v92
    v_and_b32 v117, s40, v92
    v_lshlrev_b32 v118, 16, v93
    v_and_b32 v119, s40, v93
    v_lshlrev_b32 v124, 16, v108
    v_and_b32 v125, s40, v108
    v_lshlrev_b32 v126, 16, v109
    v_and_b32 v127, s40, v109
    v_pk_mul_f32 v[116:117], v[116:117], v[120:121]
    v_pk_mul_f32 v[118:119], v[118:119], v[122:123]
    v_pk_mul_f32 v[124:125], v[124:125], v[128:129]
    v_pk_mul_f32 v[126:127], v[126:127], v[130:131]
    v_cvt_pk_bf16_f32 v92, v116, v117
    v_cvt_pk_bf16_f32 v93, v118, v119
    v_cvt_pk_bf16_f32 v94, v124, v125
    v_cvt_pk_bf16_f32 v95, v126, v127
    s_mov_b32 s53, 117760
    buffer_store_dwordx4 v[92:95], v114, s[12:15], s53 offen sc1
    s_branch Ljoin_34
Lp_32:
    ds_write_b64 v115, v[0:1] offset:0
    ds_write_b64 v115, v[4:5] offset:512
    ds_write_b64 v115, v[16:17] offset:1024
    ds_write_b64 v115, v[20:21] offset:1536
    ds_write_b64 v115, v[32:33] offset:2048
    ds_write_b64 v115, v[36:37] offset:2560
    ds_write_b64 v115, v[48:49] offset:3072
    ds_write_b64 v115, v[52:53] offset:3584
    ds_write_b64 v115, v[64:65] offset:4096
    ds_write_b64 v115, v[68:69] offset:4608
    ds_write_b64 v115, v[80:81] offset:5120
    ds_write_b64 v115, v[84:85] offset:5632
    ds_write_b64 v115, v[96:97] offset:6144
    ds_write_b64 v115, v[100:101] offset:6656
    s_waitcnt lgkmcnt(0)
    s_barrier
    ds_read_b64 v[10:11], v132 offset:0
    ds_read_b64 v[14:15], v132 offset:512
    ds_read_b64 v[26:27], v132 offset:1024
    ds_read_b64 v[30:31], v132 offset:1536
    ds_read_b64 v[42:43], v132 offset:2048
    ds_read_b64 v[46:47], v132 offset:2560
    ds_read_b64 v[58:59], v132 offset:3072
    ds_read_b64 v[62:63], v132 offset:3584
    ds_read_b64 v[74:75], v132 offset:4096
    ds_read_b64 v[78:79], v132 offset:4608
    ds_read_b64 v[90:91], v132 offset:5120
    ds_read_b64 v[94:95], v132 offset:5632
    ds_read_b64 v[106:107], v132 offset:6144
    ds_read_b64 v[110:111], v132 offset:6656
    s_waitcnt lgkmcnt(0)
    v_lshlrev_b32 v0, 16, v10
    v_and_b32 v1, s40, v10
    v_lshlrev_b32 v2, 16, v11
    v_and_b32 v3, s40, v11
    v_lshlrev_b32 v16, 16, v26
    v_and_b32 v17, s40, v26
    v_lshlrev_b32 v18, 16, v27
    v_and_b32 v19, s40, v27
    v_pk_mul_f32 v[116:117], v[0:1], s[50:51]
    v_pk_mul_f32 v[118:119], v[2:3], s[50:51]
    v_pk_mul_f32 v[124:125], v[16:17], s[50:51]
    v_pk_mul_f32 v[126:127], v[18:19], s[50:51]
    v_exp_f32 v116, v116
    v_exp_f32 v117, v117
    v_exp_f32 v118, v118
    v_exp_f32 v119, v119
    v_exp_f32 v124, v124
    v_exp_f32 v125, v125
    v_exp_f32 v126, v126
    v_exp_f32 v127, v127
    v_lshlrev_b32 v120, 16, v8
    v_and_b32 v121, s40, v8
    v_lshlrev_b32 v122, 16, v9
    v_and_b32 v123, s40, v9
    v_lshlrev_b32 v128, 16, v24
    v_and_b32 v129, s40, v24
    v_lshlrev_b32 v130, 16, v25
    v_and_b32 v131, s40, v25
    v_pk_add_f32 v[116:117], v[116:117], 1.0 op_sel_hi:[1,0]
    v_pk_add_f32 v[118:119], v[118:119], 1.0 op_sel_hi:[1,0]
    v_pk_add_f32 v[124:125], v[124:125], 1.0 op_sel_hi:[1,0]
    v_pk_add_f32 v[126:127], v[126:127], 1.0 op_sel_hi:[1,0]
    v_rcp_f32 v116, v116
    v_rcp_f32 v117, v117
    v_rcp_f32 v118, v118
    v_rcp_f32 v119, v119
    v_rcp_f32 v124, v124
    v_rcp_f32 v125, v125
    v_rcp_f32 v126, v126
    v_rcp_f32 v127, v127
    s_nop 0
    v_pk_mul_f32 v[116:117], v[116:117], v[0:1]
    v_pk_mul_f32 v[118:119], v[118:119], v[2:3]
    v_pk_mul_f32 v[124:125], v[124:125], v[16:17]
    v_pk_mul_f32 v[126:127], v[126:127], v[18:19]
    v_cvt_pk_bf16_f32 v0, v116, v117
    v_cvt_pk_bf16_f32 v1, v118, v119
    v_cvt_pk_bf16_f32 v16, v124, v125
    v_cvt_pk_bf16_f32 v17, v126, v127
    v_lshlrev_b32 v116, 16, v0
    v_and_b32 v117, s40, v0
    v_lshlrev_b32 v118, 16, v1
    v_and_b32 v119, s40, v1
    v_lshlrev_b32 v124, 16, v16
    v_and_b32 v125, s40, v16
    v_lshlrev_b32 v126, 16, v17
    v_and_b32 v127, s40, v17
    v_pk_mul_f32 v[116:117], v[116:117], v[120:121]
    v_pk_mul_f32 v[118:119], v[118:119], v[122:123]
    v_pk_mul_f32 v[124:125], v[124:125], v[128:129]
    v_pk_mul_f32 v[126:127], v[126:127], v[130:131]
    v_cvt_pk_bf16_f32 v0, v116, v117
    v_cvt_pk_bf16_f32 v1, v118, v119
    v_cvt_pk_bf16_f32 v2, v124, v125
    v_cvt_pk_bf16_f32 v3, v126, v127
    s_mov_b32 s53, 229376
    buffer_store_dwordx4 v[0:3], v114, s[12:15], s53 offen sc1
    v_lshlrev_b32 v4, 16, v14
    v_and_b32 v5, s40, v14
    v_lshlrev_b32 v6, 16, v15
    v_and_b32 v7, s40, v15
    v_lshlrev_b32 v20, 16, v30
    v_and_b32 v21, s40, v30
    v_lshlrev_b32 v22, 16, v31
    v_and_b32 v23, s40, v31
    v_pk_mul_f32 v[116:117], v[4:5], s[50:51]
    v_pk_mul_f32 v[118:119], v[6:7], s[50:51]
    v_pk_mul_f32 v[124:125], v[20:21], s[50:51]
    v_pk_mul_f32 v[126:127], v[22:23], s[50:51]
    v_exp_f32 v116, v116
    v_exp_f32 v117, v117
    v_exp_f32 v118, v118
    v_exp_f32 v119, v119
    v_exp_f32 v124, v124
    v_exp_f32 v125, v125
    v_exp_f32 v126, v126
    v_exp_f32 v127, v127
    v_lshlrev_b32 v120, 16, v12
    v_and_b32 v121, s40, v12
    v_lshlrev_b32 v122, 16, v13
    v_and_b32 v123, s40, v13
    v_lshlrev_b32 v128, 16, v28
    v_and_b32 v129, s40, v28
    v_lshlrev_b32 v130, 16, v29
    v_and_b32 v131, s40, v29
    v_pk_add_f32 v[116:117], v[116:117], 1.0 op_sel_hi:[1,0]
    v_pk_add_f32 v[118:119], v[118:119], 1.0 op_sel_hi:[1,0]
    v_pk_add_f32 v[124:125], v[124:125], 1.0 op_sel_hi:[1,0]
    v_pk_add_f32 v[126:127], v[126:127], 1.0 op_sel_hi:[1,0]
    v_rcp_f32 v116, v116
    v_rcp_f32 v117, v117
    v_rcp_f32 v118, v118
    v_rcp_f32 v119, v119
    v_rcp_f32 v124, v124
    v_rcp_f32 v125, v125
    v_rcp_f32 v126, v126
    v_rcp_f32 v127, v127
    s_nop 0
    v_pk_mul_f32 v[116:117], v[116:117], v[4:5]
    v_pk_mul_f32 v[118:119], v[118:119], v[6:7]
    v_pk_mul_f32 v[124:125], v[124:125], v[20:21]
    v_pk_mul_f32 v[126:127], v[126:127], v[22:23]
    v_cvt_pk_bf16_f32 v4, v116, v117
    v_cvt_pk_bf16_f32 v5, v118, v119
    v_cvt_pk_bf16_f32 v20, v124, v125
    v_cvt_pk_bf16_f32 v21, v126, v127
    v_lshlrev_b32 v116, 16, v4
    v_and_b32 v117, s40, v4
    v_lshlrev_b32 v118, 16, v5
    v_and_b32 v119, s40, v5
    v_lshlrev_b32 v124, 16, v20
    v_and_b32 v125, s40, v20
    v_lshlrev_b32 v126, 16, v21
    v_and_b32 v127, s40, v21
    v_pk_mul_f32 v[116:117], v[116:117], v[120:121]
    v_pk_mul_f32 v[118:119], v[118:119], v[122:123]
    v_pk_mul_f32 v[124:125], v[124:125], v[128:129]
    v_pk_mul_f32 v[126:127], v[126:127], v[130:131]
    v_cvt_pk_bf16_f32 v4, v116, v117
    v_cvt_pk_bf16_f32 v5, v118, v119
    v_cvt_pk_bf16_f32 v6, v124, v125
    v_cvt_pk_bf16_f32 v7, v126, v127
    s_mov_b32 s53, 344064
    buffer_store_dwordx4 v[4:7], v114, s[12:15], s53 offen sc1
    v_lshlrev_b32 v32, 16, v42
    v_and_b32 v33, s40, v42
    v_lshlrev_b32 v34, 16, v43
    v_and_b32 v35, s40, v43
    v_lshlrev_b32 v48, 16, v58
    v_and_b32 v49, s40, v58
    v_lshlrev_b32 v50, 16, v59
    v_and_b32 v51, s40, v59
    v_pk_mul_f32 v[116:117], v[32:33], s[50:51]
    v_pk_mul_f32 v[118:119], v[34:35], s[50:51]
    v_pk_mul_f32 v[124:125], v[48:49], s[50:51]
    v_pk_mul_f32 v[126:127], v[50:51], s[50:51]
    v_exp_f32 v116, v116
    v_exp_f32 v117, v117
    v_exp_f32 v118, v118
    v_exp_f32 v119, v119
    v_exp_f32 v124, v124
    v_exp_f32 v125, v125
    v_exp_f32 v126, v126
    v_exp_f32 v127, v127
    v_lshlrev_b32 v120, 16, v40
    v_and_b32 v121, s40, v40
    v_lshlrev_b32 v122, 16, v41
    v_and_b32 v123, s40, v41
    v_lshlrev_b32 v128, 16, v56
    v_and_b32 v129, s40, v56
    v_lshlrev_b32 v130, 16, v57
    v_and_b32 v131, s40, v57
    v_pk_add_f32 v[116:117], v[116:117], 1.0 op_sel_hi:[1,0]
    v_pk_add_f32 v[118:119], v[118:119], 1.0 op_sel_hi:[1,0]
    v_pk_add_f32 v[124:125], v[124:125], 1.0 op_sel_hi:[1,0]
    v_pk_add_f32 v[126:127], v[126:127], 1.0 op_sel_hi:[1,0]
    v_rcp_f32 v116, v116
    v_rcp_f32 v117, v117
    v_rcp_f32 v118, v118
    v_rcp_f32 v119, v119
    v_rcp_f32 v124, v124
    v_rcp_f32 v125, v125
    v_rcp_f32 v126, v126
    v_rcp_f32 v127, v127
    s_nop 0
    v_pk_mul_f32 v[116:117], v[116:117], v[32:33]
    v_pk_mul_f32 v[118:119], v[118:119], v[34:35]
    v_pk_mul_f32 v[124:125], v[124:125], v[48:49]
    v_pk_mul_f32 v[126:127], v[126:127], v[50:51]
    v_cvt_pk_bf16_f32 v32, v116, v117
    v_cvt_pk_bf16_f32 v33, v118, v119
    v_cvt_pk_bf16_f32 v48, v124, v125
    v_cvt_pk_bf16_f32 v49, v126, v127
    v_lshlrev_b32 v116, 16, v32
    v_and_b32 v117, s40, v32
    v_lshlrev_b32 v118, 16, v33
    v_and_b32 v119, s40, v33
    v_lshlrev_b32 v124, 16, v48
    v_and_b32 v125, s40, v48
    v_lshlrev_b32 v126, 16, v49
    v_and_b32 v127, s40, v49
    v_pk_mul_f32 v[116:117], v[116:117], v[120:121]
    v_pk_mul_f32 v[118:119], v[118:119], v[122:123]
    v_pk_mul_f32 v[124:125], v[124:125], v[128:129]
    v_pk_mul_f32 v[126:127], v[126:127], v[130:131]
    v_cvt_pk_bf16_f32 v32, v116, v117
    v_cvt_pk_bf16_f32 v33, v118, v119
    v_cvt_pk_bf16_f32 v34, v124, v125
    v_cvt_pk_bf16_f32 v35, v126, v127
    s_mov_b32 s53, 230400
    buffer_store_dwordx4 v[32:35], v114, s[12:15], s53 offen sc1
    v_lshlrev_b32 v36, 16, v46
    v_and_b32 v37, s40, v46
    v_lshlrev_b32 v38, 16, v47
    v_and_b32 v39, s40, v47
    v_lshlrev_b32 v52, 16, v62
    v_and_b32 v53, s40, v62
    v_lshlrev_b32 v54, 16, v63
    v_and_b32 v55, s40, v63
    v_pk_mul_f32 v[116:117], v[36:37], s[50:51]
    v_pk_mul_f32 v[118:119], v[38:39], s[50:51]
    v_pk_mul_f32 v[124:125], v[52:53], s[50:51]
    v_pk_mul_f32 v[126:127], v[54:55], s[50:51]
    v_exp_f32 v116, v116
    v_exp_f32 v117, v117
    v_exp_f32 v118, v118
    v_exp_f32 v119, v119
    v_exp_f32 v124, v124
    v_exp_f32 v125, v125
    v_exp_f32 v126, v126
    v_exp_f32 v127, v127
    v_lshlrev_b32 v120, 16, v44
    v_and_b32 v121, s40, v44
    v_lshlrev_b32 v122, 16, v45
    v_and_b32 v123, s40, v45
    v_lshlrev_b32 v128, 16, v60
    v_and_b32 v129, s40, v60
    v_lshlrev_b32 v130, 16, v61
    v_and_b32 v131, s40, v61
    v_pk_add_f32 v[116:117], v[116:117], 1.0 op_sel_hi:[1,0]
    v_pk_add_f32 v[118:119], v[118:119], 1.0 op_sel_hi:[1,0]
    v_pk_add_f32 v[124:125], v[124:125], 1.0 op_sel_hi:[1,0]
    v_pk_add_f32 v[126:127], v[126:127], 1.0 op_sel_hi:[1,0]
    v_rcp_f32 v116, v116
    v_rcp_f32 v117, v117
    v_rcp_f32 v118, v118
    v_rcp_f32 v119, v119
    v_rcp_f32 v124, v124
    v_rcp_f32 v125, v125
    v_rcp_f32 v126, v126
    v_rcp_f32 v127, v127
    s_nop 0
    v_pk_mul_f32 v[116:117], v[116:117], v[36:37]
    v_pk_mul_f32 v[118:119], v[118:119], v[38:39]
    v_pk_mul_f32 v[124:125], v[124:125], v[52:53]
    v_pk_mul_f32 v[126:127], v[126:127], v[54:55]
    v_cvt_pk_bf16_f32 v36, v116, v117
    v_cvt_pk_bf16_f32 v37, v118, v119
    v_cvt_pk_bf16_f32 v52, v124, v125
    v_cvt_pk_bf16_f32 v53, v126, v127
    v_lshlrev_b32 v116, 16, v36
    v_and_b32 v117, s40, v36
    v_lshlrev_b32 v118, 16, v37
    v_and_b32 v119, s40, v37
    v_lshlrev_b32 v124, 16, v52
    v_and_b32 v125, s40, v52
    v_lshlrev_b32 v126, 16, v53
    v_and_b32 v127, s40, v53
    v_pk_mul_f32 v[116:117], v[116:117], v[120:121]
    v_pk_mul_f32 v[118:119], v[118:119], v[122:123]
    v_pk_mul_f32 v[124:125], v[124:125], v[128:129]
    v_pk_mul_f32 v[126:127], v[126:127], v[130:131]
    v_cvt_pk_bf16_f32 v36, v116, v117
    v_cvt_pk_bf16_f32 v37, v118, v119
    v_cvt_pk_bf16_f32 v38, v124, v125
    v_cvt_pk_bf16_f32 v39, v126, v127
    s_mov_b32 s53, 345088
    buffer_store_dwordx4 v[36:39], v114, s[12:15], s53 offen sc1
    v_lshlrev_b32 v64, 16, v74
    v_and_b32 v65, s40, v74
    v_lshlrev_b32 v66, 16, v75
    v_and_b32 v67, s40, v75
    v_lshlrev_b32 v80, 16, v90
    v_and_b32 v81, s40, v90
    v_lshlrev_b32 v82, 16, v91
    v_and_b32 v83, s40, v91
    v_pk_mul_f32 v[116:117], v[64:65], s[50:51]
    v_pk_mul_f32 v[118:119], v[66:67], s[50:51]
    v_pk_mul_f32 v[124:125], v[80:81], s[50:51]
    v_pk_mul_f32 v[126:127], v[82:83], s[50:51]
    v_exp_f32 v116, v116
    v_exp_f32 v117, v117
    v_exp_f32 v118, v118
    v_exp_f32 v119, v119
    v_exp_f32 v124, v124
    v_exp_f32 v125, v125
    v_exp_f32 v126, v126
    v_exp_f32 v127, v127
    v_lshlrev_b32 v120, 16, v72
    v_and_b32 v121, s40, v72
    v_lshlrev_b32 v122, 16, v73
    v_and_b32 v123, s40, v73
    v_lshlrev_b32 v128, 16, v88
    v_and_b32 v129, s40, v88
    v_lshlrev_b32 v130, 16, v89
    v_and_b32 v131, s40, v89
    v_pk_add_f32 v[116:117], v[116:117], 1.0 op_sel_hi:[1,0]
    v_pk_add_f32 v[118:119], v[118:119], 1.0 op_sel_hi:[1,0]
    v_pk_add_f32 v[124:125], v[124:125], 1.0 op_sel_hi:[1,0]
    v_pk_add_f32 v[126:127], v[126:127], 1.0 op_sel_hi:[1,0]
    v_rcp_f32 v116, v116
    v_rcp_f32 v117, v117
    v_rcp_f32 v118, v118
    v_rcp_f32 v119, v119
    v_rcp_f32 v124, v124
    v_rcp_f32 v125, v125
    v_rcp_f32 v126, v126
    v_rcp_f32 v127, v127
    s_nop 0
    v_pk_mul_f32 v[116:117], v[116:117], v[64:65]
    v_pk_mul_f32 v[118:119], v[118:119], v[66:67]
    v_pk_mul_f32 v[124:125], v[124:125], v[80:81]
    v_pk_mul_f32 v[126:127], v[126:127], v[82:83]
    v_cvt_pk_bf16_f32 v64, v116, v117
    v_cvt_pk_bf16_f32 v65, v118, v119
    v_cvt_pk_bf16_f32 v80, v124, v125
    v_cvt_pk_bf16_f32 v81, v126, v127
    v_lshlrev_b32 v116, 16, v64
    v_and_b32 v117, s40, v64
    v_lshlrev_b32 v118, 16, v65
    v_and_b32 v119, s40, v65
    v_lshlrev_b32 v124, 16, v80
    v_and_b32 v125, s40, v80
    v_lshlrev_b32 v126, 16, v81
    v_and_b32 v127, s40, v81
    v_pk_mul_f32 v[116:117], v[116:117], v[120:121]
    v_pk_mul_f32 v[118:119], v[118:119], v[122:123]
    v_pk_mul_f32 v[124:125], v[124:125], v[128:129]
    v_pk_mul_f32 v[126:127], v[126:127], v[130:131]
    v_cvt_pk_bf16_f32 v64, v116, v117
    v_cvt_pk_bf16_f32 v65, v118, v119
    v_cvt_pk_bf16_f32 v66, v124, v125
    v_cvt_pk_bf16_f32 v67, v126, v127
    s_mov_b32 s53, 231424
    buffer_store_dwordx4 v[64:67], v114, s[12:15], s53 offen sc1
    v_lshlrev_b32 v68, 16, v78
    v_and_b32 v69, s40, v78
    v_lshlrev_b32 v70, 16, v79
    v_and_b32 v71, s40, v79
    v_lshlrev_b32 v84, 16, v94
    v_and_b32 v85, s40, v94
    v_lshlrev_b32 v86, 16, v95
    v_and_b32 v87, s40, v95
    v_pk_mul_f32 v[116:117], v[68:69], s[50:51]
    v_pk_mul_f32 v[118:119], v[70:71], s[50:51]
    v_pk_mul_f32 v[124:125], v[84:85], s[50:51]
    v_pk_mul_f32 v[126:127], v[86:87], s[50:51]
    v_exp_f32 v116, v116
    v_exp_f32 v117, v117
    v_exp_f32 v118, v118
    v_exp_f32 v119, v119
    v_exp_f32 v124, v124
    v_exp_f32 v125, v125
    v_exp_f32 v126, v126
    v_exp_f32 v127, v127
    v_lshlrev_b32 v120, 16, v76
    v_and_b32 v121, s40, v76
    v_lshlrev_b32 v122, 16, v77
    v_and_b32 v123, s40, v77
    v_lshlrev_b32 v128, 16, v92
    v_and_b32 v129, s40, v92
    v_lshlrev_b32 v130, 16, v93
    v_and_b32 v131, s40, v93
    v_pk_add_f32 v[116:117], v[116:117], 1.0 op_sel_hi:[1,0]
    v_pk_add_f32 v[118:119], v[118:119], 1.0 op_sel_hi:[1,0]
    v_pk_add_f32 v[124:125], v[124:125], 1.0 op_sel_hi:[1,0]
    v_pk_add_f32 v[126:127], v[126:127], 1.0 op_sel_hi:[1,0]
    v_rcp_f32 v116, v116
    v_rcp_f32 v117, v117
    v_rcp_f32 v118, v118
    v_rcp_f32 v119, v119
    v_rcp_f32 v124, v124
    v_rcp_f32 v125, v125
    v_rcp_f32 v126, v126
    v_rcp_f32 v127, v127
    s_nop 0
    v_pk_mul_f32 v[116:117], v[116:117], v[68:69]
    v_pk_mul_f32 v[118:119], v[118:119], v[70:71]
    v_pk_mul_f32 v[124:125], v[124:125], v[84:85]
    v_pk_mul_f32 v[126:127], v[126:127], v[86:87]
    v_cvt_pk_bf16_f32 v68, v116, v117
    v_cvt_pk_bf16_f32 v69, v118, v119
    v_cvt_pk_bf16_f32 v84, v124, v125
    v_cvt_pk_bf16_f32 v85, v126, v127
    v_lshlrev_b32 v116, 16, v68
    v_and_b32 v117, s40, v68
    v_lshlrev_b32 v118, 16, v69
    v_and_b32 v119, s40, v69
    v_lshlrev_b32 v124, 16, v84
    v_and_b32 v125, s40, v84
    v_lshlrev_b32 v126, 16, v85
    v_and_b32 v127, s40, v85
    v_pk_mul_f32 v[116:117], v[116:117], v[120:121]
    v_pk_mul_f32 v[118:119], v[118:119], v[122:123]
    v_pk_mul_f32 v[124:125], v[124:125], v[128:129]
    v_pk_mul_f32 v[126:127], v[126:127], v[130:131]
    v_cvt_pk_bf16_f32 v68, v116, v117
    v_cvt_pk_bf16_f32 v69, v118, v119
    v_cvt_pk_bf16_f32 v70, v124, v125
    v_cvt_pk_bf16_f32 v71, v126, v127
    s_mov_b32 s53, 346112
    buffer_store_dwordx4 v[68:71], v114, s[12:15], s53 offen sc1
    v_lshlrev_b32 v96, 16, v106
    v_and_b32 v97, s40, v106
    v_lshlrev_b32 v98, 16, v107
    v_and_b32 v99, s40, v107
    v_pk_mul_f32 v[116:117], v[96:97], s[50:51]
    v_pk_mul_f32 v[118:119], v[98:99], s[50:51]
    v_exp_f32 v116, v116
    v_exp_f32 v117, v117
    v_exp_f32 v118, v118
    v_exp_f32 v119, v119
    v_lshlrev_b32 v120, 16, v104
    v_and_b32 v121, s40, v104
    v_lshlrev_b32 v122, 16, v105
    v_and_b32 v123, s40, v105
    v_pk_add_f32 v[116:117], v[116:117], 1.0 op_sel_hi:[1,0]
    v_pk_add_f32 v[118:119], v[118:119], 1.0 op_sel_hi:[1,0]
    v_rcp_f32 v116, v116
    v_rcp_f32 v117, v117
    v_rcp_f32 v118, v118
    v_rcp_f32 v119, v119
    s_nop 0
    v_pk_mul_f32 v[116:117], v[116:117], v[96:97]
    v_pk_mul_f32 v[118:119], v[118:119], v[98:99]
    v_cvt_pk_bf16_f32 v96, v116, v117
    v_cvt_pk_bf16_f32 v97, v118, v119
    v_lshlrev_b32 v116, 16, v96
    v_and_b32 v117, s40, v96
    v_lshlrev_b32 v118, 16, v97
    v_and_b32 v119, s40, v97
    v_pk_mul_f32 v[116:117], v[116:117], v[120:121]
    v_pk_mul_f32 v[118:119], v[118:119], v[122:123]
    v_cvt_pk_bf16_f32 v96, v116, v117
    v_cvt_pk_bf16_f32 v97, v118, v119
    s_mov_b32 s53, 232448
    buffer_store_dwordx2 v[96:97], v114, s[12:15], s53 offen offset:0 sc1
    v_lshlrev_b32 v100, 16, v110
    v_and_b32 v101, s40, v110
    v_lshlrev_b32 v102, 16, v111
    v_and_b32 v103, s40, v111
    v_pk_mul_f32 v[116:117], v[100:101], s[50:51]
    v_pk_mul_f32 v[118:119], v[102:103], s[50:51]
    v_exp_f32 v116, v116
    v_exp_f32 v117, v117
    v_exp_f32 v118, v118
    v_exp_f32 v119, v119
    v_lshlrev_b32 v120, 16, v108
    v_and_b32 v121, s40, v108
    v_lshlrev_b32 v122, 16, v109
    v_and_b32 v123, s40, v109
    v_pk_add_f32 v[116:117], v[116:117], 1.0 op_sel_hi:[1,0]
    v_pk_add_f32 v[118:119], v[118:119], 1.0 op_sel_hi:[1,0]
    v_rcp_f32 v116, v116
    v_rcp_f32 v117, v117
    v_rcp_f32 v118, v118
    v_rcp_f32 v119, v119
    s_nop 0
    v_pk_mul_f32 v[116:117], v[116:117], v[100:101]
    v_pk_mul_f32 v[118:119], v[118:119], v[102:103]
    v_cvt_pk_bf16_f32 v100, v116, v117
    v_cvt_pk_bf16_f32 v101, v118, v119
    v_lshlrev_b32 v116, 16, v100
    v_and_b32 v117, s40, v100
    v_lshlrev_b32 v118, 16, v101
    v_and_b32 v119, s40, v101
    v_pk_mul_f32 v[116:117], v[116:117], v[120:121]
    v_pk_mul_f32 v[118:119], v[118:119], v[122:123]
    v_cvt_pk_bf16_f32 v100, v116, v117
    v_cvt_pk_bf16_f32 v101, v118, v119
    s_mov_b32 s53, 347136
    buffer_store_dwordx2 v[100:101], v114, s[12:15], s53 offen offset:0 sc1
    s_branch Ljoin_34
Lp_33:
    ds_write_b64 v115, v[0:1] offset:0
    ds_write_b64 v115, v[4:5] offset:512
    ds_write_b64 v115, v[16:17] offset:1024
    ds_write_b64 v115, v[20:21] offset:1536
    ds_write_b64 v115, v[32:33] offset:2048
    ds_write_b64 v115, v[36:37] offset:2560
    ds_write_b64 v115, v[48:49] offset:3072
    ds_write_b64 v115, v[52:53] offset:3584
    ds_write_b64 v115, v[64:65] offset:4096
    ds_write_b64 v115, v[68:69] offset:4608
    ds_write_b64 v115, v[80:81] offset:5120
    ds_write_b64 v115, v[84:85] offset:5632
    ds_write_b64 v115, v[96:97] offset:6144
    ds_write_b64 v115, v[100:101] offset:6656
    s_waitcnt lgkmcnt(0)
    s_barrier
    ds_read_b64 v[10:11], v132 offset:0
    ds_read_b64 v[14:15], v132 offset:512
    ds_read_b64 v[26:27], v132 offset:1024
    ds_read_b64 v[30:31], v132 offset:1536
    ds_read_b64 v[42:43], v132 offset:2048
    ds_read_b64 v[46:47], v132 offset:2560
    ds_read_b64 v[58:59], v132 offset:3072
    ds_read_b64 v[62:63], v132 offset:3584
    ds_read_b64 v[74:75], v132 offset:4096
    ds_read_b64 v[78:79], v132 offset:4608
    ds_read_b64 v[90:91], v132 offset:5120
    ds_read_b64 v[94:95], v132 offset:5632
    ds_read_b64 v[106:107], v132 offset:6144
    ds_read_b64 v[110:111], v132 offset:6656
    s_waitcnt lgkmcnt(0)
    v_lshlrev_b32 v0, 16, v10
    v_and_b32 v1, s40, v10
    v_lshlrev_b32 v2, 16, v11
    v_and_b32 v3, s40, v11
    v_pk_mul_f32 v[116:117], v[0:1], s[50:51]
    v_pk_mul_f32 v[118:119], v[2:3], s[50:51]
    v_exp_f32 v116, v116
    v_exp_f32 v117, v117
    v_exp_f32 v118, v118
    v_exp_f32 v119, v119
    v_lshlrev_b32 v120, 16, v8
    v_and_b32 v121, s40, v8
    v_lshlrev_b32 v122, 16, v9
    v_and_b32 v123, s40, v9
    v_pk_add_f32 v[116:117], v[116:117], 1.0 op_sel_hi:[1,0]
    v_pk_add_f32 v[118:119], v[118:119], 1.0 op_sel_hi:[1,0]
    v_rcp_f32 v116, v116
    v_rcp_f32 v117, v117
    v_rcp_f32 v118, v118
    v_rcp_f32 v119, v119
    s_nop 0
    v_pk_mul_f32 v[116:117], v[116:117], v[0:1]
    v_pk_mul_f32 v[118:119], v[118:119], v[2:3]
    v_cvt_pk_bf16_f32 v0, v116, v117
    v_cvt_pk_bf16_f32 v1, v118, v119
    v_lshlrev_b32 v116, 16, v0
    v_and_b32 v117, s40, v0
    v_lshlrev_b32 v118, 16, v1
    v_and_b32 v119, s40, v1
    v_pk_mul_f32 v[116:117], v[116:117], v[120:121]
    v_pk_mul_f32 v[118:119], v[118:119], v[122:123]
    v_cvt_pk_bf16_f32 v0, v116, v117
    v_cvt_pk_bf16_f32 v1, v118, v119
    s_mov_b32 s53, 229376
    buffer_store_dwordx2 v[0:1], v114, s[12:15], s53 offen offset:8 sc1
    v_lshlrev_b32 v4, 16, v14
    v_and_b32 v5, s40, v14
    v_lshlrev_b32 v6, 16, v15
    v_and_b32 v7, s40, v15
    v_pk_mul_f32 v[116:117], v[4:5], s[50:51]
    v_pk_mul_f32 v[118:119], v[6:7], s[50:51]
    v_exp_f32 v116, v116
    v_exp_f32 v117, v117
    v_exp_f32 v118, v118
    v_exp_f32 v119, v119
    v_lshlrev_b32 v120, 16, v12
    v_and_b32 v121, s40, v12
    v_lshlrev_b32 v122, 16, v13
    v_and_b32 v123, s40, v13
    v_pk_add_f32 v[116:117], v[116:117], 1.0 op_sel_hi:[1,0]
    v_pk_add_f32 v[118:119], v[118:119], 1.0 op_sel_hi:[1,0]
    v_rcp_f32 v116, v116
    v_rcp_f32 v117, v117
    v_rcp_f32 v118, v118
    v_rcp_f32 v119, v119
    s_nop 0
    v_pk_mul_f32 v[116:117], v[116:117], v[4:5]
    v_pk_mul_f32 v[118:119], v[118:119], v[6:7]
    v_cvt_pk_bf16_f32 v4, v116, v117
    v_cvt_pk_bf16_f32 v5, v118, v119
    v_lshlrev_b32 v116, 16, v4
    v_and_b32 v117, s40, v4
    v_lshlrev_b32 v118, 16, v5
    v_and_b32 v119, s40, v5
    v_pk_mul_f32 v[116:117], v[116:117], v[120:121]
    v_pk_mul_f32 v[118:119], v[118:119], v[122:123]
    v_cvt_pk_bf16_f32 v4, v116, v117
    v_cvt_pk_bf16_f32 v5, v118, v119
    s_mov_b32 s53, 344064
    buffer_store_dwordx2 v[4:5], v114, s[12:15], s53 offen offset:8 sc1
    v_lshlrev_b32 v16, 16, v26
    v_and_b32 v17, s40, v26
    v_lshlrev_b32 v18, 16, v27
    v_and_b32 v19, s40, v27
    v_lshlrev_b32 v32, 16, v42
    v_and_b32 v33, s40, v42
    v_lshlrev_b32 v34, 16, v43
    v_and_b32 v35, s40, v43
    v_pk_mul_f32 v[116:117], v[16:17], s[50:51]
    v_pk_mul_f32 v[118:119], v[18:19], s[50:51]
    v_pk_mul_f32 v[124:125], v[32:33], s[50:51]
    v_pk_mul_f32 v[126:127], v[34:35], s[50:51]
    v_exp_f32 v116, v116
    v_exp_f32 v117, v117
    v_exp_f32 v118, v118
    v_exp_f32 v119, v119
    v_exp_f32 v124, v124
    v_exp_f32 v125, v125
    v_exp_f32 v126, v126
    v_exp_f32 v127, v127
    v_lshlrev_b32 v120, 16, v24
    v_and_b32 v121, s40, v24
    v_lshlrev_b32 v122, 16, v25
    v_and_b32 v123, s40, v25
    v_lshlrev_b32 v128, 16, v40
    v_and_b32 v129, s40, v40
    v_lshlrev_b32 v130, 16, v41
    v_and_b32 v131, s40, v41
    v_pk_add_f32 v[116:117], v[116:117], 1.0 op_sel_hi:[1,0]
    v_pk_add_f32 v[118:119], v[118:119], 1.0 op_sel_hi:[1,0]
    v_pk_add_f32 v[124:125], v[124:125], 1.0 op_sel_hi:[1,0]
    v_pk_add_f32 v[126:127], v[126:127], 1.0 op_sel_hi:[1,0]
    v_rcp_f32 v116, v116
    v_rcp_f32 v117, v117
    v_rcp_f32 v118, v118
    v_rcp_f32 v119, v119
    v_rcp_f32 v124, v124
    v_rcp_f32 v125, v125
    v_rcp_f32 v126, v126
    v_rcp_f32 v127, v127
    s_nop 0
    v_pk_mul_f32 v[116:117], v[116:117], v[16:17]
    v_pk_mul_f32 v[118:119], v[118:119], v[18:19]
    v_pk_mul_f32 v[124:125], v[124:125], v[32:33]
    v_pk_mul_f32 v[126:127], v[126:127], v[34:35]
    v_cvt_pk_bf16_f32 v16, v116, v117
    v_cvt_pk_bf16_f32 v17, v118, v119
    v_cvt_pk_bf16_f32 v32, v124, v125
    v_cvt_pk_bf16_f32 v33, v126, v127
    v_lshlrev_b32 v116, 16, v16
    v_and_b32 v117, s40, v16
    v_lshlrev_b32 v118, 16, v17
    v_and_b32 v119, s40, v17
    v_lshlrev_b32 v124, 16, v32
    v_and_b32 v125, s40, v32
    v_lshlrev_b32 v126, 16, v33
    v_and_b32 v127, s40, v33
    v_pk_mul_f32 v[116:117], v[116:117], v[120:121]
    v_pk_mul_f32 v[118:119], v[118:119], v[122:123]
    v_pk_mul_f32 v[124:125], v[124:125], v[128:129]
    v_pk_mul_f32 v[126:127], v[126:127], v[130:131]
    v_cvt_pk_bf16_f32 v16, v116, v117
    v_cvt_pk_bf16_f32 v17, v118, v119
    v_cvt_pk_bf16_f32 v18, v124, v125
    v_cvt_pk_bf16_f32 v19, v126, v127
    s_mov_b32 s53, 230400
    buffer_store_dwordx4 v[16:19], v114, s[12:15], s53 offen sc1
    v_lshlrev_b32 v20, 16, v30
    v_and_b32 v21, s40, v30
    v_lshlrev_b32 v22, 16, v31
    v_and_b32 v23, s40, v31
    v_lshlrev_b32 v36, 16, v46
    v_and_b32 v37, s40, v46
    v_lshlrev_b32 v38, 16, v47
    v_and_b32 v39, s40, v47
    v_pk_mul_f32 v[116:117], v[20:21], s[50:51]
    v_pk_mul_f32 v[118:119], v[22:23], s[50:51]
    v_pk_mul_f32 v[124:125], v[36:37], s[50:51]
    v_pk_mul_f32 v[126:127], v[38:39], s[50:51]
    v_exp_f32 v116, v116
    v_exp_f32 v117, v117
    v_exp_f32 v118, v118
    v_exp_f32 v119, v119
    v_exp_f32 v124, v124
    v_exp_f32 v125, v125
    v_exp_f32 v126, v126
    v_exp_f32 v127, v127
    v_lshlrev_b32 v120, 16, v28
    v_and_b32 v121, s40, v28
    v_lshlrev_b32 v122, 16, v29
    v_and_b32 v123, s40, v29
    v_lshlrev_b32 v128, 16, v44
    v_and_b32 v129, s40, v44
    v_lshlrev_b32 v130, 16, v45
    v_and_b32 v131, s40, v45
    v_pk_add_f32 v[116:117], v[116:117], 1.0 op_sel_hi:[1,0]
    v_pk_add_f32 v[118:119], v[118:119], 1.0 op_sel_hi:[1,0]
    v_pk_add_f32 v[124:125], v[124:125], 1.0 op_sel_hi:[1,0]
    v_pk_add_f32 v[126:127], v[126:127], 1.0 op_sel_hi:[1,0]
    v_rcp_f32 v116, v116
    v_rcp_f32 v117, v117
    v_rcp_f32 v118, v118
    v_rcp_f32 v119, v119
    v_rcp_f32 v124, v124
    v_rcp_f32 v125, v125
    v_rcp_f32 v126, v126
    v_rcp_f32 v127, v127
    s_nop 0
    v_pk_mul_f32 v[116:117], v[116:117], v[20:21]
    v_pk_mul_f32 v[118:119], v[118:119], v[22:23]
    v_pk_mul_f32 v[124:125], v[124:125], v[36:37]
    v_pk_mul_f32 v[126:127], v[126:127], v[38:39]
    v_cvt_pk_bf16_f32 v20, v116, v117
    v_cvt_pk_bf16_f32 v21, v118, v119
    v_cvt_pk_bf16_f32 v36, v124, v125
    v_cvt_pk_bf16_f32 v37, v126, v127
    v_lshlrev_b32 v116, 16, v20
    v_and_b32 v117, s40, v20
    v_lshlrev_b32 v118, 16, v21
    v_and_b32 v119, s40, v21
    v_lshlrev_b32 v124, 16, v36
    v_and_b32 v125, s40, v36
    v_lshlrev_b32 v126, 16, v37
    v_and_b32 v127, s40, v37
    v_pk_mul_f32 v[116:117], v[116:117], v[120:121]
    v_pk_mul_f32 v[118:119], v[118:119], v[122:123]
    v_pk_mul_f32 v[124:125], v[124:125], v[128:129]
    v_pk_mul_f32 v[126:127], v[126:127], v[130:131]
    v_cvt_pk_bf16_f32 v20, v116, v117
    v_cvt_pk_bf16_f32 v21, v118, v119
    v_cvt_pk_bf16_f32 v22, v124, v125
    v_cvt_pk_bf16_f32 v23, v126, v127
    s_mov_b32 s53, 345088
    buffer_store_dwordx4 v[20:23], v114, s[12:15], s53 offen sc1
    v_lshlrev_b32 v48, 16, v58
    v_and_b32 v49, s40, v58
    v_lshlrev_b32 v50, 16, v59
    v_and_b32 v51, s40, v59
    v_lshlrev_b32 v64, 16, v74
    v_and_b32 v65, s40, v74
    v_lshlrev_b32 v66, 16, v75
    v_and_b32 v67, s40, v75
    v_pk_mul_f32 v[116:117], v[48:49], s[50:51]
    v_pk_mul_f32 v[118:119], v[50:51], s[50:51]
    v_pk_mul_f32 v[124:125], v[64:65], s[50:51]
    v_pk_mul_f32 v[126:127], v[66:67], s[50:51]
    v_exp_f32 v116, v116
    v_exp_f32 v117, v117
    v_exp_f32 v118, v118
    v_exp_f32 v119, v119
    v_exp_f32 v124, v124
    v_exp_f32 v125, v125
    v_exp_f32 v126, v126
    v_exp_f32 v127, v127
    v_lshlrev_b32 v120, 16, v56
    v_and_b32 v121, s40, v56
    v_lshlrev_b32 v122, 16, v57
    v_and_b32 v123, s40, v57
    v_lshlrev_b32 v128, 16, v72
    v_and_b32 v129, s40, v72
    v_lshlrev_b32 v130, 16, v73
    v_and_b32 v131, s40, v73
    v_pk_add_f32 v[116:117], v[116:117], 1.0 op_sel_hi:[1,0]
    v_pk_add_f32 v[118:119], v[118:119], 1.0 op_sel_hi:[1,0]
    v_pk_add_f32 v[124:125], v[124:125], 1.0 op_sel_hi:[1,0]
    v_pk_add_f32 v[126:127], v[126:127], 1.0 op_sel_hi:[1,0]
    v_rcp_f32 v116, v116
    v_rcp_f32 v117, v117
    v_rcp_f32 v118, v118
    v_rcp_f32 v119, v119
    v_rcp_f32 v124, v124
    v_rcp_f32 v125, v125
    v_rcp_f32 v126, v126
    v_rcp_f32 v127, v127
    s_nop 0
    v_pk_mul_f32 v[116:117], v[116:117], v[48:49]
    v_pk_mul_f32 v[118:119], v[118:119], v[50:51]
    v_pk_mul_f32 v[124:125], v[124:125], v[64:65]
    v_pk_mul_f32 v[126:127], v[126:127], v[66:67]
    v_cvt_pk_bf16_f32 v48, v116, v117
    v_cvt_pk_bf16_f32 v49, v118, v119
    v_cvt_pk_bf16_f32 v64, v124, v125
    v_cvt_pk_bf16_f32 v65, v126, v127
    v_lshlrev_b32 v116, 16, v48
    v_and_b32 v117, s40, v48
    v_lshlrev_b32 v118, 16, v49
    v_and_b32 v119, s40, v49
    v_lshlrev_b32 v124, 16, v64
    v_and_b32 v125, s40, v64
    v_lshlrev_b32 v126, 16, v65
    v_and_b32 v127, s40, v65
    v_pk_mul_f32 v[116:117], v[116:117], v[120:121]
    v_pk_mul_f32 v[118:119], v[118:119], v[122:123]
    v_pk_mul_f32 v[124:125], v[124:125], v[128:129]
    v_pk_mul_f32 v[126:127], v[126:127], v[130:131]
    v_cvt_pk_bf16_f32 v48, v116, v117
    v_cvt_pk_bf16_f32 v49, v118, v119
    v_cvt_pk_bf16_f32 v50, v124, v125
    v_cvt_pk_bf16_f32 v51, v126, v127
    s_mov_b32 s53, 231424
    buffer_store_dwordx4 v[48:51], v114, s[12:15], s53 offen sc1
    v_lshlrev_b32 v52, 16, v62
    v_and_b32 v53, s40, v62
    v_lshlrev_b32 v54, 16, v63
    v_and_b32 v55, s40, v63
    v_lshlrev_b32 v68, 16, v78
    v_and_b32 v69, s40, v78
    v_lshlrev_b32 v70, 16, v79
    v_and_b32 v71, s40, v79
    v_pk_mul_f32 v[116:117], v[52:53], s[50:51]
    v_pk_mul_f32 v[118:119], v[54:55], s[50:51]
    v_pk_mul_f32 v[124:125], v[68:69], s[50:51]
    v_pk_mul_f32 v[126:127], v[70:71], s[50:51]
    v_exp_f32 v116, v116
    v_exp_f32 v117, v117
    v_exp_f32 v118, v118
    v_exp_f32 v119, v119
    v_exp_f32 v124, v124
    v_exp_f32 v125, v125
    v_exp_f32 v126, v126
    v_exp_f32 v127, v127
    v_lshlrev_b32 v120, 16, v60
    v_and_b32 v121, s40, v60
    v_lshlrev_b32 v122, 16, v61
    v_and_b32 v123, s40, v61
    v_lshlrev_b32 v128, 16, v76
    v_and_b32 v129, s40, v76
    v_lshlrev_b32 v130, 16, v77
    v_and_b32 v131, s40, v77
    v_pk_add_f32 v[116:117], v[116:117], 1.0 op_sel_hi:[1,0]
    v_pk_add_f32 v[118:119], v[118:119], 1.0 op_sel_hi:[1,0]
    v_pk_add_f32 v[124:125], v[124:125], 1.0 op_sel_hi:[1,0]
    v_pk_add_f32 v[126:127], v[126:127], 1.0 op_sel_hi:[1,0]
    v_rcp_f32 v116, v116
    v_rcp_f32 v117, v117
    v_rcp_f32 v118, v118
    v_rcp_f32 v119, v119
    v_rcp_f32 v124, v124
    v_rcp_f32 v125, v125
    v_rcp_f32 v126, v126
    v_rcp_f32 v127, v127
    s_nop 0
    v_pk_mul_f32 v[116:117], v[116:117], v[52:53]
    v_pk_mul_f32 v[118:119], v[118:119], v[54:55]
    v_pk_mul_f32 v[124:125], v[124:125], v[68:69]
    v_pk_mul_f32 v[126:127], v[126:127], v[70:71]
    v_cvt_pk_bf16_f32 v52, v116, v117
    v_cvt_pk_bf16_f32 v53, v118, v119
    v_cvt_pk_bf16_f32 v68, v124, v125
    v_cvt_pk_bf16_f32 v69, v126, v127
    v_lshlrev_b32 v116, 16, v52
    v_and_b32 v117, s40, v52
    v_lshlrev_b32 v118, 16, v53
    v_and_b32 v119, s40, v53
    v_lshlrev_b32 v124, 16, v68
    v_and_b32 v125, s40, v68
    v_lshlrev_b32 v126, 16, v69
    v_and_b32 v127, s40, v69
    v_pk_mul_f32 v[116:117], v[116:117], v[120:121]
    v_pk_mul_f32 v[118:119], v[118:119], v[122:123]
    v_pk_mul_f32 v[124:125], v[124:125], v[128:129]
    v_pk_mul_f32 v[126:127], v[126:127], v[130:131]
    v_cvt_pk_bf16_f32 v52, v116, v117
    v_cvt_pk_bf16_f32 v53, v118, v119
    v_cvt_pk_bf16_f32 v54, v124, v125
    v_cvt_pk_bf16_f32 v55, v126, v127
    s_mov_b32 s53, 346112
    buffer_store_dwordx4 v[52:55], v114, s[12:15], s53 offen sc1
    v_lshlrev_b32 v80, 16, v90
    v_and_b32 v81, s40, v90
    v_lshlrev_b32 v82, 16, v91
    v_and_b32 v83, s40, v91
    v_lshlrev_b32 v96, 16, v106
    v_and_b32 v97, s40, v106
    v_lshlrev_b32 v98, 16, v107
    v_and_b32 v99, s40, v107
    v_pk_mul_f32 v[116:117], v[80:81], s[50:51]
    v_pk_mul_f32 v[118:119], v[82:83], s[50:51]
    v_pk_mul_f32 v[124:125], v[96:97], s[50:51]
    v_pk_mul_f32 v[126:127], v[98:99], s[50:51]
    v_exp_f32 v116, v116
    v_exp_f32 v117, v117
    v_exp_f32 v118, v118
    v_exp_f32 v119, v119
    v_exp_f32 v124, v124
    v_exp_f32 v125, v125
    v_exp_f32 v126, v126
    v_exp_f32 v127, v127
    v_lshlrev_b32 v120, 16, v88
    v_and_b32 v121, s40, v88
    v_lshlrev_b32 v122, 16, v89
    v_and_b32 v123, s40, v89
    v_lshlrev_b32 v128, 16, v104
    v_and_b32 v129, s40, v104
    v_lshlrev_b32 v130, 16, v105
    v_and_b32 v131, s40, v105
    v_pk_add_f32 v[116:117], v[116:117], 1.0 op_sel_hi:[1,0]
    v_pk_add_f32 v[118:119], v[118:119], 1.0 op_sel_hi:[1,0]
    v_pk_add_f32 v[124:125], v[124:125], 1.0 op_sel_hi:[1,0]
    v_pk_add_f32 v[126:127], v[126:127], 1.0 op_sel_hi:[1,0]
    v_rcp_f32 v116, v116
    v_rcp_f32 v117, v117
    v_rcp_f32 v118, v118
    v_rcp_f32 v119, v119
    v_rcp_f32 v124, v124
    v_rcp_f32 v125, v125
    v_rcp_f32 v126, v126
    v_rcp_f32 v127, v127
    s_nop 0
    v_pk_mul_f32 v[116:117], v[116:117], v[80:81]
    v_pk_mul_f32 v[118:119], v[118:119], v[82:83]
    v_pk_mul_f32 v[124:125], v[124:125], v[96:97]
    v_pk_mul_f32 v[126:127], v[126:127], v[98:99]
    v_cvt_pk_bf16_f32 v80, v116, v117
    v_cvt_pk_bf16_f32 v81, v118, v119
    v_cvt_pk_bf16_f32 v96, v124, v125
    v_cvt_pk_bf16_f32 v97, v126, v127
    v_lshlrev_b32 v116, 16, v80
    v_and_b32 v117, s40, v80
    v_lshlrev_b32 v118, 16, v81
    v_and_b32 v119, s40, v81
    v_lshlrev_b32 v124, 16, v96
    v_and_b32 v125, s40, v96
    v_lshlrev_b32 v126, 16, v97
    v_and_b32 v127, s40, v97
    v_pk_mul_f32 v[116:117], v[116:117], v[120:121]
    v_pk_mul_f32 v[118:119], v[118:119], v[122:123]
    v_pk_mul_f32 v[124:125], v[124:125], v[128:129]
    v_pk_mul_f32 v[126:127], v[126:127], v[130:131]
    v_cvt_pk_bf16_f32 v80, v116, v117
    v_cvt_pk_bf16_f32 v81, v118, v119
    v_cvt_pk_bf16_f32 v82, v124, v125
    v_cvt_pk_bf16_f32 v83, v126, v127
    s_mov_b32 s53, 232448
    buffer_store_dwordx4 v[80:83], v114, s[12:15], s53 offen sc1
    v_lshlrev_b32 v84, 16, v94
    v_and_b32 v85, s40, v94
    v_lshlrev_b32 v86, 16, v95
    v_and_b32 v87, s40, v95
    v_lshlrev_b32 v100, 16, v110
    v_and_b32 v101, s40, v110
    v_lshlrev_b32 v102, 16, v111
    v_and_b32 v103, s40, v111
    v_pk_mul_f32 v[116:117], v[84:85], s[50:51]
    v_pk_mul_f32 v[118:119], v[86:87], s[50:51]
    v_pk_mul_f32 v[124:125], v[100:101], s[50:51]
    v_pk_mul_f32 v[126:127], v[102:103], s[50:51]
    v_exp_f32 v116, v116
    v_exp_f32 v117, v117
    v_exp_f32 v118, v118
    v_exp_f32 v119, v119
    v_exp_f32 v124, v124
    v_exp_f32 v125, v125
    v_exp_f32 v126, v126
    v_exp_f32 v127, v127
    v_lshlrev_b32 v120, 16, v92
    v_and_b32 v121, s40, v92
    v_lshlrev_b32 v122, 16, v93
    v_and_b32 v123, s40, v93
    v_lshlrev_b32 v128, 16, v108
    v_and_b32 v129, s40, v108
    v_lshlrev_b32 v130, 16, v109
    v_and_b32 v131, s40, v109
    v_pk_add_f32 v[116:117], v[116:117], 1.0 op_sel_hi:[1,0]
    v_pk_add_f32 v[118:119], v[118:119], 1.0 op_sel_hi:[1,0]
    v_pk_add_f32 v[124:125], v[124:125], 1.0 op_sel_hi:[1,0]
    v_pk_add_f32 v[126:127], v[126:127], 1.0 op_sel_hi:[1,0]
    v_rcp_f32 v116, v116
    v_rcp_f32 v117, v117
    v_rcp_f32 v118, v118
    v_rcp_f32 v119, v119
    v_rcp_f32 v124, v124
    v_rcp_f32 v125, v125
    v_rcp_f32 v126, v126
    v_rcp_f32 v127, v127
    s_nop 0
    v_pk_mul_f32 v[116:117], v[116:117], v[84:85]
    v_pk_mul_f32 v[118:119], v[118:119], v[86:87]
    v_pk_mul_f32 v[124:125], v[124:125], v[100:101]
    v_pk_mul_f32 v[126:127], v[126:127], v[102:103]
    v_cvt_pk_bf16_f32 v84, v116, v117
    v_cvt_pk_bf16_f32 v85, v118, v119
    v_cvt_pk_bf16_f32 v100, v124, v125
    v_cvt_pk_bf16_f32 v101, v126, v127
    v_lshlrev_b32 v116, 16, v84
    v_and_b32 v117, s40, v84
    v_lshlrev_b32 v118, 16, v85
    v_and_b32 v119, s40, v85
    v_lshlrev_b32 v124, 16, v100
    v_and_b32 v125, s40, v100
    v_lshlrev_b32 v126, 16, v101
    v_and_b32 v127, s40, v101
    v_pk_mul_f32 v[116:117], v[116:117], v[120:121]
    v_pk_mul_f32 v[118:119], v[118:119], v[122:123]
    v_pk_mul_f32 v[124:125], v[124:125], v[128:129]
    v_pk_mul_f32 v[126:127], v[126:127], v[130:131]
    v_cvt_pk_bf16_f32 v84, v116, v117
    v_cvt_pk_bf16_f32 v85, v118, v119
    v_cvt_pk_bf16_f32 v86, v124, v125
    v_cvt_pk_bf16_f32 v87, v126, v127
    s_mov_b32 s53, 347136
    buffer_store_dwordx4 v[84:87], v114, s[12:15], s53 offen sc1
Ljoin_34:
    s_waitcnt vmcnt(0)
    s_barrier
    s_cmp_lg_u32 s16, 0
    s_cbranch_scc1 Lpub_35
    s_lshl_b32 s76, s92, 4
    s_add_u32 s76, s76, s3
    s_lshl_b32 s76, s76, 7
    s_add_u32 s77, s93, 4
    v_mov_b32 v0, s76
    v_mov_b32 v1, s77
    s_mov_b64 exec, 1
    buffer_store_dword v1, v0, s[88:91], 0 offen sc1
    s_mov_b64 exec, -1
Lpub_35:
    s_mov_b32 s92, s85
    s_mov_b32 s3, s86
    s_load_dwordx2 s[32:33], s[0:1], 72
    s_load_dwordx2 s[34:35], s[0:1], 72
    s_load_dwordx2 s[36:37], s[0:1], 112
    s_load_dwordx2 s[38:39], s[0:1], 96
    v_mbcnt_lo_u32_b32 v32, -1, 0
    v_mbcnt_hi_u32_b32 v32, -1, v32
    s_mov_b32 s26, s92
    s_mov_b32 s27, s3
    s_and_b32 s24, s16, 7
    s_lshr_b32 s57, s16, 3
    s_lshr_b32 s28, s24, 2
    s_and_b32 s29, s24, 3
    s_mul_i32 s24, s26, 8
    s_mul_i32 s25, s16, 1
    s_add_u32 s24, s24, s25
    s_mul_i32 s24, s24, 114688
    v_lshlrev_b32 v60, 4, v32
    v_add_u32 v64, s24, v60
    s_and_b32 s24, s16, 7
    s_mul_i32 s20, s24, 1
    s_lshl_b32 s20, s20, 10
    s_add_u32 s20, s20, 8192
    s_mul_i32 s21, s16, 1024
    s_waitcnt lgkmcnt(0)
    s_add_u32 s8, s36, 13631488
    s_addc_u32 s9, s37, 0
    s_and_b32 s9, s9, 0xffff
    s_mov_b32 s10, 14680064
    s_mov_b32 s11, 0x00020000
    v_and_b32 v60, 15, v32
    s_lshl_b32 s58, s92, 4
    v_add_u32 v60, s58, v60
    v_lshlrev_b32 v60, 7, v60
    s_mov_b32 s59, 200000
    s_add_u32 s76, s93, 4
Lpoll_36:
    buffer_load_dword v61, v60, s[88:91], 0 offen sc1
    s_waitcnt vmcnt(0)
    v_subrev_u32 v61, s76, v61
    v_cmp_gt_u32 vcc, 4, v61
    s_nop 1
    s_cmp_eq_u64 vcc, -1
    s_cbranch_scc1 Lpd_37
    s_sub_u32 s59, s59, 1
    s_cmp_lg_u32 s59, 0
    s_sleep 1
    s_cbranch_scc1 Lpoll_36
Lpd_37:
    s_lshl_b32 s18, s45, 10
    s_add_u32 m0, s21, 0
    s_nop 0
    buffer_load_dwordx4 v64, s[8:11], s18 offen sc1 lds
    s_add_u32 s18, s18, 1024
    s_add_u32 m0, s21, 16384
    s_nop 0
    buffer_load_dwordx4 v64, s[8:11], s18 offen sc1 lds
    s_add_u32 s18, s18, 1024
    s_add_u32 m0, s21, 32768
    s_nop 0
    buffer_load_dwordx4 v64, s[8:11], s18 offen sc1 lds
    s_add_u32 s18, s18, 1024
    s_add_u32 m0, s21, 49152
    s_nop 0
    buffer_load_dwordx4 v64, s[8:11], s18 offen sc1 lds
    s_add_u32 s18, s18, 1024
    s_add_u32 m0, s21, 65536
    s_nop 0
    buffer_load_dwordx4 v64, s[8:11], s18 offen sc1 lds
    s_add_u32 s18, s18, 1024
    s_add_u32 m0, s21, 81920
    s_nop 0
    buffer_load_dwordx4 v64, s[8:11], s18 offen sc1 lds
    s_add_u32 s18, s18, 1024
    s_add_u32 m0, s21, 98304
    s_nop 0
    buffer_load_dwordx4 v64, s[8:11], s18 offen sc1 lds
    s_add_u32 s18, s18, 1024
    s_add_u32 m0, s21, 114688
    s_nop 0
    buffer_load_dwordx4 v64, s[8:11], s18 offen sc1 lds
    s_add_u32 s18, s18, 1024
    s_mul_i32 s17, s18, 64
    s_mov_b32 s31, 131072
    s_mov_b32 s4, s32
    s_and_b32 s5, s33, 0xffff
    s_mov_b32 s6, 7340032
    s_mov_b32 s7, 0x00020000
    s_mul_i32 s24, s28, 4096
    v_lshl_add_u32 v65, v32, 4, s24
    v_lshrrev_b32 v60, 2, v32
    v_and_b32 v61, 3, v32
    v_mul_u32_u24 v62, 256, v60
    v_lshl_add_u32 v62, v61, 3, v62
    s_mul_i32 s24, s57, 8192
    s_add_u32 s24, s24, 8192
    v_add_u32 v62, s24, v62
    v_lshrrev_b32 v63, 0, v60
    v_and_b32 v63, 7, v63
    s_mul_i32 s24, s29, 2
    s_add_u32 s25, s24, 0
    v_xor_b32 v61, s25, v63
    v_lshl_add_u32 v66, v61, 5, v62
    s_add_u32 s25, s24, 1
    v_xor_b32 v61, s25, v63
    v_lshl_add_u32 v67, v61, 5, v62
    s_add_u32 s60, s36, 5242880
    s_addc_u32 s61, s37, 0
    s_and_b32 s61, s61, 0xffff
    s_mov_b32 s62, 4194304
    s_mov_b32 s63, 0x00020000
    s_add_u32 s64, s36, 0
    s_addc_u32 s65, s37, 0
    s_and_b32 s65, s65, 0xffff
    s_mov_b32 s66, 49152
    s_mov_b32 s67, 0x00020000
    s_mul_i32 s24, s27, 128
    s_mul_i32 s48, s29, 32
    s_add_u32 s24, s24, s48
    s_mul_i32 s25, s26, 128
    s_mul_i32 s48, s28, 64
    s_add_u32 s25, s25, s48
    s_mul_i32 s48, s47, 32
    s_add_u32 s25, s25, s48
    v_lshrrev_b32 v60, 4, v32
    v_lshlrev_b32 v60, 2, v60
    v_add_u32 v60, s24, v60
    v_and_b32 v34, 15, v32
    v_add_u32 v34, s25, v34
    v_lshlrev_b32 v34, 11, v34
    v_lshl_add_u32 v34, v60, 1, v34
    v_lshlrev_b32 v60, 2, v60
    v_add_u32 v60, 20480, v60
    s_mov_b32 s48, 24576
    buffer_load_dwordx4 v[36:39], v60, s[64:67], 0 offen offset:0 sc1
    buffer_load_dwordx4 v[44:47], v60, s[64:67], s48 offen offset:0 sc1
    buffer_load_dwordx4 v[40:43], v60, s[64:67], 0 offen offset:64 sc1
    buffer_load_dwordx4 v[48:51], v60, s[64:67], s48 offen offset:64 sc1
    s_mov_b32 s48, 0
    buffer_load_dwordx2 v[52:53], v34, s[60:63], s48 offen offset:0 sc1
    s_mov_b32 s48, 32768
    buffer_load_dwordx2 v[54:55], v34, s[60:63], s48 offen offset:0 sc1
    s_mov_b32 s48, 0
    buffer_load_dwordx2 v[56:57], v34, s[60:63], s48 offen offset:32 sc1
    s_mov_b32 s48, 32768
    buffer_load_dwordx2 v[58:59], v34, s[60:63], s48 offen offset:32 sc1
    v_mov_b32 v0, 0
    v_mov_b32 v1, 0
    v_mov_b32 v2, 0
    v_mov_b32 v3, 0
    v_mov_b32 v4, 0
    v_mov_b32 v5, 0
    v_mov_b32 v6, 0
    v_mov_b32 v7, 0
    v_mov_b32 v8, 0
    v_mov_b32 v9, 0
    v_mov_b32 v10, 0
    v_mov_b32 v11, 0
    v_mov_b32 v12, 0
    v_mov_b32 v13, 0
    v_mov_b32 v14, 0
    v_mov_b32 v15, 0
    v_mov_b32 v16, 0
    v_mov_b32 v17, 0
    v_mov_b32 v18, 0
    v_mov_b32 v19, 0
    v_mov_b32 v20, 0
    v_mov_b32 v21, 0
    v_mov_b32 v22, 0
    v_mov_b32 v23, 0
    v_mov_b32 v24, 0
    v_mov_b32 v25, 0
    v_mov_b32 v26, 0
    v_mov_b32 v27, 0
    v_mov_b32 v28, 0
    v_mov_b32 v29, 0
    v_mov_b32 v30, 0
    v_mov_b32 v31, 0
    s_waitcnt vmcnt(14)
    s_barrier
    v_add_u32 v70, 0, v65
    v_add_u32 v71, 0, v66
    v_add_u32 v72, 0, v67
    ds_read_b128 a[8:11], v70 offset:0
    ds_read_b128 a[12:15], v70 offset:1024
    ds_read_b128 a[16:19], v70 offset:2048
    ds_read_b128 a[20:23], v70 offset:3072
    ds_read_b64_tr_b16 a[0:1], v71 offset:0
    ds_read_b64_tr_b16 a[2:3], v71 offset:4096
    ds_read_b64_tr_b16 a[4:5], v72 offset:0
    ds_read_b64_tr_b16 a[6:7], v72 offset:4096
    ds_read_b128 a[32:35], v70 offset:16384
    ds_read_b128 a[36:39], v70 offset:17408
    ds_read_b128 a[40:43], v70 offset:18432
    ds_read_b128 a[44:47], v70 offset:19456
    ds_read_b64_tr_b16 a[24:25], v71 offset:16384
    ds_read_b64_tr_b16 a[26:27], v71 offset:20480
    ds_read_b64_tr_b16 a[28:29], v72 offset:16384
    ds_read_b64_tr_b16 a[30:31], v72 offset:20480
    s_mov_b32 s22, 0
    s_mov_b32 s56, 32768
    v_add_u32 v73, s56, v65
    v_add_u32 v74, s56, v66
    v_add_u32 v75, s56, v67
    s_waitcnt vmcnt(12) lgkmcnt(8)
    s_barrier
    v_mfma_f32_16x16x32_bf16 v[0:3], a[0:3], a[8:11], v[0:3]
    ds_read_b128 a[56:59], v73 offset:0
    s_add_u32 s23, s31, s21
    s_add_u32 s30, s31, s20
    s_mov_b32 s31, s22
    s_mov_b32 s22, s56
    v_mfma_f32_16x16x32_bf16 v[4:7], a[0:3], a[12:15], v[4:7]
    ds_read_b128 a[60:63], v73 offset:1024
    s_add_u32 s56, s56, 32768
    s_cmp_eq_u32 s56, 163840
    s_cselect_b32 s56, 0, s56
    v_mfma_f32_16x16x32_bf16 v[8:11], a[0:3], a[16:19], v[8:11]
    ds_read_b128 a[64:67], v73 offset:2048
    s_add_u32 m0, s23, 0
    v_mfma_f32_16x16x32_bf16 v[12:15], a[0:3], a[20:23], v[12:15]
    ds_read_b128 a[68:71], v73 offset:3072
    buffer_load_dwordx4 v64, s[8:11], s18 offen sc1 lds
    v_mfma_f32_16x16x32_bf16 v[16:19], a[4:7], a[8:11], v[16:19]
    ds_read_b64_tr_b16 a[48:49], v74 offset:0
    s_add_u32 m0, s30, 0
    v_mfma_f32_16x16x32_bf16 v[20:23], a[4:7], a[12:15], v[20:23]
    ds_read_b64_tr_b16 a[50:51], v74 offset:4096
    buffer_load_dwordx4 v143, s[4:7], s17 offen lds
    v_mfma_f32_16x16x32_bf16 v[24:27], a[4:7], a[16:19], v[24:27]
    ds_read_b64_tr_b16 a[52:53], v75 offset:0
    v_mfma_f32_16x16x32_bf16 v[28:31], a[4:7], a[20:23], v[28:31]
    ds_read_b64_tr_b16 a[54:55], v75 offset:4096
    s_add_u32 s18, s18, 1024
    s_add_u32 s17, s17, 65536
    s_waitcnt lgkmcnt(8)
    v_mfma_f32_16x16x32_bf16 v[0:3], a[24:27], a[32:35], v[0:3]
    ds_read_b128 a[80:83], v73 offset:16384
    s_add_u32 m0, s23, 16384
    v_mfma_f32_16x16x32_bf16 v[4:7], a[24:27], a[36:39], v[4:7]
    ds_read_b128 a[84:87], v73 offset:17408
    buffer_load_dwordx4 v64, s[8:11], s18 offen sc1 lds
    v_mfma_f32_16x16x32_bf16 v[8:11], a[24:27], a[40:43], v[8:11]
    ds_read_b128 a[88:91], v73 offset:18432
    v_mfma_f32_16x16x32_bf16 v[12:15], a[24:27], a[44:47], v[12:15]
    ds_read_b128 a[92:95], v73 offset:19456
    s_add_u32 m0, s30, 16384
    v_mfma_f32_16x16x32_bf16 v[16:19], a[28:31], a[32:35], v[16:19]
    ds_read_b64_tr_b16 a[72:73], v74 offset:16384
    buffer_load_dwordx4 v143, s[4:7], s17 offen lds
    v_mfma_f32_16x16x32_bf16 v[20:23], a[28:31], a[36:39], v[20:23]
    ds_read_b64_tr_b16 a[74:75], v74 offset:20480
    v_mfma_f32_16x16x32_bf16 v[24:27], a[28:31], a[40:43], v[24:27]
    ds_read_b64_tr_b16 a[76:77], v75 offset:16384
    v_mfma_f32_16x16x32_bf16 v[28:31], a[28:31], a[44:47], v[28:31]
    ds_read_b64_tr_b16 a[78:79], v75 offset:20480
    s_add_u32 s18, s18, 1024
    s_add_u32 s17, s17, 65536
    v_add_u32 v70, s56, v65
    v_add_u32 v71, s56, v66
    v_add_u32 v72, s56, v67
    s_waitcnt vmcnt(14) lgkmcnt(8)
    s_barrier
    v_mfma_f32_16x16x32_bf16 v[0:3], a[48:51], a[56:59], v[0:3]
    ds_read_b128 a[8:11], v70 offset:0
    s_add_u32 s23, s31, s21
    s_add_u32 s30, s31, s20
    s_mov_b32 s31, s22
    s_mov_b32 s22, s56
    v_mfma_f32_16x16x32_bf16 v[4:7], a[48:51], a[60:63], v[4:7]
    ds_read_b128 a[12:15], v70 offset:1024
    s_add_u32 s56, s56, 32768
    s_cmp_eq_u32 s56, 163840
    s_cselect_b32 s56, 0, s56
    v_mfma_f32_16x16x32_bf16 v[8:11], a[48:51], a[64:67], v[8:11]
    ds_read_b128 a[16:19], v70 offset:2048
    s_add_u32 m0, s23, 0
    v_mfma_f32_16x16x32_bf16 v[12:15], a[48:51], a[68:71], v[12:15]
    ds_read_b128 a[20:23], v70 offset:3072
    buffer_load_dwordx4 v64, s[8:11], s18 offen sc1 lds
    v_mfma_f32_16x16x32_bf16 v[16:19], a[52:55], a[56:59], v[16:19]
    ds_read_b64_tr_b16 a[0:1], v71 offset:0
    s_add_u32 m0, s30, 0
    v_mfma_f32_16x16x32_bf16 v[20:23], a[52:55], a[60:63], v[20:23]
    ds_read_b64_tr_b16 a[2:3], v71 offset:4096
    buffer_load_dwordx4 v143, s[4:7], s17 offen lds
    v_mfma_f32_16x16x32_bf16 v[24:27], a[52:55], a[64:67], v[24:27]
    ds_read_b64_tr_b16 a[4:5], v72 offset:0
    v_mfma_f32_16x16x32_bf16 v[28:31], a[52:55], a[68:71], v[28:31]
    ds_read_b64_tr_b16 a[6:7], v72 offset:4096
    s_add_u32 s18, s18, 1024
    s_add_u32 s17, s17, 65536
    s_waitcnt lgkmcnt(8)
    v_mfma_f32_16x16x32_bf16 v[0:3], a[72:75], a[80:83], v[0:3]
    ds_read_b128 a[32:35], v70 offset:16384
    s_add_u32 m0, s23, 16384
    v_mfma_f32_16x16x32_bf16 v[4:7], a[72:75], a[84:87], v[4:7]
    ds_read_b128 a[36:39], v70 offset:17408
    buffer_load_dwordx4 v64, s[8:11], s18 offen sc1 lds
    v_mfma_f32_16x16x32_bf16 v[8:11], a[72:75], a[88:91], v[8:11]
    ds_read_b128 a[40:43], v70 offset:18432
    v_mfma_f32_16x16x32_bf16 v[12:15], a[72:75], a[92:95], v[12:15]
    ds_read_b128 a[44:47], v70 offset:19456
    s_add_u32 m0, s30, 16384
    v_mfma_f32_16x16x32_bf16 v[16:19], a[76:79], a[80:83], v[16:19]
    ds_read_b64_tr_b16 a[24:25], v71 offset:16384
    buffer_load_dwordx4 v143, s[4:7], s17 offen lds
    v_mfma_f32_16x16x32_bf16 v[20:23], a[76:79], a[84:87], v[20:23]
    ds_read_b64_tr_b16 a[26:27], v71 offset:20480
    v_mfma_f32_16x16x32_bf16 v[24:27], a[76:79], a[88:91], v[24:27]
    ds_read_b64_tr_b16 a[28:29], v72 offset:16384
    v_mfma_f32_16x16x32_bf16 v[28:31], a[76:79], a[92:95], v[28:31]
    ds_read_b64_tr_b16 a[30:31], v72 offset:20480
    s_add_u32 s18, s18, 1024
    s_add_u32 s17, s17, 65536
    v_add_u32 v73, s56, v65
    v_add_u32 v74, s56, v66
    v_add_u32 v75, s56, v67
    s_waitcnt vmcnt(16) lgkmcnt(8)
    s_barrier
    v_mfma_f32_16x16x32_bf16 v[0:3], a[0:3], a[8:11], v[0:3]
    ds_read_b128 a[56:59], v73 offset:0
    s_add_u32 s23, s31, s21
    s_add_u32 s30, s31, s20
    s_mov_b32 s31, s22
    s_mov_b32 s22, s56
    v_mfma_f32_16x16x32_bf16 v[4:7], a[0:3], a[12:15], v[4:7]
    ds_read_b128 a[60:63], v73 offset:1024
    s_add_u32 s56, s56, 32768
    s_cmp_eq_u32 s56, 163840
    s_cselect_b32 s56, 0, s56
    v_mfma_f32_16x16x32_bf16 v[8:11], a[0:3], a[16:19], v[8:11]
    ds_read_b128 a[64:67], v73 offset:2048
    s_add_u32 m0, s23, 0
    v_mfma_f32_16x16x32_bf16 v[12:15], a[0:3], a[20:23], v[12:15]
    ds_read_b128 a[68:71], v73 offset:3072
    buffer_load_dwordx4 v64, s[8:11], s18 offen sc1 lds
    v_mfma_f32_16x16x32_bf16 v[16:19], a[4:7], a[8:11], v[16:19]
    ds_read_b64_tr_b16 a[48:49], v74 offset:0
    s_add_u32 m0, s30, 0
    v_mfma_f32_16x16x32_bf16 v[20:23], a[4:7], a[12:15], v[20:23]
    ds_read_b64_tr_b16 a[50:51], v74 offset:4096
    buffer_load_dwordx4 v143, s[4:7], s17 offen lds
    v_mfma_f32_16x16x32_bf16 v[24:27], a[4:7], a[16:19], v[24:27]
    ds_read_b64_tr_b16 a[52:53], v75 offset:0
    v_mfma_f32_16x16x32_bf16 v[28:31], a[4:7], a[20:23], v[28:31]
    ds_read_b64_tr_b16 a[54:55], v75 offset:4096
    s_add_u32 s18, s18, 1024
    s_add_u32 s17, s17, 65536
    s_waitcnt lgkmcnt(8)
    v_mfma_f32_16x16x32_bf16 v[0:3], a[24:27], a[32:35], v[0:3]
    ds_read_b128 a[80:83], v73 offset:16384
    s_add_u32 m0, s23, 16384
    v_mfma_f32_16x16x32_bf16 v[4:7], a[24:27], a[36:39], v[4:7]
    ds_read_b128 a[84:87], v73 offset:17408
    buffer_load_dwordx4 v64, s[8:11], s18 offen sc1 lds
    v_mfma_f32_16x16x32_bf16 v[8:11], a[24:27], a[40:43], v[8:11]
    ds_read_b128 a[88:91], v73 offset:18432
    v_mfma_f32_16x16x32_bf16 v[12:15], a[24:27], a[44:47], v[12:15]
    ds_read_b128 a[92:95], v73 offset:19456
    s_add_u32 m0, s30, 16384
    v_mfma_f32_16x16x32_bf16 v[16:19], a[28:31], a[32:35], v[16:19]
    ds_read_b64_tr_b16 a[72:73], v74 offset:16384
    buffer_load_dwordx4 v143, s[4:7], s17 offen lds
    v_mfma_f32_16x16x32_bf16 v[20:23], a[28:31], a[36:39], v[20:23]
    ds_read_b64_tr_b16 a[74:75], v74 offset:20480
    v_mfma_f32_16x16x32_bf16 v[24:27], a[28:31], a[40:43], v[24:27]
    ds_read_b64_tr_b16 a[76:77], v75 offset:16384
    v_mfma_f32_16x16x32_bf16 v[28:31], a[28:31], a[44:47], v[28:31]
    ds_read_b64_tr_b16 a[78:79], v75 offset:20480
    s_add_u32 s18, s18, 1024
    s_add_u32 s17, s17, 65536
    v_add_u32 v70, s56, v65
    v_add_u32 v71, s56, v66
    v_add_u32 v72, s56, v67
    s_waitcnt vmcnt(8) lgkmcnt(8)
    s_barrier
    v_mfma_f32_16x16x32_bf16 v[0:3], a[48:51], a[56:59], v[0:3]
    ds_read_b128 a[8:11], v70 offset:0
    s_add_u32 s23, s31, s21
    s_add_u32 s30, s31, s20
    s_mov_b32 s31, s22
    s_mov_b32 s22, s56
    v_mfma_f32_16x16x32_bf16 v[4:7], a[48:51], a[60:63], v[4:7]
    ds_read_b128 a[12:15], v70 offset:1024
    s_add_u32 s56, s56, 32768
    s_cmp_eq_u32 s56, 163840
    s_cselect_b32 s56, 0, s56
    v_mfma_f32_16x16x32_bf16 v[8:11], a[48:51], a[64:67], v[8:11]
    ds_read_b128 a[16:19], v70 offset:2048
    s_add_u32 m0, s23, 0
    v_mfma_f32_16x16x32_bf16 v[12:15], a[48:51], a[68:71], v[12:15]
    ds_read_b128 a[20:23], v70 offset:3072
    buffer_load_dwordx4 v64, s[8:11], s18 offen sc1 lds
    v_mfma_f32_16x16x32_bf16 v[16:19], a[52:55], a[56:59], v[16:19]
    ds_read_b64_tr_b16 a[0:1], v71 offset:0
    s_add_u32 m0, s30, 0
    v_mfma_f32_16x16x32_bf16 v[20:23], a[52:55], a[60:63], v[20:23]
    ds_read_b64_tr_b16 a[2:3], v71 offset:4096
    buffer_load_dwordx4 v143, s[4:7], s17 offen lds
    v_mfma_f32_16x16x32_bf16 v[24:27], a[52:55], a[64:67], v[24:27]
    ds_read_b64_tr_b16 a[4:5], v72 offset:0
    v_mfma_f32_16x16x32_bf16 v[28:31], a[52:55], a[68:71], v[28:31]
    ds_read_b64_tr_b16 a[6:7], v72 offset:4096
    s_add_u32 s18, s18, 1024
    s_add_u32 s17, s17, 65536
    s_waitcnt lgkmcnt(8)
    v_mfma_f32_16x16x32_bf16 v[0:3], a[72:75], a[80:83], v[0:3]
    ds_read_b128 a[32:35], v70 offset:16384
    s_add_u32 m0, s23, 16384
    v_mfma_f32_16x16x32_bf16 v[4:7], a[72:75], a[84:87], v[4:7]
    ds_read_b128 a[36:39], v70 offset:17408
    buffer_load_dwordx4 v64, s[8:11], s18 offen sc1 lds
    v_mfma_f32_16x16x32_bf16 v[8:11], a[72:75], a[88:91], v[8:11]
    ds_read_b128 a[40:43], v70 offset:18432
    v_mfma_f32_16x16x32_bf16 v[12:15], a[72:75], a[92:95], v[12:15]
    ds_read_b128 a[44:47], v70 offset:19456
    s_add_u32 m0, s30, 16384
    v_mfma_f32_16x16x32_bf16 v[16:19], a[76:79], a[80:83], v[16:19]
    ds_read_b64_tr_b16 a[24:25], v71 offset:16384
    buffer_load_dwordx4 v143, s[4:7], s17 offen lds
    v_mfma_f32_16x16x32_bf16 v[20:23], a[76:79], a[84:87], v[20:23]
    ds_read_b64_tr_b16 a[26:27], v71 offset:20480
    v_mfma_f32_16x16x32_bf16 v[24:27], a[76:79], a[88:91], v[24:27]
    ds_read_b64_tr_b16 a[28:29], v72 offset:16384
    v_mfma_f32_16x16x32_bf16 v[28:31], a[76:79], a[92:95], v[28:31]
    ds_read_b64_tr_b16 a[30:31], v72 offset:20480
    s_add_u32 s18, s18, 1024
    s_add_u32 s17, s17, 65536
    v_add_u32 v73, s56, v65
    v_add_u32 v74, s56, v66
    v_add_u32 v75, s56, v67
    s_mov_b32 s19, 10
Lloop_38:
    s_waitcnt vmcnt(8) lgkmcnt(8)
    s_barrier
    v_mfma_f32_16x16x32_bf16 v[0:3], a[0:3], a[8:11], v[0:3]
    ds_read_b128 a[56:59], v73 offset:0
    s_add_u32 s23, s31, s21
    s_add_u32 s30, s31, s20
    s_mov_b32 s31, s22
    s_mov_b32 s22, s56
    v_mfma_f32_16x16x32_bf16 v[4:7], a[0:3], a[12:15], v[4:7]
    ds_read_b128 a[60:63], v73 offset:1024
    s_add_u32 s56, s56, 32768
    s_cmp_eq_u32 s56, 163840
    s_cselect_b32 s56, 0, s56
    v_mfma_f32_16x16x32_bf16 v[8:11], a[0:3], a[16:19], v[8:11]
    ds_read_b128 a[64:67], v73 offset:2048
    s_add_u32 m0, s23, 0
    v_mfma_f32_16x16x32_bf16 v[12:15], a[0:3], a[20:23], v[12:15]
    ds_read_b128 a[68:71], v73 offset:3072
    buffer_load_dwordx4 v64, s[8:11], s18 offen sc1 lds
    v_mfma_f32_16x16x32_bf16 v[16:19], a[4:7], a[8:11], v[16:19]
    ds_read_b64_tr_b16 a[48:49], v74 offset:0
    s_add_u32 m0, s30, 0
    v_mfma_f32_16x16x32_bf16 v[20:23], a[4:7], a[12:15], v[20:23]
    ds_read_b64_tr_b16 a[50:51], v74 offset:4096
    buffer_load_dwordx4 v143, s[4:7], s17 offen lds
    v_mfma_f32_16x16x32_bf16 v[24:27], a[4:7], a[16:19], v[24:27]
    ds_read_b64_tr_b16 a[52:53], v75 offset:0
    v_mfma_f32_16x16x32_bf16 v[28:31], a[4:7], a[20:23], v[28:31]
    ds_read_b64_tr_b16 a[54:55], v75 offset:4096
    s_add_u32 s18, s18, 1024
    s_add_u32 s17, s17, 65536
    s_waitcnt lgkmcnt(8)
    v_mfma_f32_16x16x32_bf16 v[0:3], a[24:27], a[32:35], v[0:3]
    ds_read_b128 a[80:83], v73 offset:16384
    s_add_u32 m0, s23, 16384
    v_mfma_f32_16x16x32_bf16 v[4:7], a[24:27], a[36:39], v[4:7]
    ds_read_b128 a[84:87], v73 offset:17408
    buffer_load_dwordx4 v64, s[8:11], s18 offen sc1 lds
    v_mfma_f32_16x16x32_bf16 v[8:11], a[24:27], a[40:43], v[8:11]
    ds_read_b128 a[88:91], v73 offset:18432
    v_mfma_f32_16x16x32_bf16 v[12:15], a[24:27], a[44:47], v[12:15]
    ds_read_b128 a[92:95], v73 offset:19456
    s_add_u32 m0, s30, 16384
    v_mfma_f32_16x16x32_bf16 v[16:19], a[28:31], a[32:35], v[16:19]
    ds_read_b64_tr_b16 a[72:73], v74 offset:16384
    buffer_load_dwordx4 v143, s[4:7], s17 offen lds
    v_mfma_f32_16x16x32_bf16 v[20:23], a[28:31], a[36:39], v[20:23]
    ds_read_b64_tr_b16 a[74:75], v74 offset:20480
    v_mfma_f32_16x16x32_bf16 v[24:27], a[28:31], a[40:43], v[24:27]
    ds_read_b64_tr_b16 a[76:77], v75 offset:16384
    v_mfma_f32_16x16x32_bf16 v[28:31], a[28:31], a[44:47], v[28:31]
    ds_read_b64_tr_b16 a[78:79], v75 offset:20480
    s_add_u32 s18, s18, 1024
    s_add_u32 s17, s17, 65536
    v_add_u32 v70, s56, v65
    v_add_u32 v71, s56, v66
    v_add_u32 v72, s56, v67
    s_waitcnt vmcnt(8) lgkmcnt(8)
    s_barrier
    v_mfma_f32_16x16x32_bf16 v[0:3], a[48:51], a[56:59], v[0:3]
    ds_read_b128 a[8:11], v70 offset:0
    s_add_u32 s23, s31, s21
    s_add_u32 s30, s31, s20
    s_mov_b32 s31, s22
    s_mov_b32 s22, s56
    v_mfma_f32_16x16x32_bf16 v[4:7], a[48:51], a[60:63], v[4:7]
    ds_read_b128 a[12:15], v70 offset:1024
    s_add_u32 s56, s56, 32768
    s_cmp_eq_u32 s56, 163840
    s_cselect_b32 s56, 0, s56
    v_mfma_f32_16x16x32_bf16 v[8:11], a[48:51], a[64:67], v[8:11]
    ds_read_b128 a[16:19], v70 offset:2048
    s_add_u32 m0, s23, 0
    v_mfma_f32_16x16x32_bf16 v[12:15], a[48:51], a[68:71], v[12:15]
    ds_read_b128 a[20:23], v70 offset:3072
    buffer_load_dwordx4 v64, s[8:11], s18 offen sc1 lds
    v_mfma_f32_16x16x32_bf16 v[16:19], a[52:55], a[56:59], v[16:19]
    ds_read_b64_tr_b16 a[0:1], v71 offset:0
    s_add_u32 m0, s30, 0
    v_mfma_f32_16x16x32_bf16 v[20:23], a[52:55], a[60:63], v[20:23]
    ds_read_b64_tr_b16 a[2:3], v71 offset:4096
    buffer_load_dwordx4 v143, s[4:7], s17 offen lds
    v_mfma_f32_16x16x32_bf16 v[24:27], a[52:55], a[64:67], v[24:27]
    ds_read_b64_tr_b16 a[4:5], v72 offset:0
    v_mfma_f32_16x16x32_bf16 v[28:31], a[52:55], a[68:71], v[28:31]
    ds_read_b64_tr_b16 a[6:7], v72 offset:4096
    s_add_u32 s18, s18, 1024
    s_add_u32 s17, s17, 65536
    s_waitcnt lgkmcnt(8)
    v_mfma_f32_16x16x32_bf16 v[0:3], a[72:75], a[80:83], v[0:3]
    ds_read_b128 a[32:35], v70 offset:16384
    s_add_u32 m0, s23, 16384
    v_mfma_f32_16x16x32_bf16 v[4:7], a[72:75], a[84:87], v[4:7]
    ds_read_b128 a[36:39], v70 offset:17408
    buffer_load_dwordx4 v64, s[8:11], s18 offen sc1 lds
    v_mfma_f32_16x16x32_bf16 v[8:11], a[72:75], a[88:91], v[8:11]
    ds_read_b128 a[40:43], v70 offset:18432
    v_mfma_f32_16x16x32_bf16 v[12:15], a[72:75], a[92:95], v[12:15]
    ds_read_b128 a[44:47], v70 offset:19456
    s_add_u32 m0, s30, 16384
    v_mfma_f32_16x16x32_bf16 v[16:19], a[76:79], a[80:83], v[16:19]
    ds_read_b64_tr_b16 a[24:25], v71 offset:16384
    buffer_load_dwordx4 v143, s[4:7], s17 offen lds
    v_mfma_f32_16x16x32_bf16 v[20:23], a[76:79], a[84:87], v[20:23]
    ds_read_b64_tr_b16 a[26:27], v71 offset:20480
    v_mfma_f32_16x16x32_bf16 v[24:27], a[76:79], a[88:91], v[24:27]
    ds_read_b64_tr_b16 a[28:29], v72 offset:16384
    v_mfma_f32_16x16x32_bf16 v[28:31], a[76:79], a[92:95], v[28:31]
    ds_read_b64_tr_b16 a[30:31], v72 offset:20480
    s_add_u32 s18, s18, 1024
    s_add_u32 s17, s17, 65536
    v_add_u32 v73, s56, v65
    v_add_u32 v74, s56, v66
    v_add_u32 v75, s56, v67
    s_sub_u32 s19, s19, 1
    s_cmp_lg_u32 s19, 0
    s_cbranch_scc1 Lloop_38
    s_waitcnt vmcnt(8) lgkmcnt(8)
    s_barrier
    v_mfma_f32_16x16x32_bf16 v[0:3], a[0:3], a[8:11], v[0:3]
    ds_read_b128 a[56:59], v73 offset:0
    s_mov_b32 s22, s56
    s_add_u32 s56, s56, 32768
    v_mfma_f32_16x16x32_bf16 v[4:7], a[0:3], a[12:15], v[4:7]
    ds_read_b128 a[60:63], v73 offset:1024
    s_cmp_eq_u32 s56, 163840
    s_cselect_b32 s56, 0, s56
    v_mfma_f32_16x16x32_bf16 v[8:11], a[0:3], a[16:19], v[8:11]
    ds_read_b128 a[64:67], v73 offset:2048
    v_mfma_f32_16x16x32_bf16 v[12:15], a[0:3], a[20:23], v[12:15]
    ds_read_b128 a[68:71], v73 offset:3072
    v_mfma_f32_16x16x32_bf16 v[16:19], a[4:7], a[8:11], v[16:19]
    ds_read_b64_tr_b16 a[48:49], v74 offset:0
    v_mfma_f32_16x16x32_bf16 v[20:23], a[4:7], a[12:15], v[20:23]
    ds_read_b64_tr_b16 a[50:51], v74 offset:4096
    v_mfma_f32_16x16x32_bf16 v[24:27], a[4:7], a[16:19], v[24:27]
    ds_read_b64_tr_b16 a[52:53], v75 offset:0
    v_mfma_f32_16x16x32_bf16 v[28:31], a[4:7], a[20:23], v[28:31]
    ds_read_b64_tr_b16 a[54:55], v75 offset:4096
    s_waitcnt lgkmcnt(8)
    v_mfma_f32_16x16x32_bf16 v[0:3], a[24:27], a[32:35], v[0:3]
    ds_read_b128 a[80:83], v73 offset:16384
    v_mfma_f32_16x16x32_bf16 v[4:7], a[24:27], a[36:39], v[4:7]
    ds_read_b128 a[84:87], v73 offset:17408
    v_mfma_f32_16x16x32_bf16 v[8:11], a[24:27], a[40:43], v[8:11]
    ds_read_b128 a[88:91], v73 offset:18432
    v_mfma_f32_16x16x32_bf16 v[12:15], a[24:27], a[44:47], v[12:15]
    ds_read_b128 a[92:95], v73 offset:19456
    v_mfma_f32_16x16x32_bf16 v[16:19], a[28:31], a[32:35], v[16:19]
    ds_read_b64_tr_b16 a[72:73], v74 offset:16384
    v_mfma_f32_16x16x32_bf16 v[20:23], a[28:31], a[36:39], v[20:23]
    ds_read_b64_tr_b16 a[74:75], v74 offset:20480
    v_mfma_f32_16x16x32_bf16 v[24:27], a[28:31], a[40:43], v[24:27]
    ds_read_b64_tr_b16 a[76:77], v75 offset:16384
    v_mfma_f32_16x16x32_bf16 v[28:31], a[28:31], a[44:47], v[28:31]
    ds_read_b64_tr_b16 a[78:79], v75 offset:20480
    v_add_u32 v70, s56, v65
    v_add_u32 v71, s56, v66
    v_add_u32 v72, s56, v67
    s_waitcnt vmcnt(4) lgkmcnt(8)
    s_barrier
    v_mfma_f32_16x16x32_bf16 v[0:3], a[48:51], a[56:59], v[0:3]
    ds_read_b128 a[8:11], v70 offset:0
    s_mov_b32 s22, s56
    s_add_u32 s56, s56, 32768
    v_mfma_f32_16x16x32_bf16 v[4:7], a[48:51], a[60:63], v[4:7]
    ds_read_b128 a[12:15], v70 offset:1024
    s_cmp_eq_u32 s56, 163840
    s_cselect_b32 s56, 0, s56
    v_mfma_f32_16x16x32_bf16 v[8:11], a[48:51], a[64:67], v[8:11]
    ds_read_b128 a[16:19], v70 offset:2048
    v_mfma_f32_16x16x32_bf16 v[12:15], a[48:51], a[68:71], v[12:15]
    ds_read_b128 a[20:23], v70 offset:3072
    v_mfma_f32_16x16x32_bf16 v[16:19], a[52:55], a[56:59], v[16:19]
    ds_read_b64_tr_b16 a[0:1], v71 offset:0
    v_mfma_f32_16x16x32_bf16 v[20:23], a[52:55], a[60:63], v[20:23]
    ds_read_b64_tr_b16 a[2:3], v71 offset:4096
    v_mfma_f32_16x16x32_bf16 v[24:27], a[52:55], a[64:67], v[24:27]
    ds_read_b64_tr_b16 a[4:5], v72 offset:0
    v_mfma_f32_16x16x32_bf16 v[28:31], a[52:55], a[68:71], v[28:31]
    ds_read_b64_tr_b16 a[6:7], v72 offset:4096
    s_waitcnt lgkmcnt(8)
    v_mfma_f32_16x16x32_bf16 v[0:3], a[72:75], a[80:83], v[0:3]
    ds_read_b128 a[32:35], v70 offset:16384
    v_mfma_f32_16x16x32_bf16 v[4:7], a[72:75], a[84:87], v[4:7]
    ds_read_b128 a[36:39], v70 offset:17408
    v_mfma_f32_16x16x32_bf16 v[8:11], a[72:75], a[88:91], v[8:11]
    ds_read_b128 a[40:43], v70 offset:18432
    v_mfma_f32_16x16x32_bf16 v[12:15], a[72:75], a[92:95], v[12:15]
    ds_read_b128 a[44:47], v70 offset:19456
    v_mfma_f32_16x16x32_bf16 v[16:19], a[76:79], a[80:83], v[16:19]
    ds_read_b64_tr_b16 a[24:25], v71 offset:16384
    v_mfma_f32_16x16x32_bf16 v[20:23], a[76:79], a[84:87], v[20:23]
    ds_read_b64_tr_b16 a[26:27], v71 offset:20480
    v_mfma_f32_16x16x32_bf16 v[24:27], a[76:79], a[88:91], v[24:27]
    ds_read_b64_tr_b16 a[28:29], v72 offset:16384
    v_mfma_f32_16x16x32_bf16 v[28:31], a[76:79], a[92:95], v[28:31]
    ds_read_b64_tr_b16 a[30:31], v72 offset:20480
    v_add_u32 v73, s56, v65
    v_add_u32 v74, s56, v66
    v_add_u32 v75, s56, v67
    s_waitcnt vmcnt(0) lgkmcnt(8)
    s_barrier
    v_mfma_f32_16x16x32_bf16 v[0:3], a[0:3], a[8:11], v[0:3]
    ds_read_b128 a[56:59], v73 offset:0
    s_mov_b32 s22, s56
    s_add_u32 s56, s56, 32768
    v_mfma_f32_16x16x32_bf16 v[4:7], a[0:3], a[12:15], v[4:7]
    ds_read_b128 a[60:63], v73 offset:1024
    s_cmp_eq_u32 s56, 163840
    s_cselect_b32 s56, 0, s56
    v_mfma_f32_16x16x32_bf16 v[8:11], a[0:3], a[16:19], v[8:11]
    ds_read_b128 a[64:67], v73 offset:2048
    v_mfma_f32_16x16x32_bf16 v[12:15], a[0:3], a[20:23], v[12:15]
    ds_read_b128 a[68:71], v73 offset:3072
    v_mfma_f32_16x16x32_bf16 v[16:19], a[4:7], a[8:11], v[16:19]
    ds_read_b64_tr_b16 a[48:49], v74 offset:0
    v_mfma_f32_16x16x32_bf16 v[20:23], a[4:7], a[12:15], v[20:23]
    ds_read_b64_tr_b16 a[50:51], v74 offset:4096
    v_mfma_f32_16x16x32_bf16 v[24:27], a[4:7], a[16:19], v[24:27]
    ds_read_b64_tr_b16 a[52:53], v75 offset:0
    v_mfma_f32_16x16x32_bf16 v[28:31], a[4:7], a[20:23], v[28:31]
    ds_read_b64_tr_b16 a[54:55], v75 offset:4096
    s_waitcnt lgkmcnt(8)
    v_mfma_f32_16x16x32_bf16 v[0:3], a[24:27], a[32:35], v[0:3]
    ds_read_b128 a[80:83], v73 offset:16384
    v_mfma_f32_16x16x32_bf16 v[4:7], a[24:27], a[36:39], v[4:7]
    ds_read_b128 a[84:87], v73 offset:17408
    v_mfma_f32_16x16x32_bf16 v[8:11], a[24:27], a[40:43], v[8:11]
    ds_read_b128 a[88:91], v73 offset:18432
    v_mfma_f32_16x16x32_bf16 v[12:15], a[24:27], a[44:47], v[12:15]
    ds_read_b128 a[92:95], v73 offset:19456
    v_mfma_f32_16x16x32_bf16 v[16:19], a[28:31], a[32:35], v[16:19]
    ds_read_b64_tr_b16 a[72:73], v74 offset:16384
    v_mfma_f32_16x16x32_bf16 v[20:23], a[28:31], a[36:39], v[20:23]
    ds_read_b64_tr_b16 a[74:75], v74 offset:20480
    v_mfma_f32_16x16x32_bf16 v[24:27], a[28:31], a[40:43], v[24:27]
    ds_read_b64_tr_b16 a[76:77], v75 offset:16384
    v_mfma_f32_16x16x32_bf16 v[28:31], a[28:31], a[44:47], v[28:31]
    ds_read_b64_tr_b16 a[78:79], v75 offset:20480
    v_add_u32 v70, s56, v65
    v_add_u32 v71, s56, v66
    v_add_u32 v72, s56, v67
    s_waitcnt lgkmcnt(8)
    v_mfma_f32_16x16x32_bf16 v[0:3], a[48:51], a[56:59], v[0:3]
    v_mfma_f32_16x16x32_bf16 v[4:7], a[48:51], a[60:63], v[4:7]
    v_mfma_f32_16x16x32_bf16 v[8:11], a[48:51], a[64:67], v[8:11]
    v_mfma_f32_16x16x32_bf16 v[12:15], a[48:51], a[68:71], v[12:15]
    v_mfma_f32_16x16x32_bf16 v[16:19], a[52:55], a[56:59], v[16:19]
    v_mfma_f32_16x16x32_bf16 v[20:23], a[52:55], a[60:63], v[20:23]
    v_mfma_f32_16x16x32_bf16 v[24:27], a[52:55], a[64:67], v[24:27]
    v_mfma_f32_16x16x32_bf16 v[28:31], a[52:55], a[68:71], v[28:31]
    s_waitcnt lgkmcnt(0)
    v_mfma_f32_16x16x32_bf16 v[0:3], a[72:75], a[80:83], v[0:3]
    v_mfma_f32_16x16x32_bf16 v[4:7], a[72:75], a[84:87], v[4:7]
    v_mfma_f32_16x16x32_bf16 v[8:11], a[72:75], a[88:91], v[8:11]
    v_mfma_f32_16x16x32_bf16 v[12:15], a[72:75], a[92:95], v[12:15]
    v_mfma_f32_16x16x32_bf16 v[16:19], a[76:79], a[80:83], v[16:19]
    v_mfma_f32_16x16x32_bf16 v[20:23], a[76:79], a[84:87], v[20:23]
    v_mfma_f32_16x16x32_bf16 v[24:27], a[76:79], a[88:91], v[24:27]
    v_mfma_f32_16x16x32_bf16 v[28:31], a[76:79], a[92:95], v[28:31]
    s_waitcnt vmcnt(0) lgkmcnt(0)
    s_nop 7
    s_nop 7
    s_add_u32 s60, s36, 67108864
    s_addc_u32 s61, s37, 0
    s_and_b32 s61, s61, 0xffff
    s_mov_b32 s62, 8388608
    s_mov_b32 s63, 0x00020000
    s_mov_b32 s12, s38
    s_and_b32 s13, s39, 0xffff
    s_mov_b32 s14, 4194304
    s_mov_b32 s15, 0x00020000
    s_lshl_b32 s48, s2, 3
    s_add_u32 s48, s48, s16
    s_mul_i32 s48, s48, 4096
    v_lshl_add_u32 v60, v32, 4, s48
    s_lshl_b32 s48, s46, 3
    s_add_u32 s48, s48, s16
    s_mul_i32 s48, s48, 4096
    v_lshl_add_u32 v61, v32, 4, s48
    s_cmp_lg_u32 s47, 0
    s_cbranch_scc1 Lk1_39
    buffer_store_dwordx4 v[8:11], v60, s[60:63], 0 offen offset:0 sc1
    buffer_store_dwordx4 v[12:15], v60, s[60:63], 0 offen offset:1024 sc1
    buffer_store_dwordx4 v[24:27], v60, s[60:63], 0 offen offset:2048 sc1
    buffer_store_dwordx4 v[28:31], v60, s[60:63], 0 offen offset:3072 sc1
    s_waitcnt vmcnt(0)
    s_lshl_b32 s76, s2, 3
    s_add_u32 s76, s76, s16
    s_lshl_b32 s76, s76, 7
    s_add_u32 s76, s76, 32768
    s_add_u32 s77, s93, 5
    v_mov_b32 v62, s76
    v_mov_b32 v63, s77
    s_mov_b64 exec, 1
    buffer_store_dword v63, v62, s[88:91], 0 offen sc1
    s_mov_b64 exec, -1
    s_barrier
    v_pk_add_f32 v[36:37], v[36:37], v[44:45]
    v_cvt_pk_bf16_f32 v62, v36, v37
    v_lshlrev_b32 v36, 16, v62
    v_and_b32 v37, s40, v62
    v_pk_add_f32 v[38:39], v[38:39], v[46:47]
    v_cvt_pk_bf16_f32 v62, v38, v39
    v_lshlrev_b32 v38, 16, v62
    v_and_b32 v39, s40, v62
    v_pk_add_f32 v[40:41], v[40:41], v[48:49]
    v_cvt_pk_bf16_f32 v62, v40, v41
    v_lshlrev_b32 v40, 16, v62
    v_and_b32 v41, s40, v62
    v_pk_add_f32 v[42:43], v[42:43], v[50:51]
    v_cvt_pk_bf16_f32 v62, v42, v43
    v_lshlrev_b32 v42, 16, v62
    v_and_b32 v43, s40, v62
    s_lshl_b32 s48, s46, 3
    s_add_u32 s48, s48, s16
    s_lshl_b32 s48, s48, 7
    s_add_u32 s48, s48, 32768
    v_mov_b32 v62, s48
    s_mov_b32 s59, 200000
    s_add_u32 s76, s93, 5
Lpoll_41:
    buffer_load_dword v63, v62, s[88:91], 0 offen sc1
    s_waitcnt vmcnt(0)
    v_subrev_u32 v63, s76, v63
    v_cmp_gt_u32 vcc, 3, v63
    s_nop 1
    s_cmp_eq_u64 vcc, -1
    s_cbranch_scc1 Lpd_42
    s_sub_u32 s59, s59, 1
    s_cmp_lg_u32 s59, 0
    s_sleep 1
    s_cbranch_scc1 Lpoll_41
Lpd_42:
    buffer_load_dwordx4 v[8:11], v61, s[60:63], 0 offen offset:0 sc1
    buffer_load_dwordx4 v[12:15], v61, s[60:63], 0 offen offset:1024 sc1
    buffer_load_dwordx4 v[24:27], v61, s[60:63], 0 offen offset:2048 sc1
    buffer_load_dwordx4 v[28:31], v61, s[60:63], 0 offen offset:3072 sc1
    s_waitcnt vmcnt(3)
    v_pk_add_f32 v[0:1], v[0:1], v[8:9]
    v_cvt_pk_bf16_f32 v62, v0, v1
    v_lshlrev_b32 v0, 16, v62
    v_and_b32 v1, s40, v62
    v_pk_mul_f32 v[0:1], v[0:1], v[36:37]
    v_cvt_pk_bf16_f32 v62, v0, v1
    v_lshlrev_b32 v0, 16, v62
    v_and_b32 v1, s40, v62
    v_lshlrev_b32 v64, 16, v52
    v_and_b32 v65, s40, v52
    v_pk_add_f32 v[0:1], v[0:1], v[64:65]
    v_cvt_pk_bf16_f32 v52, v0, v1
    v_pk_add_f32 v[2:3], v[2:3], v[10:11]
    v_cvt_pk_bf16_f32 v66, v2, v3
    v_lshlrev_b32 v2, 16, v66
    v_and_b32 v3, s40, v66
    v_pk_mul_f32 v[2:3], v[2:3], v[38:39]
    v_cvt_pk_bf16_f32 v66, v2, v3
    v_lshlrev_b32 v2, 16, v66
    v_and_b32 v3, s40, v66
    v_lshlrev_b32 v68, 16, v53
    v_and_b32 v69, s40, v53
    v_pk_add_f32 v[2:3], v[2:3], v[68:69]
    v_cvt_pk_bf16_f32 v53, v2, v3
    s_mov_b32 s48, 0
    buffer_store_dwordx2 v[52:53], v34, s[12:15], s48 offen offset:0
    s_waitcnt vmcnt(3)
    v_pk_add_f32 v[4:5], v[4:5], v[12:13]
    v_cvt_pk_bf16_f32 v62, v4, v5
    v_lshlrev_b32 v4, 16, v62
    v_and_b32 v5, s40, v62
    v_pk_mul_f32 v[4:5], v[4:5], v[36:37]
    v_cvt_pk_bf16_f32 v62, v4, v5
    v_lshlrev_b32 v4, 16, v62
    v_and_b32 v5, s40, v62
    v_lshlrev_b32 v64, 16, v54
    v_and_b32 v65, s40, v54
    v_pk_add_f32 v[4:5], v[4:5], v[64:65]
    v_cvt_pk_bf16_f32 v54, v4, v5
    v_pk_add_f32 v[6:7], v[6:7], v[14:15]
    v_cvt_pk_bf16_f32 v66, v6, v7
    v_lshlrev_b32 v6, 16, v66
    v_and_b32 v7, s40, v66
    v_pk_mul_f32 v[6:7], v[6:7], v[38:39]
    v_cvt_pk_bf16_f32 v66, v6, v7
    v_lshlrev_b32 v6, 16, v66
    v_and_b32 v7, s40, v66
    v_lshlrev_b32 v68, 16, v55
    v_and_b32 v69, s40, v55
    v_pk_add_f32 v[6:7], v[6:7], v[68:69]
    v_cvt_pk_bf16_f32 v55, v6, v7
    s_mov_b32 s48, 32768
    buffer_store_dwordx2 v[54:55], v34, s[12:15], s48 offen offset:0
    s_waitcnt vmcnt(3)
    v_pk_add_f32 v[16:17], v[16:17], v[24:25]
    v_cvt_pk_bf16_f32 v62, v16, v17
    v_lshlrev_b32 v16, 16, v62
    v_and_b32 v17, s40, v62
    v_pk_mul_f32 v[16:17], v[16:17], v[40:41]
    v_cvt_pk_bf16_f32 v62, v16, v17
    v_lshlrev_b32 v16, 16, v62
    v_and_b32 v17, s40, v62
    v_lshlrev_b32 v64, 16, v56
    v_and_b32 v65, s40, v56
    v_pk_add_f32 v[16:17], v[16:17], v[64:65]
    v_cvt_pk_bf16_f32 v56, v16, v17
    v_pk_add_f32 v[18:19], v[18:19], v[26:27]
    v_cvt_pk_bf16_f32 v66, v18, v19
    v_lshlrev_b32 v18, 16, v66
    v_and_b32 v19, s40, v66
    v_pk_mul_f32 v[18:19], v[18:19], v[42:43]
    v_cvt_pk_bf16_f32 v66, v18, v19
    v_lshlrev_b32 v18, 16, v66
    v_and_b32 v19, s40, v66
    v_lshlrev_b32 v68, 16, v57
    v_and_b32 v69, s40, v57
    v_pk_add_f32 v[18:19], v[18:19], v[68:69]
    v_cvt_pk_bf16_f32 v57, v18, v19
    s_mov_b32 s48, 0
    buffer_store_dwordx2 v[56:57], v34, s[12:15], s48 offen offset:32
    s_waitcnt vmcnt(3)
    v_pk_add_f32 v[20:21], v[20:21], v[28:29]
    v_cvt_pk_bf16_f32 v62, v20, v21
    v_lshlrev_b32 v20, 16, v62
    v_and_b32 v21, s40, v62
    v_pk_mul_f32 v[20:21], v[20:21], v[40:41]
    v_cvt_pk_bf16_f32 v62, v20, v21
    v_lshlrev_b32 v20, 16, v62
    v_and_b32 v21, s40, v62
    v_lshlrev_b32 v64, 16, v58
    v_and_b32 v65, s40, v58
    v_pk_add_f32 v[20:21], v[20:21], v[64:65]
    v_cvt_pk_bf16_f32 v58, v20, v21
    v_pk_add_f32 v[22:23], v[22:23], v[30:31]
    v_cvt_pk_bf16_f32 v66, v22, v23
    v_lshlrev_b32 v22, 16, v66
    v_and_b32 v23, s40, v66
    v_pk_mul_f32 v[22:23], v[22:23], v[42:43]
    v_cvt_pk_bf16_f32 v66, v22, v23
    v_lshlrev_b32 v22, 16, v66
    v_and_b32 v23, s40, v66
    v_lshlrev_b32 v68, 16, v59
    v_and_b32 v69, s40, v59
    v_pk_add_f32 v[22:23], v[22:23], v[68:69]
    v_cvt_pk_bf16_f32 v59, v22, v23
    s_mov_b32 s48, 32768
    buffer_store_dwordx2 v[58:59], v34, s[12:15], s48 offen offset:32
    s_branch Lkj_40
Lk1_39:
    buffer_store_dwordx4 v[0:3], v60, s[60:63], 0 offen offset:0 sc1
    buffer_store_dwordx4 v[4:7], v60, s[60:63], 0 offen offset:1024 sc1
    buffer_store_dwordx4 v[16:19], v60, s[60:63], 0 offen offset:2048 sc1
    buffer_store_dwordx4 v[20:23], v60, s[60:63], 0 offen offset:3072 sc1
    s_waitcnt vmcnt(0)
    s_lshl_b32 s76, s2, 3
    s_add_u32 s76, s76, s16
    s_lshl_b32 s76, s76, 7
    s_add_u32 s76, s76, 32768
    s_add_u32 s77, s93, 5
    v_mov_b32 v62, s76
    v_mov_b32 v63, s77
    s_mov_b64 exec, 1
    buffer_store_dword v63, v62, s[88:91], 0 offen sc1
    s_mov_b64 exec, -1
    s_barrier
    v_pk_add_f32 v[36:37], v[36:37], v[44:45]
    v_cvt_pk_bf16_f32 v62, v36, v37
    v_lshlrev_b32 v36, 16, v62
    v_and_b32 v37, s40, v62
    v_pk_add_f32 v[38:39], v[38:39], v[46:47]
    v_cvt_pk_bf16_f32 v62, v38, v39
    v_lshlrev_b32 v38, 16, v62
    v_and_b32 v39, s40, v62
    v_pk_add_f32 v[40:41], v[40:41], v[48:49]
    v_cvt_pk_bf16_f32 v62, v40, v41
    v_lshlrev_b32 v40, 16, v62
    v_and_b32 v41, s40, v62
    v_pk_add_f32 v[42:43], v[42:43], v[50:51]
    v_cvt_pk_bf16_f32 v62, v42, v43
    v_lshlrev_b32 v42, 16, v62
    v_and_b32 v43, s40, v62
    s_lshl_b32 s48, s46, 3
    s_add_u32 s48, s48, s16
    s_lshl_b32 s48, s48, 7
    s_add_u32 s48, s48, 32768
    v_mov_b32 v62, s48
    s_mov_b32 s59, 200000
    s_add_u32 s76, s93, 5
Lpoll_43:
    buffer_load_dword v63, v62, s[88:91], 0 offen sc1
    s_waitcnt vmcnt(0)
    v_subrev_u32 v63, s76, v63
    v_cmp_gt_u32 vcc, 3, v63
    s_nop 1
    s_cmp_eq_u64 vcc, -1
    s_cbranch_scc1 Lpd_44
    s_sub_u32 s59, s59, 1
    s_cmp_lg_u32 s59, 0
    s_sleep 1
    s_cbranch_scc1 Lpoll_43
Lpd_44:
    buffer_load_dwordx4 v[0:3], v61, s[60:63], 0 offen offset:0 sc1
    buffer_load_dwordx4 v[4:7], v61, s[60:63], 0 offen offset:1024 sc1
    buffer_load_dwordx4 v[16:19], v61, s[60:63], 0 offen offset:2048 sc1
    buffer_load_dwordx4 v[20:23], v61, s[60:63], 0 offen offset:3072 sc1
    s_waitcnt vmcnt(3)
    v_pk_add_f32 v[8:9], v[8:9], v[0:1]
    v_cvt_pk_bf16_f32 v62, v8, v9
    v_lshlrev_b32 v8, 16, v62
    v_and_b32 v9, s40, v62
    v_pk_mul_f32 v[8:9], v[8:9], v[36:37]
    v_cvt_pk_bf16_f32 v62, v8, v9
    v_lshlrev_b32 v8, 16, v62
    v_and_b32 v9, s40, v62
    v_lshlrev_b32 v64, 16, v52
    v_and_b32 v65, s40, v52
    v_pk_add_f32 v[8:9], v[8:9], v[64:65]
    v_cvt_pk_bf16_f32 v52, v8, v9
    v_pk_add_f32 v[10:11], v[10:11], v[2:3]
    v_cvt_pk_bf16_f32 v66, v10, v11
    v_lshlrev_b32 v10, 16, v66
    v_and_b32 v11, s40, v66
    v_pk_mul_f32 v[10:11], v[10:11], v[38:39]
    v_cvt_pk_bf16_f32 v66, v10, v11
    v_lshlrev_b32 v10, 16, v66
    v_and_b32 v11, s40, v66
    v_lshlrev_b32 v68, 16, v53
    v_and_b32 v69, s40, v53
    v_pk_add_f32 v[10:11], v[10:11], v[68:69]
    v_cvt_pk_bf16_f32 v53, v10, v11
    s_mov_b32 s48, 0
    buffer_store_dwordx2 v[52:53], v34, s[12:15], s48 offen offset:0
    s_waitcnt vmcnt(3)
    v_pk_add_f32 v[12:13], v[12:13], v[4:5]
    v_cvt_pk_bf16_f32 v62, v12, v13
    v_lshlrev_b32 v12, 16, v62
    v_and_b32 v13, s40, v62
    v_pk_mul_f32 v[12:13], v[12:13], v[36:37]
    v_cvt_pk_bf16_f32 v62, v12, v13
    v_lshlrev_b32 v12, 16, v62
    v_and_b32 v13, s40, v62
    v_lshlrev_b32 v64, 16, v54
    v_and_b32 v65, s40, v54
    v_pk_add_f32 v[12:13], v[12:13], v[64:65]
    v_cvt_pk_bf16_f32 v54, v12, v13
    v_pk_add_f32 v[14:15], v[14:15], v[6:7]
    v_cvt_pk_bf16_f32 v66, v14, v15
    v_lshlrev_b32 v14, 16, v66
    v_and_b32 v15, s40, v66
    v_pk_mul_f32 v[14:15], v[14:15], v[38:39]
    v_cvt_pk_bf16_f32 v66, v14, v15
    v_lshlrev_b32 v14, 16, v66
    v_and_b32 v15, s40, v66
    v_lshlrev_b32 v68, 16, v55
    v_and_b32 v69, s40, v55
    v_pk_add_f32 v[14:15], v[14:15], v[68:69]
    v_cvt_pk_bf16_f32 v55, v14, v15
    s_mov_b32 s48, 32768
    buffer_store_dwordx2 v[54:55], v34, s[12:15], s48 offen offset:0
    s_waitcnt vmcnt(3)
    v_pk_add_f32 v[24:25], v[24:25], v[16:17]
    v_cvt_pk_bf16_f32 v62, v24, v25
    v_lshlrev_b32 v24, 16, v62
    v_and_b32 v25, s40, v62
    v_pk_mul_f32 v[24:25], v[24:25], v[40:41]
    v_cvt_pk_bf16_f32 v62, v24, v25
    v_lshlrev_b32 v24, 16, v62
    v_and_b32 v25, s40, v62
    v_lshlrev_b32 v64, 16, v56
    v_and_b32 v65, s40, v56
    v_pk_add_f32 v[24:25], v[24:25], v[64:65]
    v_cvt_pk_bf16_f32 v56, v24, v25
    v_pk_add_f32 v[26:27], v[26:27], v[18:19]
    v_cvt_pk_bf16_f32 v66, v26, v27
    v_lshlrev_b32 v26, 16, v66
    v_and_b32 v27, s40, v66
    v_pk_mul_f32 v[26:27], v[26:27], v[42:43]
    v_cvt_pk_bf16_f32 v66, v26, v27
    v_lshlrev_b32 v26, 16, v66
    v_and_b32 v27, s40, v66
    v_lshlrev_b32 v68, 16, v57
    v_and_b32 v69, s40, v57
    v_pk_add_f32 v[26:27], v[26:27], v[68:69]
    v_cvt_pk_bf16_f32 v57, v26, v27
    s_mov_b32 s48, 0
    buffer_store_dwordx2 v[56:57], v34, s[12:15], s48 offen offset:32
    s_waitcnt vmcnt(3)
    v_pk_add_f32 v[28:29], v[28:29], v[20:21]
    v_cvt_pk_bf16_f32 v62, v28, v29
    v_lshlrev_b32 v28, 16, v62
    v_and_b32 v29, s40, v62
    v_pk_mul_f32 v[28:29], v[28:29], v[40:41]
    v_cvt_pk_bf16_f32 v62, v28, v29
    v_lshlrev_b32 v28, 16, v62
    v_and_b32 v29, s40, v62
    v_lshlrev_b32 v64, 16, v58
    v_and_b32 v65, s40, v58
    v_pk_add_f32 v[28:29], v[28:29], v[64:65]
    v_cvt_pk_bf16_f32 v58, v28, v29
    v_pk_add_f32 v[30:31], v[30:31], v[22:23]
    v_cvt_pk_bf16_f32 v66, v30, v31
    v_lshlrev_b32 v30, 16, v66
    v_and_b32 v31, s40, v66
    v_pk_mul_f32 v[30:31], v[30:31], v[42:43]
    v_cvt_pk_bf16_f32 v66, v30, v31
    v_lshlrev_b32 v30, 16, v66
    v_and_b32 v31, s40, v66
    v_lshlrev_b32 v68, 16, v59
    v_and_b32 v69, s40, v59
    v_pk_add_f32 v[30:31], v[30:31], v[68:69]
    v_cvt_pk_bf16_f32 v59, v30, v31
    s_mov_b32 s48, 32768
    buffer_store_dwordx2 v[58:59], v34, s[12:15], s48 offen offset:32
Lkj_40:
Lend_1:
    s_endpgm
.section .rodata,"a"
.p2align 6
.amdhsa_kernel adaLN_cond__ssm_conv_h3__glu_gated_swiglu__prompt_kernel
  .amdhsa_next_free_vgpr 256
  .amdhsa_next_free_sgpr 102
  .amdhsa_accum_offset 144
  .amdhsa_group_segment_fixed_size 0
  .amdhsa_kernarg_size 120
  .amdhsa_user_sgpr_count 2
  .amdhsa_user_sgpr_kernarg_segment_ptr 1
  .amdhsa_system_sgpr_workgroup_id_x 1
  .amdhsa_float_denorm_mode_32 3
.end_amdhsa_kernel
```
